```python
import torch

def _softmax(x, axis=-1):
    return torch.softmax(x, dim=axis)
def _gelu(x):
    return torch.nn.functional.gelu(x, approximate="tanh")
def _silu(x):
    return torch.nn.functional.silu(x)
def _sigmoid(x):
    return torch.sigmoid(x)
def _layernorm(x, axis=-1, eps=1e-5):
    m = x.mean(dim=axis, keepdim=True)
    v = x.var(dim=axis, keepdim=True, unbiased=False)
    return (x - m) / torch.sqrt(v + eps)
def _scatter_add(tgt, idx, src, axis=0):
    return tgt.clone().index_add_(axis, idx, src)
def _segment_sum(src, seg, n):
    out = torch.zeros((n,) + src.shape[1:], dtype=src.dtype)
    return out.index_add_(0, seg, src)
def _pad(x, pw):
    flat = tuple(v for pair in reversed(pw) for v in pair)
    return torch.nn.functional.pad(x, flat)

kernel_name = 'sequential_preLN__linear_kernel_hedgehog__mixer_s_mlp__prompt'

def setup_inputs():

    _w = (lambda a: (lambda t: t.to(torch.bfloat16) if t.is_floating_point() else t)(torch.as_tensor(a)))
    def _A_setup():
        B, S, D, H = 1, 2048, 640, 32
        Dh = D // H
        return {
            "x": _w((lambda *s: torch.randn(*s, dtype=torch.bfloat16) * 0.05)(B, S, D)),
            "wqkv": _w((lambda *s: torch.randn(*s, dtype=torch.bfloat16) * 0.2)(D, 3 * D)),
            "w_phi": _w((lambda *s: torch.randn(*s, dtype=torch.bfloat16) * 0.2)(H, Dh, Dh) * (Dh ** -0.5)),
            "wo": _w((lambda *s: torch.randn(*s, dtype=torch.bfloat16) * 0.05)(D, D)),
        }
    _A_in = _A_setup()

    def _B_setup():
        B, S, D, F = 1, 2048, 640, 1536
        return {
            "x":  _w((lambda *s: torch.randn(*s, dtype=torch.bfloat16) * 0.05)(B, S, D)),
            "w1": _w((lambda *s: torch.randn(*s, dtype=torch.bfloat16) * 3.2)(D, D) * (D ** -0.5)),
            "w2": _w((lambda *s: torch.randn(*s, dtype=torch.bfloat16) * 3.2)(D, D) * (D ** -0.5)),
            "w3": _w((lambda *s: torch.randn(*s, dtype=torch.bfloat16) * 3.2)(D, F) * (D ** -0.5)),
            "w4": _w((lambda *s: torch.randn(*s, dtype=torch.bfloat16) * 3.2)(F, D) * (F ** -0.5)),
        }
    _B_in = _B_setup()

    return {
        "A_x": _A_in["x"],
        "A_wqkv": _A_in["wqkv"],
        "A_w_phi": _A_in["w_phi"],
        "A_wo": _A_in["wo"],
        "B_x": _B_in["x"],
        "B_w1": _B_in["w1"],
        "B_w2": _B_in["w2"],
        "B_w3": _B_in["w3"],
        "B_w4": _B_in["w4"],
    }

def reference(A_x, A_wqkv, A_w_phi, A_wo, B_x, B_w1, B_w2, B_w3, B_w4):
    def _A_ref(x, wqkv, w_phi, wo):
        B, S, D = x.shape
        H = 32; Dh = D // H
        qkv = (lambda x, *d: x.permute(*d))((x @ wqkv).reshape(B, S, 3, H, Dh), 2, 0, 3, 1, 4)
        q, k, v = qkv[0], qkv[1], qkv[2]
        pq = torch.einsum("bhsd,hdf->bhsf", q, w_phi)
        pk = torch.einsum("bhsd,hdf->bhsf", k, w_phi)
        phi_q = torch.concatenate([_softmax(pq, axis=-1), _softmax(-pq, axis=-1)], axis=-1)
        phi_k = torch.concatenate([_softmax(pk, axis=-1), _softmax(-pk, axis=-1)], axis=-1)
        kv = torch.einsum("bhsf,bhsd->bhfd", phi_k, v)
        z  = torch.einsum("bhsf->bhf", phi_k)
        num = torch.einsum("bhqf,bhfd->bhqd", phi_q, kv)
        den = torch.einsum("bhqf,bhf->bhq", phi_q, z)[..., None] + 1e-6
        o = num / den
        return (lambda x, *d: x.permute(*d))(o, 0, 2, 1, 3).reshape(B, S, D) @ wo

    def _B_ref(x, w1, w2, w3, w4):
        B, S, D = x.shape
        h = _gelu(_layernorm(x, axis=-1) @ w1)
        c = D // 4
        g0 = _pad(h[:, :, 0*c:1*c], ((0, 0), (1, 0), (0, 0)))[:, :S, :]
        g1 = _pad(h[:, :, 1*c:2*c], ((0, 0), (0, 1), (0, 0)))[:, 1:, :]
        g2 = _pad(h[:, :, 2*c:3*c], ((0, 0), (2, 0), (0, 0)))[:, :S, :]
        g3 = _pad(h[:, :, 3*c:   ], ((0, 0), (0, 2), (0, 0)))[:, 2:, :]
        hs = torch.concatenate([g0, g1, g2, g3], axis=-1) @ w2
        x1 = x + hs
        h2 = _gelu(_layernorm(x1, axis=-1) @ w3) @ w4
        return x1 + h2

    x = A_x
    h = x + _A_ref(_layernorm(x, axis=-1), A_wqkv, A_w_phi, A_wo)
    h2 = h + _B_ref(_layernorm(h, axis=-1), B_w1, B_w2, B_w3, B_w4)
    return h2
```

```asm
; @launch grid=(256,1,1) block=(512,1,1) lds=163840
.amdgcn_target "amdgcn-amd-amdhsa--gfx950"
.text
.globl sequential_preLN__linear_kernel_hedgehog__mixer_s_mlp__prompt_kernel
.p2align 8
.type sequential_preLN__linear_kernel_hedgehog__mixer_s_mlp__prompt_kernel,@function
sequential_preLN__linear_kernel_hedgehog__mixer_s_mlp__prompt_kernel:
  s_load_dwordx16 s[64:79], s[0:1], 0
  s_load_dwordx8 s[80:87], s[0:1], 64
  s_cmp_ge_u32 s2, 256
  s_cbranch_scc1 L_end
  v_lshrrev_b32 v5, 6, v0
  v_and_b32 v1, 63, v0
  s_and_b32 s4, s2, 7
  s_lshr_b32 s5, s2, 3
  v_readfirstlane_b32 s3, v5
  v_lshrrev_b32 v2, 4, v1
  v_and_b32 v3, 15, v1
  s_and_b32 s48, s5, 1
  s_lshl_b32 s61, s4, 1
  s_add_u32 s61, s61, s48
  s_lshr_b32 s62, s5, 1
  s_and_b32 s57, s3, 3
  s_cmp_lt_u32 s3, 4
  s_cbranch_scc1 L_C0
  s_cmp_ge_u32 s5, 30
  s_cbranch_scc1 L_hsp
  s_lshl_b32 s33, s57, 4
  s_lshl_b32 s34, s62, 8
  v_add_u32 v6, s33, v2
  v_mul_u32_u24 v6, 3840, v6
  v_lshlrev_b32 v7, 2, v2
  v_xor_b32 v7, v7, v3
  v_lshlrev_b32 v7, 4, v7
  v_add3_u32 v12, v6, v7, s34
  v_add_u32 v13, 14336, v12
  v_add_u32 v14, 28672, v12
  v_add_u32 v15, 43008, v12
  s_mul_i32 s36, s48, 5
  s_add_u32 s36, s36, s62
  s_mul_i32 s38, s4, 2
  s_add_u32 s36, s36, s38
  s_mul_i32 s38, s36, 205
  s_lshr_b32 s38, s38, 11
  s_mul_i32 s38, s38, 10
  s_sub_u32 s36, s36, s38
  s_lshl_b32 s37, s57, 12
  s_waitcnt lgkmcnt(0)
  s_add_u32 s94, s86, 0xb9c000
  s_addc_u32 s95, s87, 0
  s_load_dword s99, s[94:95], 0
  s_mov_b32 s12, s66
  s_and_b32 s13, s67, 0xffff
  s_mov_b32 s14, 0x258000
  s_mov_b32 s15, 0x20000
  s_lshl_b32 s38, s36, 7
  s_mul_i32 s39, s36, 245760
  s_add_u32 m0, s37, 81920
  s_nop 0
  buffer_load_dwordx4 v12, s[12:15], s39 offen offset:0 lds
  buffer_load_dwordx4 v13, s[12:15], s39 offen offset:1024 lds
  buffer_load_dwordx4 v14, s[12:15], s39 offen offset:2048 lds
  buffer_load_dwordx4 v15, s[12:15], s39 offen offset:3072 lds
  v_lshrrev_b32 v6, 3, v1
  s_lshl_b32 s33, s61, 7
  s_lshl_b32 s34, s57, 5
  s_add_u32 s33, s33, s34
  v_add_u32 v6, s33, v6
  v_mul_u32_u24 v6, 1280, v6
  v_and_b32 v7, 7, v1
  v_xor_b32 v7, v7, v2
  v_xor_b32 v16, 0, v7
  v_lshl_add_u32 v8, v16, 4, v6
  v_xor_b32 v16, 4, v7
  v_lshl_add_u32 v9, v16, 4, v6
  v_add_u32 v9, 9216, v9
  v_xor_b32 v16, 0, v7
  v_lshl_add_u32 v10, v16, 4, v6
  v_add_u32 v10, 18432, v10
  v_xor_b32 v16, 4, v7
  v_lshl_add_u32 v11, v16, 4, v6
  v_add_u32 v11, 27648, v11
  s_mov_b32 s8, s64
  s_and_b32 s9, s65, 0xffff
  s_mov_b32 s10, 0x280000
  s_mov_b32 s11, 0x20000
  s_add_u32 m0, s37, 65536
  s_nop 0
  buffer_load_dwordx4 v8, s[8:11], s38 offen offset:0 nt lds
  buffer_load_dwordx4 v9, s[8:11], s38 offen offset:1024 nt lds
  buffer_load_dwordx4 v10, s[8:11], s38 offen offset:2048 nt lds
  buffer_load_dwordx4 v11, s[8:11], s38 offen offset:3072 nt lds
  s_add_u32 s36, s36, 1
  s_cmp_eq_u32 s36, 10
  s_cselect_b32 s36, 0, s36
  s_branch L_H1
L_C0:
  s_waitcnt lgkmcnt(0)
  s_add_u32 s94, s86, 0xb9c000
  s_addc_u32 s95, s87, 0
  s_load_dword s99, s[94:95], 0
  s_mov_b32 s8, s64
  s_and_b32 s9, s65, 0xffff
  s_mov_b32 s10, 0x280000
  s_mov_b32 s11, 0x20000
  s_cmp_eq_u32 s3, 1
  s_cbranch_scc1 I_1
  s_cmp_eq_u32 s3, 2
  s_cbranch_scc1 I_2
  s_lshl_b32 s32, s4, 8
  s_lshl_b32 s33, s5, 3
  s_add_u32 s32, s32, s33
  s_and_b32 s33, s3, 1
  s_lshl_b32 s33, s33, 2
  s_add_u32 s32, s32, s33
  v_add_u32 v201, s32, v2
  v_mul_u32_u24 v202, 1280, v201
  v_lshl_add_u32 v202, v3, 4, v202
  buffer_load_dwordx4 v[224:227], v202, s[8:11], 0 offen offset:0 nt
  buffer_load_dwordx4 v[228:231], v202, s[8:11], 0 offen offset:256 nt
  buffer_load_dwordx4 v[232:235], v202, s[8:11], 0 offen offset:512 nt
  buffer_load_dwordx4 v[236:239], v202, s[8:11], 0 offen offset:768 nt
  buffer_load_dwordx4 v[240:243], v202, s[8:11], 0 offen offset:1024 nt
  s_branch I_3
I_1:
  s_mov_b32 s28, s68
  s_and_b32 s29, s69, 0xffff
  s_mov_b32 s30, 0x6400
  s_mov_b32 s31, 0x20000
  v_lshlrev_b32 v200, 4, v1
  v_add_u32 v201, 0x23000, v200
  s_mul_i32 s32, s5, 800
  buffer_load_dwordx4 v[206:209], v200, s[28:31], s32 offen
  s_getpc_b64 s[94:95]
L_pc0:
  s_sub_u32 s94, s94, L_pc0-sequential_preLN__linear_kernel_hedgehog__mixer_s_mlp__prompt_kernel
  s_subb_u32 s95, s95, 0
  s_and_b32 s96, s5, 15
  s_lshl_b32 s96, s96, 4
  v_add_u32 v210, s96, v3
  v_min_u32 v210, (L_pc-sequential_preLN__linear_kernel_hedgehog__mixer_s_mlp__prompt_kernel)/128, v210
  v_lshlrev_b32 v210, 7, v210
  v_mov_b32 v211, s95
  v_add_co_u32 v210, vcc, s94, v210
  s_nop 1
  v_addc_co_u32 v211, vcc, 0, v211, vcc
  global_load_dword v212, v[210:211], off
  v_mov_b32 v202, 0
  v_mov_b32 v203, 0
  v_mov_b32 v204, 0
  v_mov_b32 v205, 0
  ds_write_b128 v201, v[202:205] offset:0
  ds_write_b128 v201, v[202:205] offset:1024
  ds_write_b128 v201, v[202:205] offset:2048
  ds_write_b128 v201, v[202:205] offset:5120
I_2:
  s_cmp_ge_u32 s2, 200
  s_cbranch_scc1 I_3
  s_and_b32 s94, s3, 1
  s_lshl_b32 s63, s94, 12
  s_add_u32 s63, s63, 131072
  s_mul_i32 s40, s94, 200
  s_add_u32 s40, s40, s2
  s_mov_b32 s44, 0
  s_mov_b32 s33, 0
  s_mov_b32 s28, s70
  s_mov_b32 s29, s71
  s_cmp_ge_u32 s40, 200
  s_cmov_b32 s44, 1
  s_cmov_b32 s33, 200
  s_cmov_b32 s28, s74
  s_cmov_b32 s29, s75
  s_sub_u32 s45, s40, s33
  s_and_b32 s29, s29, 0xffff
  s_mov_b32 s30, 819200
  s_mov_b32 s31, 0x20000
  s_cmp_eq_u32 s44, 3
  s_mov_b32 s43, 1280
  s_cmov_b32 s43, 3072
  s_cmp_eq_u32 s44, 4
  s_mov_b32 s33, 52429
  s_cmov_b32 s33, 21846
  s_mul_i32 s41, s45, s33
  s_lshr_b32 s41, s41, 20
  s_cmp_eq_u32 s44, 4
  s_cselect_b32 s33, 48, 20
  s_mul_i32 s33, s41, s33
  s_sub_u32 s42, s45, s33
  v_lshrrev_b32 v214, 3, v1
  v_mul_lo_u32 v214, v214, s43
  v_and_b32 v215, 7, v1
  v_lshl_add_u32 v214, v215, 4, v214
  s_mul_i32 s45, s42, s43
  s_lshl_b32 s45, s45, 5
  s_lshl_b32 s33, s41, 7
  s_add_u32 s45, s45, s33
  s_lshl_b32 s34, s43, 3
  s_add_u32 m0, s63, 0
  s_nop 0
  buffer_load_dwordx4 v214, s[28:31], s45 offen nt lds
  s_add_u32 s45, s45, s34
  s_add_u32 m0, s63, 1024
  s_nop 0
  buffer_load_dwordx4 v214, s[28:31], s45 offen nt lds
  s_add_u32 s45, s45, s34
  s_add_u32 m0, s63, 2048
  s_nop 0
  buffer_load_dwordx4 v214, s[28:31], s45 offen nt lds
  s_add_u32 s45, s45, s34
  s_add_u32 m0, s63, 3072
  s_nop 0
  buffer_load_dwordx4 v214, s[28:31], s45 offen nt lds
  s_mul_i32 s36, s42, 5120
  s_mul_i32 s45, s44, 102400
  s_add_u32 s36, s36, s45
  s_add_u32 s36, s36, 0xc00000
  s_mul_i32 s37, s42, 2560
  s_add_u32 s37, s37, 0x1300000
  s_cmp_eq_u32 s44, 1
  s_cselect_b32 s37, s37, 0x40000000
  s_lshl_b32 s34, s41, 2
  s_add_u32 s34, s34, 0
  s_mul_i32 s45, s34, 52
  s_lshr_b32 s45, s45, 8
  s_mul_i32 s33, s45, 5
  s_sub_u32 s33, s34, s33
  s_and_b32 s34, s45, 1
  s_sub_u32 s33, s33, s34
  s_cmp_lt_i32 s33, 0
  s_cselect_b32 s33, 4, s33
  s_mul_i32 s34, s45, 798720
  s_lshl_b32 s35, s33, 10
  s_add_u32 s34, s34, s35
  s_add_u32 s46, s34, s36
  s_mul_i32 s34, s45, 320
  s_lshl_b32 s35, s33, 6
  s_add_u32 s34, s34, s35
  s_add_u32 s38, s34, s37
  s_lshl_b32 s34, s41, 2
  s_add_u32 s34, s34, 1
  s_mul_i32 s45, s34, 52
  s_lshr_b32 s45, s45, 8
  s_mul_i32 s33, s45, 5
  s_sub_u32 s33, s34, s33
  s_and_b32 s34, s45, 1
  s_sub_u32 s33, s33, s34
  s_cmp_lt_i32 s33, 0
  s_cselect_b32 s33, 4, s33
  s_mul_i32 s34, s45, 798720
  s_lshl_b32 s35, s33, 10
  s_add_u32 s34, s34, s35
  s_add_u32 s47, s34, s36
  s_mul_i32 s34, s45, 320
  s_lshl_b32 s35, s33, 6
  s_add_u32 s34, s34, s35
  s_add_u32 s39, s34, s37
  s_lshl_b32 s34, s41, 2
  s_add_u32 s34, s34, 2
  s_mul_i32 s45, s34, 52
  s_lshr_b32 s45, s45, 8
  s_mul_i32 s33, s45, 5
  s_sub_u32 s33, s34, s33
  s_and_b32 s34, s45, 1
  s_sub_u32 s33, s33, s34
  s_cmp_lt_i32 s33, 0
  s_cselect_b32 s33, 4, s33
  s_mul_i32 s34, s45, 798720
  s_lshl_b32 s35, s33, 10
  s_add_u32 s34, s34, s35
  s_add_u32 s92, s34, s36
  s_mul_i32 s34, s45, 320
  s_lshl_b32 s35, s33, 6
  s_add_u32 s34, s34, s35
  s_add_u32 s88, s34, s37
  s_lshl_b32 s34, s41, 2
  s_add_u32 s34, s34, 3
  s_mul_i32 s45, s34, 52
  s_lshr_b32 s45, s45, 8
  s_mul_i32 s33, s45, 5
  s_sub_u32 s33, s34, s33
  s_and_b32 s34, s45, 1
  s_sub_u32 s33, s33, s34
  s_cmp_lt_i32 s33, 0
  s_cselect_b32 s33, 4, s33
  s_mul_i32 s34, s45, 798720
  s_lshl_b32 s35, s33, 10
  s_add_u32 s34, s34, s35
  s_add_u32 s93, s34, s36
  s_mul_i32 s34, s45, 320
  s_lshl_b32 s35, s33, 6
  s_add_u32 s34, s34, s35
  s_add_u32 s89, s34, s37
  s_mov_b32 s24, s46
  s_mov_b32 s25, s47
  s_mov_b32 s26, s92
  s_mov_b32 s27, s93
  s_mov_b32 s90, s38
  s_mov_b32 s91, s39
I_3:
  s_branch L_C1
L_H1:
  s_mov_b32 s6, 0
  s_lshr_b32 s50, s5, 2
  v_mov_b32 v4, 1
  s_mul_i32 s60, s50, 798720
  s_add_u32 s60, s60, 0xc00000
  s_mul_i32 s56, s57, 5120
  s_lshr_b32 s94, s4, 1
  s_add_u32 s95, s94, 0
  s_cmp_ge_u32 s95, 5
  s_cselect_b32 s96, 5, 0
  s_sub_u32 s95, s95, s96
  s_lshl_b32 s24, s95, 10
  s_add_u32 s95, s94, 1
  s_cmp_ge_u32 s95, 5
  s_cselect_b32 s96, 5, 0
  s_sub_u32 s95, s95, s96
  s_lshl_b32 s25, s95, 10
  s_add_u32 s95, s94, 2
  s_cmp_ge_u32 s95, 5
  s_cselect_b32 s96, 5, 0
  s_sub_u32 s95, s95, s96
  s_lshl_b32 s26, s95, 10
  s_add_u32 s95, s94, 3
  s_cmp_ge_u32 s95, 5
  s_cselect_b32 s96, 5, 0
  s_sub_u32 s95, s95, s96
  s_lshl_b32 s27, s95, 10
  s_add_u32 s95, s94, 4
  s_cmp_ge_u32 s95, 5
  s_cselect_b32 s96, 5, 0
  s_sub_u32 s95, s95, s96
  s_lshl_b32 s84, s95, 10
  s_and_b32 s85, s4, 1
  s_mul_i32 s72, s4, 11
  s_lshr_b32 s72, s72, 5
  s_mul_i32 s72, s72, 3
  s_sub_u32 s72, s4, s72
  v_lshlrev_b32 v5, 4, v1
  v_add_u32 v5, s56, v5
  s_lshl_b32 s38, s36, 7
  s_mul_i32 s39, s36, 245760
  s_add_u32 m0, s37, 114688
  s_nop 0
  buffer_load_dwordx4 v12, s[12:15], s39 offen offset:0 lds
  buffer_load_dwordx4 v13, s[12:15], s39 offen offset:1024 lds
  buffer_load_dwordx4 v14, s[12:15], s39 offen offset:2048 lds
  buffer_load_dwordx4 v15, s[12:15], s39 offen offset:3072 lds
  s_add_u32 m0, s37, 98304
  s_nop 0
  buffer_load_dwordx4 v8, s[8:11], s38 offen offset:0 lds
  buffer_load_dwordx4 v9, s[8:11], s38 offen offset:1024 lds
  buffer_load_dwordx4 v10, s[8:11], s38 offen offset:2048 lds
  buffer_load_dwordx4 v11, s[8:11], s38 offen offset:3072 lds
  s_add_u32 s36, s36, 1
  s_cmp_eq_u32 s36, 10
  s_cselect_b32 s36, 0, s36
  s_mov_b32 s16, s86
  s_and_b32 s17, s87, 0xffff
  s_mov_b32 s18, 0x10000000
  s_mov_b32 s19, 0x20000
  s_mov_b32 s20, s82
  s_and_b32 s21, s83, 0xffff
  s_mov_b32 s22, 0x280000
  s_mov_b32 s23, 0x20000
  s_waitcnt lgkmcnt(0)
  s_mul_i32 s99, s99, 0x9e3779b1
  s_add_u32 s99, s99, 0x7f4a7c15
  v_mov_b32 v252, s99
  s_waitcnt vmcnt(8)
  s_barrier
  s_lshl_b32 s38, s36, 7
  s_mul_i32 s39, s36, 245760
  s_add_u32 m0, s37, 16384
  s_nop 0
  buffer_load_dwordx4 v12, s[12:15], s39 offen offset:0 lds
  buffer_load_dwordx4 v13, s[12:15], s39 offen offset:1024 lds
  buffer_load_dwordx4 v14, s[12:15], s39 offen offset:2048 lds
  buffer_load_dwordx4 v15, s[12:15], s39 offen offset:3072 lds
  s_add_u32 m0, s37, 0
  s_nop 0
  buffer_load_dwordx4 v8, s[8:11], s38 offen offset:0 lds
  buffer_load_dwordx4 v9, s[8:11], s38 offen offset:1024 lds
  buffer_load_dwordx4 v10, s[8:11], s38 offen offset:2048 lds
  buffer_load_dwordx4 v11, s[8:11], s38 offen offset:3072 lds
  s_add_u32 s36, s36, 1
  s_cmp_eq_u32 s36, 10
  s_cselect_b32 s36, 0, s36
  s_waitcnt vmcnt(8)
  s_barrier
  s_lshl_b32 s38, s36, 7
  s_mul_i32 s39, s36, 245760
  s_add_u32 m0, s37, 49152
  s_nop 0
  buffer_load_dwordx4 v12, s[12:15], s39 offen offset:0 lds
  buffer_load_dwordx4 v13, s[12:15], s39 offen offset:1024 lds
  buffer_load_dwordx4 v14, s[12:15], s39 offen offset:2048 lds
  buffer_load_dwordx4 v15, s[12:15], s39 offen offset:3072 lds
  s_add_u32 m0, s37, 32768
  s_nop 0
  buffer_load_dwordx4 v8, s[8:11], s38 offen offset:0 lds
  buffer_load_dwordx4 v9, s[8:11], s38 offen offset:1024 lds
  buffer_load_dwordx4 v10, s[8:11], s38 offen offset:2048 lds
  buffer_load_dwordx4 v11, s[8:11], s38 offen offset:3072 lds
  s_add_u32 s36, s36, 1
  s_cmp_eq_u32 s36, 10
  s_cselect_b32 s36, 0, s36
  s_waitcnt vmcnt(8)
  s_barrier
  s_lshl_b32 s38, s36, 7
  s_mul_i32 s39, s36, 245760
  s_add_u32 m0, s37, 81920
  s_nop 0
  buffer_load_dwordx4 v12, s[12:15], s39 offen offset:0 lds
  buffer_load_dwordx4 v13, s[12:15], s39 offen offset:1024 lds
  buffer_load_dwordx4 v14, s[12:15], s39 offen offset:2048 lds
  buffer_load_dwordx4 v15, s[12:15], s39 offen offset:3072 lds
  s_add_u32 m0, s37, 65536
  s_nop 0
  buffer_load_dwordx4 v8, s[8:11], s38 offen offset:0 lds
  buffer_load_dwordx4 v9, s[8:11], s38 offen offset:1024 lds
  buffer_load_dwordx4 v10, s[8:11], s38 offen offset:2048 lds
  buffer_load_dwordx4 v11, s[8:11], s38 offen offset:3072 lds
  s_add_u32 s36, s36, 1
  s_cmp_eq_u32 s36, 10
  s_cselect_b32 s36, 0, s36
  s_waitcnt vmcnt(8)
  s_barrier
  s_lshl_b32 s38, s36, 7
  s_mul_i32 s39, s36, 245760
  s_add_u32 m0, s37, 114688
  s_nop 0
  buffer_load_dwordx4 v12, s[12:15], s39 offen offset:0 lds
  buffer_load_dwordx4 v13, s[12:15], s39 offen offset:1024 lds
  buffer_load_dwordx4 v14, s[12:15], s39 offen offset:2048 lds
  buffer_load_dwordx4 v15, s[12:15], s39 offen offset:3072 lds
  s_add_u32 m0, s37, 98304
  s_nop 0
  buffer_load_dwordx4 v8, s[8:11], s38 offen offset:0 lds
  buffer_load_dwordx4 v9, s[8:11], s38 offen offset:1024 lds
  buffer_load_dwordx4 v10, s[8:11], s38 offen offset:2048 lds
  buffer_load_dwordx4 v11, s[8:11], s38 offen offset:3072 lds
  s_add_u32 s36, s36, 1
  s_cmp_eq_u32 s36, 10
  s_cselect_b32 s36, 0, s36
  s_waitcnt vmcnt(8)
  s_barrier
  s_lshl_b32 s38, s36, 7
  s_mul_i32 s39, s36, 245760
  s_add_u32 m0, s37, 16384
  s_nop 0
  buffer_load_dwordx4 v12, s[12:15], s39 offen offset:0 lds
  buffer_load_dwordx4 v13, s[12:15], s39 offen offset:1024 lds
  buffer_load_dwordx4 v14, s[12:15], s39 offen offset:2048 lds
  buffer_load_dwordx4 v15, s[12:15], s39 offen offset:3072 lds
  s_add_u32 m0, s37, 0
  s_nop 0
  buffer_load_dwordx4 v8, s[8:11], s38 offen offset:0 lds
  buffer_load_dwordx4 v9, s[8:11], s38 offen offset:1024 lds
  buffer_load_dwordx4 v10, s[8:11], s38 offen offset:2048 lds
  buffer_load_dwordx4 v11, s[8:11], s38 offen offset:3072 lds
  s_add_u32 s36, s36, 1
  s_cmp_eq_u32 s36, 10
  s_cselect_b32 s36, 0, s36
  s_waitcnt vmcnt(8)
  s_barrier
  s_lshl_b32 s38, s36, 7
  s_mul_i32 s39, s36, 245760
  s_add_u32 m0, s37, 49152
  s_nop 0
  buffer_load_dwordx4 v12, s[12:15], s39 offen offset:0 lds
  buffer_load_dwordx4 v13, s[12:15], s39 offen offset:1024 lds
  buffer_load_dwordx4 v14, s[12:15], s39 offen offset:2048 lds
  buffer_load_dwordx4 v15, s[12:15], s39 offen offset:3072 lds
  s_add_u32 m0, s37, 32768
  s_nop 0
  buffer_load_dwordx4 v8, s[8:11], s38 offen offset:0 lds
  buffer_load_dwordx4 v9, s[8:11], s38 offen offset:1024 lds
  buffer_load_dwordx4 v10, s[8:11], s38 offen offset:2048 lds
  buffer_load_dwordx4 v11, s[8:11], s38 offen offset:3072 lds
  s_add_u32 s36, s36, 1
  s_cmp_eq_u32 s36, 10
  s_cselect_b32 s36, 0, s36
  s_waitcnt vmcnt(8)
  s_barrier
  s_lshl_b32 s38, s36, 7
  s_mul_i32 s39, s36, 245760
  s_add_u32 m0, s37, 81920
  s_nop 0
  buffer_load_dwordx4 v12, s[12:15], s39 offen offset:0 lds
  buffer_load_dwordx4 v13, s[12:15], s39 offen offset:1024 lds
  buffer_load_dwordx4 v14, s[12:15], s39 offen offset:2048 lds
  buffer_load_dwordx4 v15, s[12:15], s39 offen offset:3072 lds
  s_add_u32 m0, s37, 65536
  s_nop 0
  buffer_load_dwordx4 v8, s[8:11], s38 offen offset:0 lds
  buffer_load_dwordx4 v9, s[8:11], s38 offen offset:1024 lds
  buffer_load_dwordx4 v10, s[8:11], s38 offen offset:2048 lds
  buffer_load_dwordx4 v11, s[8:11], s38 offen offset:3072 lds
  s_add_u32 s36, s36, 1
  s_cmp_eq_u32 s36, 10
  s_cselect_b32 s36, 0, s36
  s_waitcnt vmcnt(8)
  s_barrier
  s_lshl_b32 s38, s36, 7
  s_mul_i32 s39, s36, 245760
  s_add_u32 m0, s37, 114688
  s_nop 0
  buffer_load_dwordx4 v12, s[12:15], s39 offen offset:0 lds
  buffer_load_dwordx4 v13, s[12:15], s39 offen offset:1024 lds
  buffer_load_dwordx4 v14, s[12:15], s39 offen offset:2048 lds
  buffer_load_dwordx4 v15, s[12:15], s39 offen offset:3072 lds
  s_add_u32 m0, s37, 98304
  s_nop 0
  buffer_load_dwordx4 v8, s[8:11], s38 offen offset:0 lds
  buffer_load_dwordx4 v9, s[8:11], s38 offen offset:1024 lds
  buffer_load_dwordx4 v10, s[8:11], s38 offen offset:2048 lds
  buffer_load_dwordx4 v11, s[8:11], s38 offen offset:3072 lds
  s_add_u32 s36, s36, 1
  s_cmp_eq_u32 s36, 10
  s_cselect_b32 s36, 0, s36
  s_waitcnt vmcnt(8)
  s_barrier
  v_and_b32 v36, 31, v1
  v_lshlrev_b32 v36, 2, v36
  s_lshl_b32 s98, s4, 7
  s_add_u32 s98, s98, 0xb9b000
  buffer_load_dword v34, v36, s[16:19], s98 offen sc1
  s_mul_i32 s42, s50, 5
  s_lshr_b32 s42, s42, 2
  s_mul_i32 s43, s42, 80
  s_add_u32 s43, s43, 0xb99000
  v_min_u32 v30, 39, v1
  v_lshlrev_b32 v30, 2, v30
  buffer_load_dword v32, v30, s[16:19], s43 offen offset:0 sc1
  s_waitcnt vmcnt(2)
  s_barrier
  s_waitcnt vmcnt(0)
  v_cmp_ne_u32 vcc, s99, v32
  s_mov_b32 s59, 1
  s_cbranch_vccnz SC_7
  s_mov_b32 s59, 0
  s_mov_b32 s94, 0
  s_mov_b32 s95, 0
  s_cmp_eq_u32 s72, 1
  s_cmov_b32 s94, 20480
  s_cmov_b32 s95, 20480
  s_cmp_eq_u32 s72, 2
  s_cmov_b32 s94, 40960
  s_cmov_b32 s95, 40960
  s_add_u32 s94, s94, s60
  s_add_u32 s95, s95, s56
  s_add_u32 m0, s95, s24
  s_add_u32 s96, s94, s24
  buffer_load_dwordx4 v5, s[16:19], s96 offen sc1 lds
  s_add_u32 m0, s95, s25
  s_add_u32 s96, s94, s25
  buffer_load_dwordx4 v5, s[16:19], s96 offen sc1 lds
  s_add_u32 m0, s95, s26
  s_add_u32 s96, s94, s26
  buffer_load_dwordx4 v5, s[16:19], s96 offen sc1 lds
  s_add_u32 m0, s95, s27
  s_add_u32 s96, s94, s27
  buffer_load_dwordx4 v5, s[16:19], s96 offen sc1 lds
  s_add_u32 m0, s95, s84
  s_add_u32 s96, s94, s84
  buffer_load_dwordx4 v5, s[16:19], s96 offen sc1 lds
  s_mov_b32 s94, 20480
  s_mov_b32 s95, 20480
  s_cmp_eq_u32 s72, 1
  s_cmov_b32 s94, 40960
  s_cmov_b32 s95, 40960
  s_cmp_eq_u32 s72, 2
  s_cmov_b32 s94, 0
  s_cmov_b32 s95, 0
  s_add_u32 s94, s94, s60
  s_add_u32 s95, s95, s56
  s_add_u32 m0, s95, s24
  s_add_u32 s96, s94, s24
  buffer_load_dwordx4 v5, s[16:19], s96 offen sc1 lds
  s_add_u32 m0, s95, s25
  s_add_u32 s96, s94, s25
  buffer_load_dwordx4 v5, s[16:19], s96 offen sc1 lds
  s_add_u32 m0, s95, s26
  s_add_u32 s96, s94, s26
  buffer_load_dwordx4 v5, s[16:19], s96 offen sc1 lds
  s_add_u32 m0, s95, s27
  s_add_u32 s96, s94, s27
  buffer_load_dwordx4 v5, s[16:19], s96 offen sc1 lds
  s_add_u32 m0, s95, s84
  s_add_u32 s96, s94, s84
  buffer_load_dwordx4 v5, s[16:19], s96 offen sc1 lds
  s_mov_b32 s94, 40960
  s_mov_b32 s95, 40960
  s_cmp_eq_u32 s72, 1
  s_cmov_b32 s94, 0
  s_cmov_b32 s95, 0
  s_cmp_eq_u32 s72, 2
  s_cmov_b32 s94, 20480
  s_cmov_b32 s95, 20480
  s_add_u32 s94, s94, s60
  s_add_u32 s95, s95, s56
  s_add_u32 m0, s95, s24
  s_add_u32 s96, s94, s24
  buffer_load_dwordx4 v5, s[16:19], s96 offen sc1 lds
  s_add_u32 m0, s95, s25
  s_add_u32 s96, s94, s25
  buffer_load_dwordx4 v5, s[16:19], s96 offen sc1 lds
  s_add_u32 m0, s95, s26
  s_add_u32 s96, s94, s26
  buffer_load_dwordx4 v5, s[16:19], s96 offen sc1 lds
  s_add_u32 m0, s95, s27
  s_add_u32 s96, s94, s27
  buffer_load_dwordx4 v5, s[16:19], s96 offen sc1 lds
  s_add_u32 m0, s95, s84
  s_add_u32 s96, s94, s84
  buffer_load_dwordx4 v5, s[16:19], s96 offen sc1 lds
SC_7:
  s_waitcnt lgkmcnt(0)
  s_barrier
L_h3:
  v_mov_b32 v128, 0
  v_mov_b32 v129, 0
  s_mov_b32 s7, 400000
  s_waitcnt vmcnt(63)
  s_branch PE_10
P_8:
  buffer_load_dword v34, v36, s[16:19], s98 offen sc1
  s_waitcnt vmcnt(0)
PE_10:
  v_xor_b32 v34, s99, v34
  v_cmp_lt_u32 vcc, 15, v34
  s_nop 0
  s_cbranch_vccz PD_9
  s_sleep 20
  s_sub_u32 s7, s7, 1
  s_cbranch_scc0 P_8
PD_9:
  s_getreg_b32 s94, hwreg(HW_REG_XCC_ID, 0, 4)
  v_cmp_ne_u32 vcc, s94, v34
  s_nop 1
  s_cmp_eq_u64 vcc, 0
  s_cselect_b32 s6, 1, 0
  s_lshr_b32 s58, s5, 1
  s_mul_i32 s58, s58, 5
  s_lshl_b32 s32, s48, 1
  s_add_u32 s58, s58, s32
  v_bfe_u32 v6, v1, 2, 2
  v_and_b32 v7, 3, v1
  s_mul_i32 s32, s48, 160
  s_sub_u32 s32, 145408, s32
  v_mul_u32_u24 v8, 40, v6
  v_add_u32 v8, s32, v8
  v_mov_b32 v9, 0x23000
  v_cmp_eq_u32 vcc, v7, v2
  s_nop 1
  v_cndmask_b32 v8, v9, v8, vcc
  ds_read_b64_tr_b16 v[28:29], v8 offset:0
  ds_read_b64_tr_b16 v[30:31], v8 offset:160
  ds_read_b64_tr_b16 v[32:33], v8 offset:8
  ds_read_b64_tr_b16 v[34:35], v8 offset:168
  ds_read_b64_tr_b16 v[36:37], v8 offset:16
  ds_read_b64_tr_b16 v[38:39], v8 offset:176
  ds_read_b64_tr_b16 v[40:41], v8 offset:24
  ds_read_b64_tr_b16 v[42:43], v8 offset:184
  ds_read_b64_tr_b16 v[44:45], v8 offset:32
  ds_read_b64_tr_b16 v[46:47], v8 offset:192
  s_waitcnt lgkmcnt(5)
  ds_read_b64_tr_b16 v[48:49], v8 offset:320
  ds_read_b64_tr_b16 v[50:51], v8 offset:480
  ds_read_b64_tr_b16 v[52:53], v8 offset:328
  ds_read_b64_tr_b16 v[54:55], v8 offset:488
  ds_read_b64_tr_b16 v[56:57], v8 offset:336
  ds_read_b64_tr_b16 v[58:59], v8 offset:496
  ds_read_b64_tr_b16 v[60:61], v8 offset:344
  ds_read_b64_tr_b16 v[62:63], v8 offset:504
  ds_read_b64_tr_b16 v[64:65], v8 offset:352
  ds_read_b64_tr_b16 v[66:67], v8 offset:512
  s_lshl_b32 s49, s4, 2
  s_add_u32 s49, s49, s57
  v_and_b32 v10, 1, v1
  v_lshlrev_b32 v10, 1, v10
  v_add_u32 v10, s58, v10
  v_lshrrev_b32 v10, 3, v10
  v_lshlrev_b32 v10, 2, v10
  s_lshl_b32 s32, s49, 7
  s_add_u32 s32, s32, 0xb98000
  v_mul_u32_u24 v12, 20480, v2
  v_lshl_add_u32 v12, v3, 4, v12
  s_mul_i32 s33, s49, 81920
  s_lshl_b32 s34, s58, 8
  s_add_u32 s34, s33, s34
  s_add_u32 s33, s34, 0
  s_mov_b32 s7, 400000
P_11:
  buffer_load_dword v11, v10, s[16:19], s32 offen sc1
  s_waitcnt vmcnt(0)
PE_13:
  v_cmp_ne_u32 vcc, s99, v11
  s_nop 0
  s_cbranch_vccz PD_12
  s_sleep 1
  s_sub_u32 s7, s7, 1
  s_cbranch_scc0 P_11
PD_12:
  buffer_load_dwordx4 v[68:71], v12, s[16:19], s33 offen offset:0 sc1
  buffer_load_dwordx4 v[72:75], v12, s[16:19], s33 offen offset:256 sc1
  buffer_load_dwordx4 v[76:79], v12, s[16:19], s33 offen offset:512 sc1
  s_waitcnt lgkmcnt(0)
  s_waitcnt vmcnt(2)
  v_mfma_f32_16x16x32_bf16 v[80:83], v[28:31], v[68:71], 0
  v_mfma_f32_16x16x32_bf16 v[84:87], v[32:35], v[68:71], 0
  v_mfma_f32_16x16x32_bf16 v[88:91], v[36:39], v[68:71], 0
  v_mfma_f32_16x16x32_bf16 v[92:95], v[40:43], v[68:71], 0
  v_mfma_f32_16x16x32_bf16 v[96:99], v[44:47], v[68:71], 0
  ds_read_b64_tr_b16 v[28:29], v8 offset:640
  ds_read_b64_tr_b16 v[30:31], v8 offset:800
  ds_read_b64_tr_b16 v[32:33], v8 offset:648
  ds_read_b64_tr_b16 v[34:35], v8 offset:808
  ds_read_b64_tr_b16 v[36:37], v8 offset:656
  ds_read_b64_tr_b16 v[38:39], v8 offset:816
  ds_read_b64_tr_b16 v[40:41], v8 offset:664
  ds_read_b64_tr_b16 v[42:43], v8 offset:824
  ds_read_b64_tr_b16 v[44:45], v8 offset:672
  ds_read_b64_tr_b16 v[46:47], v8 offset:832
  s_waitcnt vmcnt(1)
  v_mfma_f32_16x16x32_bf16 v[80:83], v[48:51], v[72:75], v[80:83]
  v_mfma_f32_16x16x32_bf16 v[84:87], v[52:55], v[72:75], v[84:87]
  v_mfma_f32_16x16x32_bf16 v[88:91], v[56:59], v[72:75], v[88:91]
  v_mfma_f32_16x16x32_bf16 v[92:95], v[60:63], v[72:75], v[92:95]
  v_mfma_f32_16x16x32_bf16 v[96:99], v[64:67], v[72:75], v[96:99]
  s_waitcnt vmcnt(0) lgkmcnt(0)
  v_mfma_f32_16x16x32_bf16 v[80:83], v[28:31], v[76:79], v[80:83]
  v_mfma_f32_16x16x32_bf16 v[84:87], v[32:35], v[76:79], v[84:87]
  v_mfma_f32_16x16x32_bf16 v[88:91], v[36:39], v[76:79], v[88:91]
  v_mfma_f32_16x16x32_bf16 v[92:95], v[40:43], v[76:79], v[92:95]
  v_mfma_f32_16x16x32_bf16 v[96:99], v[44:47], v[76:79], v[96:99]
  v_mov_b32 v240, 0x23be0
  s_mov_b32 s7, 4000000
W_15:
  ds_read_b32 v241, v240
  s_waitcnt lgkmcnt(0)
  v_cmp_gt_u32 vcc, 4, v241
  s_nop 0
  s_cbranch_vccz WD_16
  s_sub_u32 s7, s7, 1
  s_cbranch_scc0 W_15
WD_16:
  s_cmp_eq_u32 s59, 0
  s_cbranch_scc1 EW_14
  s_mul_i32 s42, s50, 5
  s_lshr_b32 s42, s42, 2
  s_mul_i32 s43, s42, 80
  s_add_u32 s43, s43, 0xb99000
  v_min_u32 v240, 39, v1
  v_lshlrev_b32 v240, 2, v240
  s_mov_b32 s7, 400000
P_17:
  buffer_load_dword v242, v240, s[16:19], s43 offen offset:0 sc1
  s_waitcnt vmcnt(0)
PE_19:
  v_cmp_ne_u32 vcc, s99, v242
  s_nop 0
  s_cbranch_vccz PD_18
  s_sleep 50
  s_sub_u32 s7, s7, 1
  s_cbranch_scc0 P_17
PD_18:
  s_add_u32 s94, s60, 0
  s_add_u32 m0, s56, 0
  s_nop 0
  buffer_load_dwordx4 v5, s[16:19], s94 offen offset:0 sc1 lds
  buffer_load_dwordx4 v5, s[16:19], s94 offen offset:1024 sc1 lds
  buffer_load_dwordx4 v5, s[16:19], s94 offen offset:2048 sc1 lds
  buffer_load_dwordx4 v5, s[16:19], s94 offen offset:3072 sc1 lds
  s_add_u32 s94, s94, 4096
  s_add_u32 m0, s56, 4096
  s_nop 0
  buffer_load_dwordx4 v5, s[16:19], s94 offen sc1 lds
  s_add_u32 s94, s60, 20480
  s_add_u32 m0, s56, 20480
  s_nop 0
  buffer_load_dwordx4 v5, s[16:19], s94 offen offset:0 sc1 lds
  buffer_load_dwordx4 v5, s[16:19], s94 offen offset:1024 sc1 lds
  buffer_load_dwordx4 v5, s[16:19], s94 offen offset:2048 sc1 lds
  buffer_load_dwordx4 v5, s[16:19], s94 offen offset:3072 sc1 lds
  s_add_u32 s94, s94, 4096
  s_add_u32 m0, s56, 24576
  s_nop 0
  buffer_load_dwordx4 v5, s[16:19], s94 offen sc1 lds
  s_add_u32 s94, s60, 40960
  s_add_u32 m0, s56, 40960
  s_nop 0
  buffer_load_dwordx4 v5, s[16:19], s94 offen offset:0 sc1 lds
  buffer_load_dwordx4 v5, s[16:19], s94 offen offset:1024 sc1 lds
  buffer_load_dwordx4 v5, s[16:19], s94 offen offset:2048 sc1 lds
  buffer_load_dwordx4 v5, s[16:19], s94 offen offset:3072 sc1 lds
  s_add_u32 s94, s94, 4096
  s_add_u32 m0, s56, 45056
  s_nop 0
  buffer_load_dwordx4 v5, s[16:19], s94 offen sc1 lds
EW_14:
  s_mov_b32 s94, 61440
  s_mov_b32 s95, 61440
  s_cmp_eq_u32 s85, 1
  s_cmov_b32 s94, 81920
  s_cmov_b32 s95, 81920
  s_add_u32 s94, s94, s60
  s_add_u32 s95, s95, s56
  s_add_u32 m0, s95, s24
  s_add_u32 s96, s94, s24
  buffer_load_dwordx4 v5, s[16:19], s96 offen sc1 lds
  s_add_u32 m0, s95, s25
  s_add_u32 s96, s94, s25
  buffer_load_dwordx4 v5, s[16:19], s96 offen sc1 lds
  s_add_u32 m0, s95, s26
  s_add_u32 s96, s94, s26
  buffer_load_dwordx4 v5, s[16:19], s96 offen sc1 lds
  s_add_u32 m0, s95, s27
  s_add_u32 s96, s94, s27
  buffer_load_dwordx4 v5, s[16:19], s96 offen sc1 lds
  s_add_u32 m0, s95, s84
  s_add_u32 s96, s94, s84
  buffer_load_dwordx4 v5, s[16:19], s96 offen sc1 lds
  s_mov_b32 s94, 81920
  s_mov_b32 s95, 81920
  s_cmp_eq_u32 s85, 1
  s_cmov_b32 s94, 61440
  s_cmov_b32 s95, 61440
  s_add_u32 s94, s94, s60
  s_add_u32 s95, s95, s56
  s_add_u32 m0, s95, s24
  s_add_u32 s96, s94, s24
  buffer_load_dwordx4 v5, s[16:19], s96 offen sc1 lds
  s_add_u32 m0, s95, s25
  s_add_u32 s96, s94, s25
  buffer_load_dwordx4 v5, s[16:19], s96 offen sc1 lds
  s_add_u32 m0, s95, s26
  s_add_u32 s96, s94, s26
  buffer_load_dwordx4 v5, s[16:19], s96 offen sc1 lds
  s_add_u32 m0, s95, s27
  s_add_u32 s96, s94, s27
  buffer_load_dwordx4 v5, s[16:19], s96 offen sc1 lds
  s_add_u32 m0, s95, s84
  s_add_u32 s96, s94, s84
  buffer_load_dwordx4 v5, s[16:19], s96 offen sc1 lds
  s_lshl_b32 s40, s2, 2
  s_add_u32 s40, s40, s57
  s_add_u32 s40, s40, 600
  s_cmp_ge_u32 s40, 1560
  s_cbranch_scc1 RB_20
  s_mov_b32 s44, 3
  s_mov_b32 s33, 600
  s_mov_b32 s28, s78
  s_mov_b32 s29, s79
  s_cmp_ge_u32 s40, 1080
  s_cmov_b32 s44, 4
  s_cmov_b32 s33, 1080
  s_cmov_b32 s28, s80
  s_cmov_b32 s29, s81
  s_sub_u32 s45, s40, s33
  s_and_b32 s29, s29, 0xffff
  s_mov_b32 s30, 1966080
  s_mov_b32 s31, 0x20000
  s_cmp_eq_u32 s44, 3
  s_mov_b32 s43, 1280
  s_cmov_b32 s43, 3072
  s_cmp_eq_u32 s44, 4
  s_mov_b32 s33, 52429
  s_cmov_b32 s33, 21846
  s_mul_i32 s41, s45, s33
  s_lshr_b32 s41, s41, 20
  s_cmp_eq_u32 s44, 4
  s_cselect_b32 s33, 48, 20
  s_mul_i32 s33, s41, s33
  s_sub_u32 s42, s45, s33
  s_add_u32 s62, s56, 122880
  v_lshrrev_b32 v20, 3, v1
  v_mul_lo_u32 v20, v20, s43
  v_and_b32 v21, 7, v1
  v_lshl_add_u32 v20, v21, 4, v20
  s_mul_i32 s45, s42, s43
  s_lshl_b32 s45, s45, 5
  s_lshl_b32 s33, s41, 7
  s_add_u32 s45, s45, s33
  s_lshl_b32 s34, s43, 3
  s_add_u32 m0, s62, 0
  s_nop 0
  buffer_load_dwordx4 v20, s[28:31], s45 offen nt lds
  s_add_u32 s45, s45, s34
  s_add_u32 m0, s62, 1024
  s_nop 0
  buffer_load_dwordx4 v20, s[28:31], s45 offen nt lds
  s_add_u32 s45, s45, s34
  s_add_u32 m0, s62, 2048
  s_nop 0
  buffer_load_dwordx4 v20, s[28:31], s45 offen nt lds
  s_add_u32 s45, s45, s34
  s_add_u32 m0, s62, 3072
  s_nop 0
  buffer_load_dwordx4 v20, s[28:31], s45 offen nt lds
RB_20:
  v_min_u32 v240, 6, v1
  v_lshlrev_b32 v240, 12, v240
  s_and_b32 s94, s5, 3
  s_lshl_b32 s95, s4, 2
  s_add_u32 s94, s94, s95
  s_lshl_b32 s94, s94, 7
  s_add_u32 s94, s94, 0xb91000
  buffer_load_dword v241, v240, s[16:19], s94 offen sc1
  s_getpc_b64 s[94:95]
L_pc1:
  s_add_u32 s94, s94, L_pc-L_pc1
  s_addc_u32 s95, s95, 0
  s_lshl_b32 s96, s5, 2
  s_add_u32 s96, s96, s57
  s_lshl_b32 s96, s96, 1
  v_and_b32 v242, 1, v1
  v_add_u32 v242, s96, v242
  v_min_u32 v242, (L_end-L_pc)/128, v242
  v_lshlrev_b32 v242, 7, v242
  v_mov_b32 v243, s95
  v_add_co_u32 v242, vcc, s94, v242
  s_nop 1
  v_addc_co_u32 v243, vcc, 0, v243, vcc
  global_load_dword v241, v[242:243], off
  s_mov_b32 s34, 0x3fb8aa3b
  s_mov_b32 s35, 0x3fb8aa3b
  v_max3_f32 v16, v80, v81, v82
  v_min3_f32 v18, v80, v81, v82
  v_max3_f32 v16, v16, v83, v84
  v_min3_f32 v18, v18, v83, v84
  v_max3_f32 v16, v16, v85, v86
  v_min3_f32 v18, v18, v85, v86
  v_max3_f32 v16, v16, v87, v88
  v_min3_f32 v18, v18, v87, v88
  v_max3_f32 v16, v16, v89, v90
  v_min3_f32 v18, v18, v89, v90
  v_max3_f32 v16, v16, v91, v92
  v_min3_f32 v18, v18, v91, v92
  v_max3_f32 v16, v16, v93, v94
  v_min3_f32 v18, v18, v93, v94
  v_max3_f32 v16, v16, v95, v96
  v_min3_f32 v18, v18, v95, v96
  v_max3_f32 v16, v16, v97, v98
  v_min3_f32 v18, v18, v97, v98
  v_max_f32 v16, v16, v99
  v_min_f32 v18, v18, v99
  v_mul_f32 v16, s34, v16
  v_mul_f32 v18, s34, v18
  v_pk_fma_f32 v[28:29], v[80:81], s[34:35], v[16:17] op_sel_hi:[1,1,0] neg_lo:[0,0,1] neg_hi:[0,0,1]
  v_pk_fma_f32 v[48:49], v[80:81], s[34:35], v[18:19] op_sel_hi:[1,1,0] neg_lo:[1,0,0] neg_hi:[1,0,0]
  v_pk_fma_f32 v[30:31], v[82:83], s[34:35], v[16:17] op_sel_hi:[1,1,0] neg_lo:[0,0,1] neg_hi:[0,0,1]
  v_pk_fma_f32 v[50:51], v[82:83], s[34:35], v[18:19] op_sel_hi:[1,1,0] neg_lo:[1,0,0] neg_hi:[1,0,0]
  v_pk_fma_f32 v[32:33], v[84:85], s[34:35], v[16:17] op_sel_hi:[1,1,0] neg_lo:[0,0,1] neg_hi:[0,0,1]
  v_pk_fma_f32 v[52:53], v[84:85], s[34:35], v[18:19] op_sel_hi:[1,1,0] neg_lo:[1,0,0] neg_hi:[1,0,0]
  v_pk_fma_f32 v[34:35], v[86:87], s[34:35], v[16:17] op_sel_hi:[1,1,0] neg_lo:[0,0,1] neg_hi:[0,0,1]
  v_pk_fma_f32 v[54:55], v[86:87], s[34:35], v[18:19] op_sel_hi:[1,1,0] neg_lo:[1,0,0] neg_hi:[1,0,0]
  v_pk_fma_f32 v[36:37], v[88:89], s[34:35], v[16:17] op_sel_hi:[1,1,0] neg_lo:[0,0,1] neg_hi:[0,0,1]
  v_pk_fma_f32 v[56:57], v[88:89], s[34:35], v[18:19] op_sel_hi:[1,1,0] neg_lo:[1,0,0] neg_hi:[1,0,0]
  v_pk_fma_f32 v[38:39], v[90:91], s[34:35], v[16:17] op_sel_hi:[1,1,0] neg_lo:[0,0,1] neg_hi:[0,0,1]
  v_pk_fma_f32 v[58:59], v[90:91], s[34:35], v[18:19] op_sel_hi:[1,1,0] neg_lo:[1,0,0] neg_hi:[1,0,0]
  v_pk_fma_f32 v[40:41], v[92:93], s[34:35], v[16:17] op_sel_hi:[1,1,0] neg_lo:[0,0,1] neg_hi:[0,0,1]
  v_pk_fma_f32 v[60:61], v[92:93], s[34:35], v[18:19] op_sel_hi:[1,1,0] neg_lo:[1,0,0] neg_hi:[1,0,0]
  v_pk_fma_f32 v[42:43], v[94:95], s[34:35], v[16:17] op_sel_hi:[1,1,0] neg_lo:[0,0,1] neg_hi:[0,0,1]
  v_pk_fma_f32 v[62:63], v[94:95], s[34:35], v[18:19] op_sel_hi:[1,1,0] neg_lo:[1,0,0] neg_hi:[1,0,0]
  v_pk_fma_f32 v[44:45], v[96:97], s[34:35], v[16:17] op_sel_hi:[1,1,0] neg_lo:[0,0,1] neg_hi:[0,0,1]
  v_pk_fma_f32 v[64:65], v[96:97], s[34:35], v[18:19] op_sel_hi:[1,1,0] neg_lo:[1,0,0] neg_hi:[1,0,0]
  v_pk_fma_f32 v[46:47], v[98:99], s[34:35], v[16:17] op_sel_hi:[1,1,0] neg_lo:[0,0,1] neg_hi:[0,0,1]
  v_pk_fma_f32 v[66:67], v[98:99], s[34:35], v[18:19] op_sel_hi:[1,1,0] neg_lo:[1,0,0] neg_hi:[1,0,0]
  v_exp_f32 v28, v28
  v_exp_f32 v29, v29
  v_exp_f32 v30, v30
  v_exp_f32 v31, v31
  v_exp_f32 v32, v32
  v_exp_f32 v33, v33
  v_exp_f32 v34, v34
  v_exp_f32 v35, v35
  v_exp_f32 v36, v36
  v_exp_f32 v37, v37
  v_exp_f32 v38, v38
  v_exp_f32 v39, v39
  v_exp_f32 v40, v40
  v_exp_f32 v41, v41
  v_exp_f32 v42, v42
  v_exp_f32 v43, v43
  v_exp_f32 v44, v44
  v_exp_f32 v45, v45
  v_exp_f32 v46, v46
  v_exp_f32 v47, v47
  v_exp_f32 v48, v48
  v_exp_f32 v49, v49
  v_exp_f32 v50, v50
  v_exp_f32 v51, v51
  v_exp_f32 v52, v52
  v_exp_f32 v53, v53
  v_exp_f32 v54, v54
  v_exp_f32 v55, v55
  v_exp_f32 v56, v56
  v_exp_f32 v57, v57
  v_exp_f32 v58, v58
  v_exp_f32 v59, v59
  v_exp_f32 v60, v60
  v_exp_f32 v61, v61
  v_exp_f32 v62, v62
  v_exp_f32 v63, v63
  v_exp_f32 v64, v64
  v_exp_f32 v65, v65
  v_exp_f32 v66, v66
  v_exp_f32 v67, v67
  v_pk_add_f32 v[16:17], v[28:29], v[30:31]
  v_pk_add_f32 v[18:19], v[48:49], v[50:51]
  v_pk_add_f32 v[16:17], v[16:17], v[32:33]
  v_pk_add_f32 v[18:19], v[18:19], v[52:53]
  v_pk_add_f32 v[16:17], v[16:17], v[34:35]
  v_pk_add_f32 v[18:19], v[18:19], v[54:55]
  v_pk_add_f32 v[16:17], v[16:17], v[36:37]
  v_pk_add_f32 v[18:19], v[18:19], v[56:57]
  v_pk_add_f32 v[16:17], v[16:17], v[38:39]
  v_pk_add_f32 v[18:19], v[18:19], v[58:59]
  v_pk_add_f32 v[16:17], v[16:17], v[40:41]
  v_pk_add_f32 v[18:19], v[18:19], v[60:61]
  v_pk_add_f32 v[16:17], v[16:17], v[42:43]
  v_pk_add_f32 v[18:19], v[18:19], v[62:63]
  v_pk_add_f32 v[16:17], v[16:17], v[44:45]
  v_pk_add_f32 v[18:19], v[18:19], v[64:65]
  v_pk_add_f32 v[16:17], v[16:17], v[46:47]
  v_pk_add_f32 v[18:19], v[18:19], v[66:67]
  v_add_f32 v16, v16, v17
  v_add_f32 v18, v18, v19
  v_rcp_f32 v16, v16
  v_rcp_f32 v18, v18
  v_pk_mul_f32 v[28:29], v[28:29], v[16:17] op_sel_hi:[1,0]
  v_pk_mul_f32 v[30:31], v[30:31], v[16:17] op_sel_hi:[1,0]
  v_pk_mul_f32 v[32:33], v[32:33], v[16:17] op_sel_hi:[1,0]
  v_pk_mul_f32 v[34:35], v[34:35], v[16:17] op_sel_hi:[1,0]
  v_pk_mul_f32 v[36:37], v[36:37], v[16:17] op_sel_hi:[1,0]
  v_pk_mul_f32 v[38:39], v[38:39], v[16:17] op_sel_hi:[1,0]
  v_pk_mul_f32 v[40:41], v[40:41], v[16:17] op_sel_hi:[1,0]
  v_pk_mul_f32 v[42:43], v[42:43], v[16:17] op_sel_hi:[1,0]
  v_pk_mul_f32 v[44:45], v[44:45], v[16:17] op_sel_hi:[1,0]
  v_pk_mul_f32 v[46:47], v[46:47], v[16:17] op_sel_hi:[1,0]
  v_pk_mul_f32 v[48:49], v[48:49], v[18:19] op_sel_hi:[1,0]
  v_pk_mul_f32 v[50:51], v[50:51], v[18:19] op_sel_hi:[1,0]
  v_pk_mul_f32 v[52:53], v[52:53], v[18:19] op_sel_hi:[1,0]
  v_pk_mul_f32 v[54:55], v[54:55], v[18:19] op_sel_hi:[1,0]
  v_pk_mul_f32 v[56:57], v[56:57], v[18:19] op_sel_hi:[1,0]
  v_pk_mul_f32 v[58:59], v[58:59], v[18:19] op_sel_hi:[1,0]
  v_pk_mul_f32 v[60:61], v[60:61], v[18:19] op_sel_hi:[1,0]
  v_pk_mul_f32 v[62:63], v[62:63], v[18:19] op_sel_hi:[1,0]
  v_pk_mul_f32 v[64:65], v[64:65], v[18:19] op_sel_hi:[1,0]
  v_pk_mul_f32 v[66:67], v[66:67], v[18:19] op_sel_hi:[1,0]
  v_cvt_pk_bf16_f32 v80, v28, v29
  v_cvt_pk_bf16_f32 v81, v30, v31
  v_cvt_pk_bf16_f32 v82, v32, v33
  v_cvt_pk_bf16_f32 v83, v34, v35
  v_cvt_pk_bf16_f32 v84, v36, v37
  v_cvt_pk_bf16_f32 v85, v38, v39
  v_cvt_pk_bf16_f32 v86, v40, v41
  v_cvt_pk_bf16_f32 v87, v42, v43
  v_cvt_pk_bf16_f32 v88, v44, v45
  v_cvt_pk_bf16_f32 v89, v46, v47
  v_cvt_pk_bf16_f32 v90, v48, v49
  v_cvt_pk_bf16_f32 v91, v50, v51
  v_cvt_pk_bf16_f32 v92, v52, v53
  v_cvt_pk_bf16_f32 v93, v54, v55
  v_cvt_pk_bf16_f32 v94, v56, v57
  v_cvt_pk_bf16_f32 v95, v58, v59
  v_cvt_pk_bf16_f32 v96, v60, v61
  v_cvt_pk_bf16_f32 v97, v62, v63
  v_cvt_pk_bf16_f32 v98, v64, v65
  v_cvt_pk_bf16_f32 v99, v66, v67
  s_cmp_lt_u32 s2, 240
  s_cbranch_scc1 NW_21
  s_waitcnt vmcnt(2)
NW_21:
  s_waitcnt vmcnt(6)
  v_mul_u32_u24 v8, 48, v6
  v_add_u32 v8, 0x23c00, v8
  v_mov_b32 v9, 0x23000
  v_cmp_eq_u32 vcc, v7, v2
  s_nop 1
  v_cndmask_b32 v8, v9, v8, vcc
  v_mul_u32_u24 v12, 20480, v2
  v_lshl_add_u32 v12, v3, 4, v12
  v_mov_b32 v13, 0
  s_mul_i32 s33, s49, 81920
  s_lshl_b32 s34, s58, 8
  s_add_u32 s33, s33, s34
  s_add_u32 s33, s33, 0x0
  s_lshl_b32 s34, s49, 5
  s_add_u32 s34, s34, s5
  s_lshl_b32 s34, s34, 2
  s_add_u32 s34, s34, 0xb91000
  s_barrier
  s_setprio 1
  ds_read_b64_tr_b16 v[28:29], v8 offset:0
  ds_read_b64_tr_b16 v[30:31], v8 offset:192
  ds_read_b64_tr_b16 v[32:33], v8 offset:8
  ds_read_b64_tr_b16 v[34:35], v8 offset:200
  ds_read_b64_tr_b16 v[36:37], v8 offset:16
  ds_read_b64_tr_b16 v[38:39], v8 offset:208
  ds_read_b64_tr_b16 v[40:41], v8 offset:24
  ds_read_b64_tr_b16 v[42:43], v8 offset:216
  ds_read_b64_tr_b16 v[44:45], v8 offset:32
  ds_read_b64_tr_b16 v[46:47], v8 offset:224
  ds_read_b64_tr_b16 v[48:49], v8 offset:40
  ds_read_b64_tr_b16 v[50:51], v8 offset:232
  ds_read_b64_tr_b16 v[52:53], v8 offset:384
  ds_read_b64_tr_b16 v[54:55], v8 offset:576
  s_waitcnt lgkmcnt(12)
  v_mfma_f32_16x16x32_bf16 v[56:59], v[28:31], v[80:83], 0
  ds_read_b64_tr_b16 v[28:29], v8 offset:392
  ds_read_b64_tr_b16 v[30:31], v8 offset:584
  s_waitcnt lgkmcnt(12)
  v_mfma_f32_16x16x32_bf16 v[60:63], v[32:35], v[80:83], 0
  ds_read_b64_tr_b16 v[32:33], v8 offset:400
  ds_read_b64_tr_b16 v[34:35], v8 offset:592
  s_waitcnt lgkmcnt(12)
  v_mfma_f32_16x16x32_bf16 v[64:67], v[36:39], v[80:83], 0
  ds_read_b64_tr_b16 v[36:37], v8 offset:408
  ds_read_b64_tr_b16 v[38:39], v8 offset:600
  s_waitcnt lgkmcnt(12)
  v_mfma_f32_16x16x32_bf16 v[68:71], v[40:43], v[80:83], 0
  ds_read_b64_tr_b16 v[40:41], v8 offset:416
  ds_read_b64_tr_b16 v[42:43], v8 offset:608
  s_waitcnt lgkmcnt(12)
  v_mfma_f32_16x16x32_bf16 v[72:75], v[44:47], v[80:83], 0
  ds_read_b64_tr_b16 v[44:45], v8 offset:424
  ds_read_b64_tr_b16 v[46:47], v8 offset:616
  s_waitcnt lgkmcnt(12)
  v_mfma_f32_16x16x32_bf16 v[76:79], v[48:51], v[80:83], 0
  ds_read_b64_tr_b16 v[48:49], v8 offset:768
  ds_read_b64_tr_b16 v[50:51], v8 offset:960
  s_waitcnt lgkmcnt(12)
  v_mfma_f32_16x16x32_bf16 v[56:59], v[52:55], v[84:87], v[56:59]
  ds_read_b64_tr_b16 v[52:53], v8 offset:776
  ds_read_b64_tr_b16 v[54:55], v8 offset:968
  s_waitcnt lgkmcnt(12)
  v_mfma_f32_16x16x32_bf16 v[60:63], v[28:31], v[84:87], v[60:63]
  ds_read_b64_tr_b16 v[28:29], v8 offset:784
  ds_read_b64_tr_b16 v[30:31], v8 offset:976
  s_waitcnt lgkmcnt(12)
  v_mfma_f32_16x16x32_bf16 v[64:67], v[32:35], v[84:87], v[64:67]
  ds_read_b64_tr_b16 v[32:33], v8 offset:792
  ds_read_b64_tr_b16 v[34:35], v8 offset:984
  s_waitcnt lgkmcnt(12)
  v_mfma_f32_16x16x32_bf16 v[68:71], v[36:39], v[84:87], v[68:71]
  ds_read_b64_tr_b16 v[36:37], v8 offset:800
  ds_read_b64_tr_b16 v[38:39], v8 offset:992
  s_waitcnt lgkmcnt(12)
  v_mfma_f32_16x16x32_bf16 v[72:75], v[40:43], v[84:87], v[72:75]
  ds_read_b64_tr_b16 v[40:41], v8 offset:808
  ds_read_b64_tr_b16 v[42:43], v8 offset:1000
  s_waitcnt lgkmcnt(12)
  v_mfma_f32_16x16x32_bf16 v[76:79], v[44:47], v[84:87], v[76:79]
  ds_read_b64_tr_b16 v[44:45], v8 offset:1152
  ds_read_b64_tr_b16 v[46:47], v8 offset:1344
  s_waitcnt lgkmcnt(12)
  v_mfma_f32_16x16x32_bf16 v[56:59], v[48:51], v[88:91], v[56:59]
  ds_read_b64_tr_b16 v[48:49], v8 offset:1160
  ds_read_b64_tr_b16 v[50:51], v8 offset:1352
  s_waitcnt lgkmcnt(12)
  v_mfma_f32_16x16x32_bf16 v[60:63], v[52:55], v[88:91], v[60:63]
  ds_read_b64_tr_b16 v[52:53], v8 offset:1168
  ds_read_b64_tr_b16 v[54:55], v8 offset:1360
  s_waitcnt lgkmcnt(12)
  v_mfma_f32_16x16x32_bf16 v[64:67], v[28:31], v[88:91], v[64:67]
  ds_read_b64_tr_b16 v[28:29], v8 offset:1176
  ds_read_b64_tr_b16 v[30:31], v8 offset:1368
  s_waitcnt lgkmcnt(12)
  v_mfma_f32_16x16x32_bf16 v[68:71], v[32:35], v[88:91], v[68:71]
  ds_read_b64_tr_b16 v[32:33], v8 offset:1184
  ds_read_b64_tr_b16 v[34:35], v8 offset:1376
  s_waitcnt lgkmcnt(12)
  v_mfma_f32_16x16x32_bf16 v[72:75], v[36:39], v[88:91], v[72:75]
  ds_read_b64_tr_b16 v[36:37], v8 offset:1192
  ds_read_b64_tr_b16 v[38:39], v8 offset:1384
  s_waitcnt lgkmcnt(12)
  v_mfma_f32_16x16x32_bf16 v[76:79], v[40:43], v[88:91], v[76:79]
  ds_read_b64_tr_b16 v[40:41], v8 offset:1536
  ds_read_b64_tr_b16 v[42:43], v8 offset:1728
  s_waitcnt lgkmcnt(12)
  v_mfma_f32_16x16x32_bf16 v[56:59], v[44:47], v[92:95], v[56:59]
  ds_read_b64_tr_b16 v[44:45], v8 offset:1544
  ds_read_b64_tr_b16 v[46:47], v8 offset:1736
  s_waitcnt lgkmcnt(12)
  v_mfma_f32_16x16x32_bf16 v[60:63], v[48:51], v[92:95], v[60:63]
  ds_read_b64_tr_b16 v[48:49], v8 offset:1552
  ds_read_b64_tr_b16 v[50:51], v8 offset:1744
  s_waitcnt lgkmcnt(12)
  v_mfma_f32_16x16x32_bf16 v[64:67], v[52:55], v[92:95], v[64:67]
  ds_read_b64_tr_b16 v[52:53], v8 offset:1560
  ds_read_b64_tr_b16 v[54:55], v8 offset:1752
  s_waitcnt lgkmcnt(12)
  v_mfma_f32_16x16x32_bf16 v[68:71], v[28:31], v[92:95], v[68:71]
  ds_read_b64_tr_b16 v[28:29], v8 offset:1568
  ds_read_b64_tr_b16 v[30:31], v8 offset:1760
  s_waitcnt lgkmcnt(12)
  v_mfma_f32_16x16x32_bf16 v[72:75], v[32:35], v[92:95], v[72:75]
  ds_read_b64_tr_b16 v[32:33], v8 offset:1576
  ds_read_b64_tr_b16 v[34:35], v8 offset:1768
  s_waitcnt lgkmcnt(12)
  v_mfma_f32_16x16x32_bf16 v[76:79], v[36:39], v[92:95], v[76:79]
  s_waitcnt lgkmcnt(10)
  v_mfma_f32_16x16x32_bf16 v[56:59], v[40:43], v[96:99], v[56:59]
  s_waitcnt lgkmcnt(8)
  v_mfma_f32_16x16x32_bf16 v[60:63], v[44:47], v[96:99], v[60:63]
  s_waitcnt lgkmcnt(6)
  v_mfma_f32_16x16x32_bf16 v[64:67], v[48:51], v[96:99], v[64:67]
  s_waitcnt lgkmcnt(4)
  v_mfma_f32_16x16x32_bf16 v[68:71], v[52:55], v[96:99], v[68:71]
  s_waitcnt lgkmcnt(2)
  v_mfma_f32_16x16x32_bf16 v[72:75], v[28:31], v[96:99], v[72:75]
  s_waitcnt lgkmcnt(0)
  v_mfma_f32_16x16x32_bf16 v[76:79], v[32:35], v[96:99], v[76:79]
  s_nop 7
  v_add_f32 v16, 0x358637bd, v76
  v_rcp_f32 v16, v16
  s_nop 0
  v_pk_mul_f32 v[56:57], v[56:57], v[16:17] op_sel_hi:[1,0]
  v_pk_mul_f32 v[58:59], v[58:59], v[16:17] op_sel_hi:[1,0]
  v_pk_mul_f32 v[60:61], v[60:61], v[16:17] op_sel_hi:[1,0]
  v_pk_mul_f32 v[62:63], v[62:63], v[16:17] op_sel_hi:[1,0]
  v_pk_mul_f32 v[64:65], v[64:65], v[16:17] op_sel_hi:[1,0]
  v_pk_mul_f32 v[66:67], v[66:67], v[16:17] op_sel_hi:[1,0]
  v_pk_mul_f32 v[68:69], v[68:69], v[16:17] op_sel_hi:[1,0]
  v_pk_mul_f32 v[70:71], v[70:71], v[16:17] op_sel_hi:[1,0]
  v_pk_mul_f32 v[72:73], v[72:73], v[16:17] op_sel_hi:[1,0]
  v_pk_mul_f32 v[74:75], v[74:75], v[16:17] op_sel_hi:[1,0]
  v_cvt_pk_bf16_f32 v20, v56, v57
  v_cvt_pk_bf16_f32 v21, v58, v59
  v_cvt_pk_bf16_f32 v22, v60, v61
  v_cvt_pk_bf16_f32 v23, v62, v63
  v_cvt_pk_bf16_f32 v24, v64, v65
  v_cvt_pk_bf16_f32 v25, v66, v67
  v_cvt_pk_bf16_f32 v26, v68, v69
  v_cvt_pk_bf16_f32 v27, v70, v71
  v_cvt_pk_bf16_f32 v28, v72, v73
  v_cvt_pk_bf16_f32 v29, v74, v75
  s_cmp_eq_u32 s6, 0
  s_cbranch_scc1 SL_22
  s_cmp_eq_u32 s48, 1
  s_cbranch_scc1 OD_24
  buffer_store_dwordx4 v[20:23], v12, s[16:19], s33 offen
  buffer_store_dwordx4 v[24:27], v12, s[16:19], s33 offen offset:256
  buffer_store_dwordx2 v[28:29], v12, s[16:19], s33 offen offset:512
  s_branch DN_25
OD_24:
  buffer_store_dwordx2 v[20:21], v12, s[16:19], s33 offen offset:8
  buffer_store_dwordx4 v[22:25], v12, s[16:19], s33 offen offset:256
  buffer_store_dwordx4 v[26:29], v12, s[16:19], s33 offen offset:512
DN_25:
  s_waitcnt vmcnt(0)
  s_mov_b64 exec, 1
  buffer_store_dword v252, v13, s[16:19], s34 offen
  s_mov_b64 exec, -1
  s_branch SE_23
SL_22:
  s_nop 1
  s_cmp_eq_u32 s48, 1
  s_cbranch_scc1 OD_26
  buffer_store_dwordx4 v[20:23], v12, s[16:19], s33 offen sc1
  buffer_store_dwordx4 v[24:27], v12, s[16:19], s33 offen offset:256 sc1
  buffer_store_dwordx2 v[28:29], v12, s[16:19], s33 offen offset:512 sc1
  s_branch DN_27
OD_26:
  buffer_store_dwordx2 v[20:21], v12, s[16:19], s33 offen offset:8 sc1
  buffer_store_dwordx4 v[22:25], v12, s[16:19], s33 offen offset:256 sc1
  buffer_store_dwordx4 v[26:29], v12, s[16:19], s33 offen offset:512 sc1
DN_27:
  s_waitcnt vmcnt(0)
  s_mov_b64 exec, 1
  buffer_store_dword v252, v13, s[16:19], s34 offen sc1
  s_mov_b64 exec, -1
SE_23:
  s_setprio 0
  s_lshl_b32 s40, s2, 2
  s_add_u32 s40, s40, s57
  s_add_u32 s40, s40, 600
  s_cmp_ge_u32 s40, 1560
  s_cbranch_scc1 RB_28
  s_mov_b32 s44, 3
  s_mov_b32 s33, 600
  s_mov_b32 s28, s78
  s_mov_b32 s29, s79
  s_cmp_ge_u32 s40, 1080
  s_cmov_b32 s44, 4
  s_cmov_b32 s33, 1080
  s_cmov_b32 s28, s80
  s_cmov_b32 s29, s81
  s_sub_u32 s45, s40, s33
  s_and_b32 s29, s29, 0xffff
  s_mov_b32 s30, 1966080
  s_mov_b32 s31, 0x20000
  s_cmp_eq_u32 s44, 3
  s_mov_b32 s43, 1280
  s_cmov_b32 s43, 3072
  s_cmp_eq_u32 s44, 4
  s_mov_b32 s33, 52429
  s_cmov_b32 s33, 21846
  s_mul_i32 s41, s45, s33
  s_lshr_b32 s41, s41, 20
  s_cmp_eq_u32 s44, 4
  s_cselect_b32 s33, 48, 20
  s_mul_i32 s33, s41, s33
  s_sub_u32 s42, s45, s33
  v_mov_b32 v124, 0x3f803f80
  v_mov_b32 v125, 0x3f803f80
  v_mov_b32 v126, 0x3f803f80
  v_mov_b32 v127, 0x3f803f80
  v_lshlrev_b32 v128, 4, v1
  v_lshlrev_b32 v129, 4, v2
  v_bfe_u32 v130, v1, 2, 2
  v_lshl_add_u32 v130, v2, 3, v130
  v_lshlrev_b32 v130, 7, v130
  v_and_b32 v131, 3, v1
  v_lshl_add_u32 v130, v131, 3, v130
  s_waitcnt vmcnt(0)
  v_add_u32 v131, s62, v130
  s_cmp_eq_u32 s44, 4
  s_cselect_b32 s94, 512, 0
  s_mov_b32 s95, 512
  s_cmov_b32 s95, 2048
  v_mul_u32_u24 v132, s94, v2
  v_sub_u32 v131, v131, v132
  v_add_u32 v132, s95, v131
  ds_read_b64_tr_b16 v[136:137], v131 offset:0
  ds_read_b64_tr_b16 v[138:139], v132 offset:0
  ds_read_b64_tr_b16 v[140:141], v131 offset:32
  ds_read_b64_tr_b16 v[142:143], v132 offset:32
  ds_read_b64_tr_b16 v[144:145], v131 offset:64
  ds_read_b64_tr_b16 v[146:147], v132 offset:64
  ds_read_b64_tr_b16 v[148:149], v131 offset:96
  ds_read_b64_tr_b16 v[150:151], v132 offset:96
  s_cmp_eq_u32 s44, 3
  s_cbranch_scc1 W3_29
  s_mul_i32 s45, s42, 43
  s_lshr_b32 s45, s45, 8
  s_mul_i32 s33, s45, 6
  s_sub_u32 s33, s42, s33
  s_mov_b32 s37, s45
  s_mov_b32 s45, 0
  s_lshl_b32 s45, s45, 1
  s_and_b32 s36, s33, 1
  s_add_u32 s45, s45, s36
  s_lshr_b32 s33, s33, 1
  s_lshl_b32 s33, s33, 4
  s_add_u32 s45, s45, s33
  s_mul_i32 s36, s45, 5120
  s_add_u32 s36, s36, 0xc87000
  s_lshl_b32 s34, s41, 2
  s_add_u32 s34, s34, 0
  s_mul_i32 s45, s34, 52
  s_lshr_b32 s45, s45, 8
  s_mul_i32 s33, s45, 5
  s_sub_u32 s33, s34, s33
  s_and_b32 s34, s45, 1
  s_sub_u32 s33, s33, s34
  s_cmp_lt_i32 s33, 0
  s_cselect_b32 s33, 4, s33
  s_mul_i32 s34, s45, 798720
  s_lshl_b32 s35, s33, 10
  s_add_u32 s34, s34, s35
  s_add_u32 s46, s34, s36
  s_sub_u32 s34, s37, s45
  s_and_b32 s34, s34, 7
  s_mul_i32 s34, s34, 10240
  s_add_u32 s46, s46, s34
  s_lshl_b32 s34, s41, 2
  s_add_u32 s34, s34, 1
  s_mul_i32 s45, s34, 52
  s_lshr_b32 s45, s45, 8
  s_mul_i32 s33, s45, 5
  s_sub_u32 s33, s34, s33
  s_and_b32 s34, s45, 1
  s_sub_u32 s33, s33, s34
  s_cmp_lt_i32 s33, 0
  s_cselect_b32 s33, 4, s33
  s_mul_i32 s34, s45, 798720
  s_lshl_b32 s35, s33, 10
  s_add_u32 s34, s34, s35
  s_add_u32 s47, s34, s36
  s_sub_u32 s34, s37, s45
  s_and_b32 s34, s34, 7
  s_mul_i32 s34, s34, 10240
  s_add_u32 s47, s47, s34
  s_lshl_b32 s34, s41, 2
  s_add_u32 s34, s34, 2
  s_mul_i32 s45, s34, 52
  s_lshr_b32 s45, s45, 8
  s_mul_i32 s33, s45, 5
  s_sub_u32 s33, s34, s33
  s_and_b32 s34, s45, 1
  s_sub_u32 s33, s33, s34
  s_cmp_lt_i32 s33, 0
  s_cselect_b32 s33, 4, s33
  s_mul_i32 s34, s45, 798720
  s_lshl_b32 s35, s33, 10
  s_add_u32 s34, s34, s35
  s_add_u32 s92, s34, s36
  s_sub_u32 s34, s37, s45
  s_and_b32 s34, s34, 7
  s_mul_i32 s34, s34, 10240
  s_add_u32 s92, s92, s34
  s_lshl_b32 s34, s41, 2
  s_add_u32 s34, s34, 3
  s_mul_i32 s45, s34, 52
  s_lshr_b32 s45, s45, 8
  s_mul_i32 s33, s45, 5
  s_sub_u32 s33, s34, s33
  s_and_b32 s34, s45, 1
  s_sub_u32 s33, s33, s34
  s_cmp_lt_i32 s33, 0
  s_cselect_b32 s33, 4, s33
  s_mul_i32 s34, s45, 798720
  s_lshl_b32 s35, s33, 10
  s_add_u32 s34, s34, s35
  s_add_u32 s93, s34, s36
  s_sub_u32 s34, s37, s45
  s_and_b32 s34, s34, 7
  s_mul_i32 s34, s34, 10240
  s_add_u32 s93, s93, s34
  s_branch DN_30
W3_29:
  s_mul_i32 s45, s41, 43
  s_lshr_b32 s45, s45, 7
  s_mul_i32 s33, s45, 3
  s_sub_u32 s33, s41, s33
  s_mul_i32 s34, s45, 798720
  s_mul_i32 s33, s33, 81920
  s_add_u32 s34, s34, s33
  s_lshl_b32 s33, s42, 11
  s_add_u32 s34, s34, s33
  s_add_u32 s46, s34, 0xc4b000
  s_add_u32 s47, s46, 1024
  s_add_u32 s92, s46, 40960
  s_add_u32 s93, s46, 41984
  s_mul_i32 s34, s42, 6144
  s_lshl_b32 s33, s41, 8
  s_add_u32 s34, s34, s33
  s_add_u32 s38, s34, 0x1310000
  s_add_u32 s39, s38, 64
  s_add_u32 s88, s38, 128
  s_add_u32 s89, s38, 192
DN_30:
  s_waitcnt lgkmcnt(0)
RB_28:
  s_lshl_b32 s40, s2, 2
  s_add_u32 s40, s40, s57
  s_add_u32 s40, s40, 600
  s_cmp_ge_u32 s40, 1560
  s_cbranch_scc1 RB_31
  buffer_store_dwordx4 v[136:139], v128, s[16:19], s46 offen sc1
  buffer_store_dwordx4 v[140:143], v128, s[16:19], s47 offen sc1
  buffer_store_dwordx4 v[144:147], v128, s[16:19], s92 offen sc1
  buffer_store_dwordx4 v[148:151], v128, s[16:19], s93 offen sc1
  s_bitcmp1_b32 s44, 0
  s_cbranch_scc0 NC_32
  v_mfma_f32_16x16x32_bf16 v[152:155], v[136:139], v[124:127], 0
  v_mfma_f32_16x16x32_bf16 v[156:159], v[140:143], v[124:127], 0
  v_mfma_f32_16x16x32_bf16 v[160:163], v[144:147], v[124:127], 0
  v_mfma_f32_16x16x32_bf16 v[164:167], v[148:151], v[124:127], 0
  s_mov_b32 exec_lo, 0x00010001
  s_mov_b32 exec_hi, 0x00010001
  s_nop 2
  buffer_store_dwordx4 v[152:155], v129, s[16:19], s38 offen sc1
  buffer_store_dwordx4 v[156:159], v129, s[16:19], s39 offen sc1
  buffer_store_dwordx4 v[160:163], v129, s[16:19], s88 offen sc1
  buffer_store_dwordx4 v[164:167], v129, s[16:19], s89 offen sc1
  s_mov_b64 exec, -1
NC_32:
  s_nop 1
RB_31:
  s_lshl_b32 s94, s3, 2
  s_add_u32 s94, s94, 146368
  v_mov_b32 v15, s94
  v_mov_b32 v248, 0x23bc0
  s_mov_b32 s7, 2000000
W_33:
  ds_read_b128 v[240:243], v248
  s_waitcnt lgkmcnt(0)
  v_min3_u32 v240, v240, v241, v242
  v_min_u32 v240, v240, v243
  v_cmp_gt_u32 vcc, 1, v240
  s_nop 0
  s_cbranch_vccz WD_34
  s_sleep 1
  s_sub_u32 s7, s7, 1
  s_cbranch_scc0 W_33
WD_34:
  s_mov_b32 s94, 122880
  s_mov_b32 s95, 122880
  s_add_u32 s94, s94, s60
  s_add_u32 s95, s95, s56
  s_add_u32 m0, s95, s24
  s_add_u32 s96, s94, s24
  buffer_load_dwordx4 v5, s[16:19], s96 offen sc1 lds
  s_add_u32 m0, s95, s25
  s_add_u32 s96, s94, s25
  buffer_load_dwordx4 v5, s[16:19], s96 offen sc1 lds
  s_add_u32 m0, s95, s26
  s_add_u32 s96, s94, s26
  buffer_load_dwordx4 v5, s[16:19], s96 offen sc1 lds
  s_add_u32 m0, s95, s27
  s_add_u32 s96, s94, s27
  buffer_load_dwordx4 v5, s[16:19], s96 offen sc1 lds
  s_add_u32 m0, s95, s84
  s_add_u32 s96, s94, s84
  buffer_load_dwordx4 v5, s[16:19], s96 offen sc1 lds
  s_waitcnt vmcnt(5)
  s_lshl_b32 s40, s2, 2
  s_add_u32 s40, s40, s57
  s_add_u32 s40, s40, 600
  s_cmp_ge_u32 s40, 1560
  s_cbranch_scc1 RB_35
  s_lshl_b32 s94, s40, 2
  s_add_u32 s94, s94, 0xb99000
  v_mov_b32 v20, 0
  s_mov_b64 exec, 1
  buffer_store_dword v252, v20, s[16:19], s94 offen sc1
  s_mov_b64 exec, -1
RB_35:
  v_mov_b32 v248, 0x23bc0
  s_mov_b32 s7, 2000000
W_36:
  ds_read_b128 v[240:243], v248
  s_waitcnt lgkmcnt(0)
  v_min3_u32 v240, v240, v241, v242
  v_min_u32 v240, v240, v243
  v_cmp_gt_u32 vcc, 2, v240
  s_nop 0
  s_cbranch_vccz WD_37
  s_sleep 1
  s_sub_u32 s7, s7, 1
  s_cbranch_scc0 W_36
WD_37:
  s_mov_b32 s94, 143360
  s_mov_b32 s95, 0
  s_cmp_eq_u32 s72, 1
  s_cmov_b32 s94, 163840
  s_cmov_b32 s95, 20480
  s_cmp_eq_u32 s72, 2
  s_cmov_b32 s94, 184320
  s_cmov_b32 s95, 40960
  s_add_u32 s94, s94, s60
  s_add_u32 s95, s95, s56
  s_add_u32 m0, s95, s24
  s_add_u32 s96, s94, s24
  buffer_load_dwordx4 v5, s[16:19], s96 offen sc1 lds
  s_add_u32 m0, s95, s25
  s_add_u32 s96, s94, s25
  buffer_load_dwordx4 v5, s[16:19], s96 offen sc1 lds
  s_add_u32 m0, s95, s26
  s_add_u32 s96, s94, s26
  buffer_load_dwordx4 v5, s[16:19], s96 offen sc1 lds
  s_add_u32 m0, s95, s27
  s_add_u32 s96, s94, s27
  buffer_load_dwordx4 v5, s[16:19], s96 offen sc1 lds
  s_add_u32 m0, s95, s84
  s_add_u32 s96, s94, s84
  buffer_load_dwordx4 v5, s[16:19], s96 offen sc1 lds
  s_mov_b32 s94, 163840
  s_mov_b32 s95, 20480
  s_cmp_eq_u32 s72, 1
  s_cmov_b32 s94, 184320
  s_cmov_b32 s95, 40960
  s_cmp_eq_u32 s72, 2
  s_cmov_b32 s94, 143360
  s_cmov_b32 s95, 0
  s_add_u32 s94, s94, s60
  s_add_u32 s95, s95, s56
  s_add_u32 m0, s95, s24
  s_add_u32 s96, s94, s24
  buffer_load_dwordx4 v5, s[16:19], s96 offen sc1 lds
  s_add_u32 m0, s95, s25
  s_add_u32 s96, s94, s25
  buffer_load_dwordx4 v5, s[16:19], s96 offen sc1 lds
  s_add_u32 m0, s95, s26
  s_add_u32 s96, s94, s26
  buffer_load_dwordx4 v5, s[16:19], s96 offen sc1 lds
  s_add_u32 m0, s95, s27
  s_add_u32 s96, s94, s27
  buffer_load_dwordx4 v5, s[16:19], s96 offen sc1 lds
  s_add_u32 m0, s95, s84
  s_add_u32 s96, s94, s84
  buffer_load_dwordx4 v5, s[16:19], s96 offen sc1 lds
  s_mov_b32 s94, 184320
  s_mov_b32 s95, 40960
  s_cmp_eq_u32 s72, 1
  s_cmov_b32 s94, 143360
  s_cmov_b32 s95, 0
  s_cmp_eq_u32 s72, 2
  s_cmov_b32 s94, 163840
  s_cmov_b32 s95, 20480
  s_add_u32 s94, s94, s60
  s_add_u32 s95, s95, s56
  s_add_u32 m0, s95, s24
  s_add_u32 s96, s94, s24
  buffer_load_dwordx4 v5, s[16:19], s96 offen sc1 lds
  s_add_u32 m0, s95, s25
  s_add_u32 s96, s94, s25
  buffer_load_dwordx4 v5, s[16:19], s96 offen sc1 lds
  s_add_u32 m0, s95, s26
  s_add_u32 s96, s94, s26
  buffer_load_dwordx4 v5, s[16:19], s96 offen sc1 lds
  s_add_u32 m0, s95, s27
  s_add_u32 s96, s94, s27
  buffer_load_dwordx4 v5, s[16:19], s96 offen sc1 lds
  s_add_u32 m0, s95, s84
  s_add_u32 s96, s94, s84
  buffer_load_dwordx4 v5, s[16:19], s96 offen sc1 lds
  s_waitcnt vmcnt(0)
  v_mov_b32 v16, 10
  ds_write_b32 v15, v16
  v_mov_b32 v248, 0x23bc0
  s_mov_b32 s7, 2000000
W_38:
  ds_read_b128 v[240:243], v248
  s_waitcnt lgkmcnt(0)
  v_min3_u32 v240, v240, v241, v242
  v_min_u32 v240, v240, v243
  v_cmp_gt_u32 vcc, 4, v240
  s_nop 0
  s_cbranch_vccz WD_39
  s_sleep 1
  s_sub_u32 s7, s7, 1
  s_cbranch_scc0 W_38
WD_39:
  s_mov_b32 s94, 204800
  s_mov_b32 s95, 61440
  s_cmp_eq_u32 s85, 1
  s_cmov_b32 s94, 225280
  s_cmov_b32 s95, 81920
  s_add_u32 s94, s94, s60
  s_add_u32 s95, s95, s56
  s_add_u32 m0, s95, s24
  s_add_u32 s96, s94, s24
  buffer_load_dwordx4 v5, s[16:19], s96 offen sc1 lds
  s_add_u32 m0, s95, s25
  s_add_u32 s96, s94, s25
  buffer_load_dwordx4 v5, s[16:19], s96 offen sc1 lds
  s_add_u32 m0, s95, s26
  s_add_u32 s96, s94, s26
  buffer_load_dwordx4 v5, s[16:19], s96 offen sc1 lds
  s_add_u32 m0, s95, s27
  s_add_u32 s96, s94, s27
  buffer_load_dwordx4 v5, s[16:19], s96 offen sc1 lds
  s_add_u32 m0, s95, s84
  s_add_u32 s96, s94, s84
  buffer_load_dwordx4 v5, s[16:19], s96 offen sc1 lds
  s_mov_b32 s94, 225280
  s_mov_b32 s95, 81920
  s_cmp_eq_u32 s85, 1
  s_cmov_b32 s94, 204800
  s_cmov_b32 s95, 61440
  s_add_u32 s94, s94, s60
  s_add_u32 s95, s95, s56
  s_add_u32 m0, s95, s24
  s_add_u32 s96, s94, s24
  buffer_load_dwordx4 v5, s[16:19], s96 offen sc1 lds
  s_add_u32 m0, s95, s25
  s_add_u32 s96, s94, s25
  buffer_load_dwordx4 v5, s[16:19], s96 offen sc1 lds
  s_add_u32 m0, s95, s26
  s_add_u32 s96, s94, s26
  buffer_load_dwordx4 v5, s[16:19], s96 offen sc1 lds
  s_add_u32 m0, s95, s27
  s_add_u32 s96, s94, s27
  buffer_load_dwordx4 v5, s[16:19], s96 offen sc1 lds
  s_add_u32 m0, s95, s84
  s_add_u32 s96, s94, s84
  buffer_load_dwordx4 v5, s[16:19], s96 offen sc1 lds
  v_mov_b32 v248, 0x23bc0
  s_mov_b32 s7, 2000000
W_40:
  ds_read_b128 v[240:243], v248
  s_waitcnt lgkmcnt(0)
  v_min3_u32 v240, v240, v241, v242
  v_min_u32 v240, v240, v243
  v_cmp_gt_u32 vcc, 5, v240
  s_nop 0
  s_cbranch_vccz WD_41
  s_sleep 1
  s_sub_u32 s7, s7, 1
  s_cbranch_scc0 W_40
WD_41:
  s_mov_b32 s94, 245760
  s_mov_b32 s95, 102400
  s_cmp_eq_u32 s72, 1
  s_cmov_b32 s94, 266240
  s_cmov_b32 s95, 122880
  s_cmp_eq_u32 s72, 2
  s_cmov_b32 s94, 286720
  s_cmov_b32 s95, 0
  s_add_u32 s94, s94, s60
  s_add_u32 s95, s95, s56
  s_add_u32 m0, s95, s24
  s_add_u32 s96, s94, s24
  buffer_load_dwordx4 v5, s[16:19], s96 offen sc1 lds
  s_add_u32 m0, s95, s25
  s_add_u32 s96, s94, s25
  buffer_load_dwordx4 v5, s[16:19], s96 offen sc1 lds
  s_add_u32 m0, s95, s26
  s_add_u32 s96, s94, s26
  buffer_load_dwordx4 v5, s[16:19], s96 offen sc1 lds
  s_add_u32 m0, s95, s27
  s_add_u32 s96, s94, s27
  buffer_load_dwordx4 v5, s[16:19], s96 offen sc1 lds
  s_add_u32 m0, s95, s84
  s_add_u32 s96, s94, s84
  buffer_load_dwordx4 v5, s[16:19], s96 offen sc1 lds
  s_mov_b32 s94, 266240
  s_mov_b32 s95, 122880
  s_cmp_eq_u32 s72, 1
  s_cmov_b32 s94, 286720
  s_cmov_b32 s95, 0
  s_cmp_eq_u32 s72, 2
  s_cmov_b32 s94, 245760
  s_cmov_b32 s95, 102400
  s_add_u32 s94, s94, s60
  s_add_u32 s95, s95, s56
  s_add_u32 m0, s95, s24
  s_add_u32 s96, s94, s24
  buffer_load_dwordx4 v5, s[16:19], s96 offen sc1 lds
  s_add_u32 m0, s95, s25
  s_add_u32 s96, s94, s25
  buffer_load_dwordx4 v5, s[16:19], s96 offen sc1 lds
  s_add_u32 m0, s95, s26
  s_add_u32 s96, s94, s26
  buffer_load_dwordx4 v5, s[16:19], s96 offen sc1 lds
  s_add_u32 m0, s95, s27
  s_add_u32 s96, s94, s27
  buffer_load_dwordx4 v5, s[16:19], s96 offen sc1 lds
  s_add_u32 m0, s95, s84
  s_add_u32 s96, s94, s84
  buffer_load_dwordx4 v5, s[16:19], s96 offen sc1 lds
  s_mov_b32 s94, 286720
  s_mov_b32 s95, 0
  s_cmp_eq_u32 s72, 1
  s_cmov_b32 s94, 245760
  s_cmov_b32 s95, 102400
  s_cmp_eq_u32 s72, 2
  s_cmov_b32 s94, 266240
  s_cmov_b32 s95, 122880
  s_add_u32 s94, s94, s60
  s_add_u32 s95, s95, s56
  s_add_u32 m0, s95, s24
  s_add_u32 s96, s94, s24
  buffer_load_dwordx4 v5, s[16:19], s96 offen sc1 lds
  s_add_u32 m0, s95, s25
  s_add_u32 s96, s94, s25
  buffer_load_dwordx4 v5, s[16:19], s96 offen sc1 lds
  s_add_u32 m0, s95, s26
  s_add_u32 s96, s94, s26
  buffer_load_dwordx4 v5, s[16:19], s96 offen sc1 lds
  s_add_u32 m0, s95, s27
  s_add_u32 s96, s94, s27
  buffer_load_dwordx4 v5, s[16:19], s96 offen sc1 lds
  s_add_u32 m0, s95, s84
  s_add_u32 s96, s94, s84
  buffer_load_dwordx4 v5, s[16:19], s96 offen sc1 lds
  s_waitcnt vmcnt(0)
  v_mov_b32 v16, 15
  ds_write_b32 v15, v16
  s_mul_i32 s42, s50, 5
  s_lshr_b32 s42, s42, 2
  s_mul_i32 s44, s50, 240
  s_add_u32 s44, s44, 0xb99960
  s_mul_i32 s45, s42, 192
  s_add_u32 s45, s45, 0xb9a0e0
  v_min_u32 v31, 59, v1
  v_lshlrev_b32 v31, 2, v31
  v_min_u32 v30, 47, v1
  v_lshlrev_b32 v30, 3, v30
  s_mov_b32 s7, 400000
P_42:
  buffer_load_dword v34, v31, s[16:19], s44 offen sc1
  buffer_load_dwordx2 v[32:33], v30, s[16:19], s45 offen sc1
  s_waitcnt vmcnt(0)
PE_44:
  v_xor_b32 v32, s99, v32
  v_xor_b32 v33, s99, v33
  v_xor_b32 v34, s99, v34
  v_or3_b32 v32, v32, v33, v34
  v_cmp_ne_u32 vcc, 0, v32
  s_nop 0
  s_cbranch_vccz PD_43
  s_sleep 50
  s_sub_u32 s7, s7, 1
  s_cbranch_scc0 P_42
PD_43:
  v_mov_b32 v248, 0x23bc0
  s_mov_b32 s7, 2000000
W_45:
  ds_read_b128 v[240:243], v248
  s_waitcnt lgkmcnt(0)
  v_min3_u32 v240, v240, v241, v242
  v_min_u32 v240, v240, v243
  v_cmp_gt_u32 vcc, 7, v240
  s_nop 0
  s_cbranch_vccz WD_46
  s_sleep 1
  s_sub_u32 s7, s7, 1
  s_cbranch_scc0 W_45
WD_46:
  s_mov_b32 s94, 307200
  s_mov_b32 s95, 20480
  s_cmp_eq_u32 s85, 1
  s_cmov_b32 s94, 327680
  s_cmov_b32 s95, 40960
  s_add_u32 s94, s94, s60
  s_add_u32 s95, s95, s56
  s_add_u32 m0, s95, s24
  s_add_u32 s96, s94, s24
  buffer_load_dwordx4 v5, s[16:19], s96 offen sc1 lds
  s_add_u32 m0, s95, s25
  s_add_u32 s96, s94, s25
  buffer_load_dwordx4 v5, s[16:19], s96 offen sc1 lds
  s_add_u32 m0, s95, s26
  s_add_u32 s96, s94, s26
  buffer_load_dwordx4 v5, s[16:19], s96 offen sc1 lds
  s_add_u32 m0, s95, s27
  s_add_u32 s96, s94, s27
  buffer_load_dwordx4 v5, s[16:19], s96 offen sc1 lds
  s_add_u32 m0, s95, s84
  s_add_u32 s96, s94, s84
  buffer_load_dwordx4 v5, s[16:19], s96 offen sc1 lds
  s_mov_b32 s94, 327680
  s_mov_b32 s95, 40960
  s_cmp_eq_u32 s85, 1
  s_cmov_b32 s94, 307200
  s_cmov_b32 s95, 20480
  s_add_u32 s94, s94, s60
  s_add_u32 s95, s95, s56
  s_add_u32 m0, s95, s24
  s_add_u32 s96, s94, s24
  buffer_load_dwordx4 v5, s[16:19], s96 offen sc1 lds
  s_add_u32 m0, s95, s25
  s_add_u32 s96, s94, s25
  buffer_load_dwordx4 v5, s[16:19], s96 offen sc1 lds
  s_add_u32 m0, s95, s26
  s_add_u32 s96, s94, s26
  buffer_load_dwordx4 v5, s[16:19], s96 offen sc1 lds
  s_add_u32 m0, s95, s27
  s_add_u32 s96, s94, s27
  buffer_load_dwordx4 v5, s[16:19], s96 offen sc1 lds
  s_add_u32 m0, s95, s84
  s_add_u32 s96, s94, s84
  buffer_load_dwordx4 v5, s[16:19], s96 offen sc1 lds
  v_mov_b32 v248, 0x23bc0
  s_mov_b32 s7, 2000000
W_47:
  ds_read_b128 v[240:243], v248
  s_waitcnt lgkmcnt(0)
  v_min3_u32 v240, v240, v241, v242
  v_min_u32 v240, v240, v243
  v_cmp_gt_u32 vcc, 8, v240
  s_nop 0
  s_cbranch_vccz WD_48
  s_sleep 1
  s_sub_u32 s7, s7, 1
  s_cbranch_scc0 W_47
WD_48:
  s_mov_b32 s94, 348160
  s_mov_b32 s95, 61440
  s_cmp_eq_u32 s72, 1
  s_cmov_b32 s94, 368640
  s_cmov_b32 s95, 81920
  s_cmp_eq_u32 s72, 2
  s_cmov_b32 s94, 389120
  s_cmov_b32 s95, 102400
  s_add_u32 s94, s94, s60
  s_add_u32 s95, s95, s56
  s_add_u32 m0, s95, s24
  s_add_u32 s96, s94, s24
  buffer_load_dwordx4 v5, s[16:19], s96 offen sc1 lds
  s_add_u32 m0, s95, s25
  s_add_u32 s96, s94, s25
  buffer_load_dwordx4 v5, s[16:19], s96 offen sc1 lds
  s_add_u32 m0, s95, s26
  s_add_u32 s96, s94, s26
  buffer_load_dwordx4 v5, s[16:19], s96 offen sc1 lds
  s_add_u32 m0, s95, s27
  s_add_u32 s96, s94, s27
  buffer_load_dwordx4 v5, s[16:19], s96 offen sc1 lds
  s_add_u32 m0, s95, s84
  s_add_u32 s96, s94, s84
  buffer_load_dwordx4 v5, s[16:19], s96 offen sc1 lds
  s_mov_b32 s94, 368640
  s_mov_b32 s95, 81920
  s_cmp_eq_u32 s72, 1
  s_cmov_b32 s94, 389120
  s_cmov_b32 s95, 102400
  s_cmp_eq_u32 s72, 2
  s_cmov_b32 s94, 348160
  s_cmov_b32 s95, 61440
  s_add_u32 s94, s94, s60
  s_add_u32 s95, s95, s56
  s_add_u32 m0, s95, s24
  s_add_u32 s96, s94, s24
  buffer_load_dwordx4 v5, s[16:19], s96 offen sc1 lds
  s_add_u32 m0, s95, s25
  s_add_u32 s96, s94, s25
  buffer_load_dwordx4 v5, s[16:19], s96 offen sc1 lds
  s_add_u32 m0, s95, s26
  s_add_u32 s96, s94, s26
  buffer_load_dwordx4 v5, s[16:19], s96 offen sc1 lds
  s_add_u32 m0, s95, s27
  s_add_u32 s96, s94, s27
  buffer_load_dwordx4 v5, s[16:19], s96 offen sc1 lds
  s_add_u32 m0, s95, s84
  s_add_u32 s96, s94, s84
  buffer_load_dwordx4 v5, s[16:19], s96 offen sc1 lds
  s_mov_b32 s94, 389120
  s_mov_b32 s95, 102400
  s_cmp_eq_u32 s72, 1
  s_cmov_b32 s94, 348160
  s_cmov_b32 s95, 61440
  s_cmp_eq_u32 s72, 2
  s_cmov_b32 s94, 368640
  s_cmov_b32 s95, 81920
  s_add_u32 s94, s94, s60
  s_add_u32 s95, s95, s56
  s_add_u32 m0, s95, s24
  s_add_u32 s96, s94, s24
  buffer_load_dwordx4 v5, s[16:19], s96 offen sc1 lds
  s_add_u32 m0, s95, s25
  s_add_u32 s96, s94, s25
  buffer_load_dwordx4 v5, s[16:19], s96 offen sc1 lds
  s_add_u32 m0, s95, s26
  s_add_u32 s96, s94, s26
  buffer_load_dwordx4 v5, s[16:19], s96 offen sc1 lds
  s_add_u32 m0, s95, s27
  s_add_u32 s96, s94, s27
  buffer_load_dwordx4 v5, s[16:19], s96 offen sc1 lds
  s_add_u32 m0, s95, s84
  s_add_u32 s96, s94, s84
  buffer_load_dwordx4 v5, s[16:19], s96 offen sc1 lds
  s_lshl_b32 s32, s57, 6
  v_add_u32 v30, s32, v1
  v_min_u32 v30, 191, v30
  v_lshlrev_b32 v30, 2, v30
  s_mul_i32 s32, s50, 768
  s_add_u32 s32, s32, 0x1310000
  buffer_load_dword v32, v30, s[16:19], s32 offen sc1
  s_add_u32 s32, s32, 6144
  buffer_load_dword v33, v30, s[16:19], s32 offen sc1
  s_add_u32 s32, s32, 6144
  buffer_load_dword v34, v30, s[16:19], s32 offen sc1
  s_add_u32 s32, s32, 6144
  buffer_load_dword v35, v30, s[16:19], s32 offen sc1
  s_add_u32 s32, s32, 6144
  buffer_load_dword v36, v30, s[16:19], s32 offen sc1
  s_add_u32 s32, s32, 6144
  buffer_load_dword v37, v30, s[16:19], s32 offen sc1
  s_add_u32 s32, s32, 6144
  buffer_load_dword v38, v30, s[16:19], s32 offen sc1
  s_add_u32 s32, s32, 6144
  buffer_load_dword v39, v30, s[16:19], s32 offen sc1
  s_add_u32 s32, s32, 6144
  buffer_load_dword v40, v30, s[16:19], s32 offen sc1
  s_add_u32 s32, s32, 6144
  buffer_load_dword v41, v30, s[16:19], s32 offen sc1
  s_add_u32 s32, s32, 6144
  buffer_load_dword v42, v30, s[16:19], s32 offen sc1
  s_add_u32 s32, s32, 6144
  buffer_load_dword v43, v30, s[16:19], s32 offen sc1
  s_add_u32 s32, s32, 6144
  buffer_load_dword v44, v30, s[16:19], s32 offen sc1
  s_add_u32 s32, s32, 6144
  buffer_load_dword v45, v30, s[16:19], s32 offen sc1
  s_add_u32 s32, s32, 6144
  buffer_load_dword v46, v30, s[16:19], s32 offen sc1
  s_add_u32 s32, s32, 6144
  buffer_load_dword v47, v30, s[16:19], s32 offen sc1
  s_add_u32 s32, s32, 6144
  buffer_load_dword v48, v30, s[16:19], s32 offen sc1
  s_add_u32 s32, s32, 6144
  buffer_load_dword v49, v30, s[16:19], s32 offen sc1
  s_add_u32 s32, s32, 6144
  buffer_load_dword v50, v30, s[16:19], s32 offen sc1
  s_add_u32 s32, s32, 6144
  buffer_load_dword v51, v30, s[16:19], s32 offen sc1
  s_waitcnt vmcnt(35)
  v_mov_b32 v16, 17
  ds_write_b32 v15, v16
  s_waitcnt vmcnt(0)
  v_add_f32 v32, v32, v33
  v_add_f32 v32, v32, v34
  v_add_f32 v32, v32, v35
  v_add_f32 v32, v32, v36
  v_add_f32 v32, v32, v37
  v_add_f32 v32, v32, v38
  v_add_f32 v32, v32, v39
  v_add_f32 v32, v32, v40
  v_add_f32 v32, v32, v41
  v_add_f32 v32, v32, v42
  v_add_f32 v32, v32, v43
  v_add_f32 v32, v32, v44
  v_add_f32 v32, v32, v45
  v_add_f32 v32, v32, v46
  v_add_f32 v32, v32, v47
  v_add_f32 v32, v32, v48
  v_add_f32 v32, v32, v49
  v_add_f32 v32, v32, v50
  v_add_f32 v32, v32, v51
  v_add_u32 v30, 0x27a00, v30
  ds_write_b32 v30, v32
  s_waitcnt lgkmcnt(0)
  s_barrier
  s_mov_b32 s94, 409600
  s_mov_b32 s95, 122880
  s_cmp_eq_u32 s85, 1
  s_cmov_b32 s94, 430080
  s_cmov_b32 s95, 0
  s_add_u32 s94, s94, s60
  s_add_u32 s95, s95, s56
  s_add_u32 m0, s95, s24
  s_add_u32 s96, s94, s24
  buffer_load_dwordx4 v5, s[16:19], s96 offen sc1 lds
  s_add_u32 m0, s95, s25
  s_add_u32 s96, s94, s25
  buffer_load_dwordx4 v5, s[16:19], s96 offen sc1 lds
  s_add_u32 m0, s95, s26
  s_add_u32 s96, s94, s26
  buffer_load_dwordx4 v5, s[16:19], s96 offen sc1 lds
  s_add_u32 m0, s95, s27
  s_add_u32 s96, s94, s27
  buffer_load_dwordx4 v5, s[16:19], s96 offen sc1 lds
  s_add_u32 m0, s95, s84
  s_add_u32 s96, s94, s84
  buffer_load_dwordx4 v5, s[16:19], s96 offen sc1 lds
  s_mov_b32 s94, 430080
  s_mov_b32 s95, 0
  s_cmp_eq_u32 s85, 1
  s_cmov_b32 s94, 409600
  s_cmov_b32 s95, 122880
  s_add_u32 s94, s94, s60
  s_add_u32 s95, s95, s56
  s_add_u32 m0, s95, s24
  s_add_u32 s96, s94, s24
  buffer_load_dwordx4 v5, s[16:19], s96 offen sc1 lds
  s_add_u32 m0, s95, s25
  s_add_u32 s96, s94, s25
  buffer_load_dwordx4 v5, s[16:19], s96 offen sc1 lds
  s_add_u32 m0, s95, s26
  s_add_u32 s96, s94, s26
  buffer_load_dwordx4 v5, s[16:19], s96 offen sc1 lds
  s_add_u32 m0, s95, s27
  s_add_u32 s96, s94, s27
  buffer_load_dwordx4 v5, s[16:19], s96 offen sc1 lds
  s_add_u32 m0, s95, s84
  s_add_u32 s96, s94, s84
  buffer_load_dwordx4 v5, s[16:19], s96 offen sc1 lds
  s_barrier
  s_mov_b32 s94, 450560
  s_mov_b32 s95, 20480
  s_cmp_eq_u32 s85, 1
  s_cmov_b32 s94, 471040
  s_cmov_b32 s95, 40960
  s_add_u32 s94, s94, s60
  s_add_u32 s95, s95, s56
  s_add_u32 m0, s95, s24
  s_add_u32 s96, s94, s24
  buffer_load_dwordx4 v5, s[16:19], s96 offen sc1 lds
  s_add_u32 m0, s95, s25
  s_add_u32 s96, s94, s25
  buffer_load_dwordx4 v5, s[16:19], s96 offen sc1 lds
  s_add_u32 m0, s95, s26
  s_add_u32 s96, s94, s26
  buffer_load_dwordx4 v5, s[16:19], s96 offen sc1 lds
  s_add_u32 m0, s95, s27
  s_add_u32 s96, s94, s27
  buffer_load_dwordx4 v5, s[16:19], s96 offen sc1 lds
  s_add_u32 m0, s95, s84
  s_add_u32 s96, s94, s84
  buffer_load_dwordx4 v5, s[16:19], s96 offen sc1 lds
  s_mov_b32 s94, 471040
  s_mov_b32 s95, 40960
  s_cmp_eq_u32 s85, 1
  s_cmov_b32 s94, 450560
  s_cmov_b32 s95, 20480
  s_add_u32 s94, s94, s60
  s_add_u32 s95, s95, s56
  s_add_u32 m0, s95, s24
  s_add_u32 s96, s94, s24
  buffer_load_dwordx4 v5, s[16:19], s96 offen sc1 lds
  s_add_u32 m0, s95, s25
  s_add_u32 s96, s94, s25
  buffer_load_dwordx4 v5, s[16:19], s96 offen sc1 lds
  s_add_u32 m0, s95, s26
  s_add_u32 s96, s94, s26
  buffer_load_dwordx4 v5, s[16:19], s96 offen sc1 lds
  s_add_u32 m0, s95, s27
  s_add_u32 s96, s94, s27
  buffer_load_dwordx4 v5, s[16:19], s96 offen sc1 lds
  s_add_u32 m0, s95, s84
  s_add_u32 s96, s94, s84
  buffer_load_dwordx4 v5, s[16:19], s96 offen sc1 lds
  s_waitcnt vmcnt(10)
  s_barrier
  s_mov_b32 s94, 491520
  s_mov_b32 s95, 61440
  s_cmp_eq_u32 s85, 1
  s_cmov_b32 s94, 512000
  s_cmov_b32 s95, 81920
  s_add_u32 s94, s94, s60
  s_add_u32 s95, s95, s56
  s_add_u32 m0, s95, s24
  s_add_u32 s96, s94, s24
  buffer_load_dwordx4 v5, s[16:19], s96 offen sc1 lds
  s_add_u32 m0, s95, s25
  s_add_u32 s96, s94, s25
  buffer_load_dwordx4 v5, s[16:19], s96 offen sc1 lds
  s_add_u32 m0, s95, s26
  s_add_u32 s96, s94, s26
  buffer_load_dwordx4 v5, s[16:19], s96 offen sc1 lds
  s_add_u32 m0, s95, s27
  s_add_u32 s96, s94, s27
  buffer_load_dwordx4 v5, s[16:19], s96 offen sc1 lds
  s_add_u32 m0, s95, s84
  s_add_u32 s96, s94, s84
  buffer_load_dwordx4 v5, s[16:19], s96 offen sc1 lds
  s_mov_b32 s94, 512000
  s_mov_b32 s95, 81920
  s_cmp_eq_u32 s85, 1
  s_cmov_b32 s94, 491520
  s_cmov_b32 s95, 61440
  s_add_u32 s94, s94, s60
  s_add_u32 s95, s95, s56
  s_add_u32 m0, s95, s24
  s_add_u32 s96, s94, s24
  buffer_load_dwordx4 v5, s[16:19], s96 offen sc1 lds
  s_add_u32 m0, s95, s25
  s_add_u32 s96, s94, s25
  buffer_load_dwordx4 v5, s[16:19], s96 offen sc1 lds
  s_add_u32 m0, s95, s26
  s_add_u32 s96, s94, s26
  buffer_load_dwordx4 v5, s[16:19], s96 offen sc1 lds
  s_add_u32 m0, s95, s27
  s_add_u32 s96, s94, s27
  buffer_load_dwordx4 v5, s[16:19], s96 offen sc1 lds
  s_add_u32 m0, s95, s84
  s_add_u32 s96, s94, s84
  buffer_load_dwordx4 v5, s[16:19], s96 offen sc1 lds
  s_waitcnt vmcnt(10)
  s_barrier
  s_mov_b32 s94, 532480
  s_mov_b32 s95, 102400
  s_cmp_eq_u32 s85, 1
  s_cmov_b32 s94, 552960
  s_cmov_b32 s95, 122880
  s_add_u32 s94, s94, s60
  s_add_u32 s95, s95, s56
  s_add_u32 m0, s95, s24
  s_add_u32 s96, s94, s24
  buffer_load_dwordx4 v5, s[16:19], s96 offen sc1 lds
  s_add_u32 m0, s95, s25
  s_add_u32 s96, s94, s25
  buffer_load_dwordx4 v5, s[16:19], s96 offen sc1 lds
  s_add_u32 m0, s95, s26
  s_add_u32 s96, s94, s26
  buffer_load_dwordx4 v5, s[16:19], s96 offen sc1 lds
  s_add_u32 m0, s95, s27
  s_add_u32 s96, s94, s27
  buffer_load_dwordx4 v5, s[16:19], s96 offen sc1 lds
  s_add_u32 m0, s95, s84
  s_add_u32 s96, s94, s84
  buffer_load_dwordx4 v5, s[16:19], s96 offen sc1 lds
  s_mov_b32 s94, 552960
  s_mov_b32 s95, 122880
  s_cmp_eq_u32 s85, 1
  s_cmov_b32 s94, 532480
  s_cmov_b32 s95, 102400
  s_add_u32 s94, s94, s60
  s_add_u32 s95, s95, s56
  s_add_u32 m0, s95, s24
  s_add_u32 s96, s94, s24
  buffer_load_dwordx4 v5, s[16:19], s96 offen sc1 lds
  s_add_u32 m0, s95, s25
  s_add_u32 s96, s94, s25
  buffer_load_dwordx4 v5, s[16:19], s96 offen sc1 lds
  s_add_u32 m0, s95, s26
  s_add_u32 s96, s94, s26
  buffer_load_dwordx4 v5, s[16:19], s96 offen sc1 lds
  s_add_u32 m0, s95, s27
  s_add_u32 s96, s94, s27
  buffer_load_dwordx4 v5, s[16:19], s96 offen sc1 lds
  s_add_u32 m0, s95, s84
  s_add_u32 s96, s94, s84
  buffer_load_dwordx4 v5, s[16:19], s96 offen sc1 lds
  s_waitcnt vmcnt(10)
  s_barrier
  s_mov_b32 s94, 573440
  s_mov_b32 s95, 0
  s_cmp_eq_u32 s85, 1
  s_cmov_b32 s94, 593920
  s_cmov_b32 s95, 20480
  s_add_u32 s94, s94, s60
  s_add_u32 s95, s95, s56
  s_add_u32 m0, s95, s24
  s_add_u32 s96, s94, s24
  buffer_load_dwordx4 v5, s[16:19], s96 offen sc1 lds
  s_add_u32 m0, s95, s25
  s_add_u32 s96, s94, s25
  buffer_load_dwordx4 v5, s[16:19], s96 offen sc1 lds
  s_add_u32 m0, s95, s26
  s_add_u32 s96, s94, s26
  buffer_load_dwordx4 v5, s[16:19], s96 offen sc1 lds
  s_add_u32 m0, s95, s27
  s_add_u32 s96, s94, s27
  buffer_load_dwordx4 v5, s[16:19], s96 offen sc1 lds
  s_add_u32 m0, s95, s84
  s_add_u32 s96, s94, s84
  buffer_load_dwordx4 v5, s[16:19], s96 offen sc1 lds
  s_mov_b32 s94, 593920
  s_mov_b32 s95, 20480
  s_cmp_eq_u32 s85, 1
  s_cmov_b32 s94, 573440
  s_cmov_b32 s95, 0
  s_add_u32 s94, s94, s60
  s_add_u32 s95, s95, s56
  s_add_u32 m0, s95, s24
  s_add_u32 s96, s94, s24
  buffer_load_dwordx4 v5, s[16:19], s96 offen sc1 lds
  s_add_u32 m0, s95, s25
  s_add_u32 s96, s94, s25
  buffer_load_dwordx4 v5, s[16:19], s96 offen sc1 lds
  s_add_u32 m0, s95, s26
  s_add_u32 s96, s94, s26
  buffer_load_dwordx4 v5, s[16:19], s96 offen sc1 lds
  s_add_u32 m0, s95, s27
  s_add_u32 s96, s94, s27
  buffer_load_dwordx4 v5, s[16:19], s96 offen sc1 lds
  s_add_u32 m0, s95, s84
  s_add_u32 s96, s94, s84
  buffer_load_dwordx4 v5, s[16:19], s96 offen sc1 lds
  s_waitcnt vmcnt(10)
  s_barrier
  s_mov_b32 s94, 614400
  s_mov_b32 s95, 40960
  s_cmp_eq_u32 s85, 1
  s_cmov_b32 s94, 634880
  s_cmov_b32 s95, 61440
  s_add_u32 s94, s94, s60
  s_add_u32 s95, s95, s56
  s_add_u32 m0, s95, s24
  s_add_u32 s96, s94, s24
  buffer_load_dwordx4 v5, s[16:19], s96 offen sc1 lds
  s_add_u32 m0, s95, s25
  s_add_u32 s96, s94, s25
  buffer_load_dwordx4 v5, s[16:19], s96 offen sc1 lds
  s_add_u32 m0, s95, s26
  s_add_u32 s96, s94, s26
  buffer_load_dwordx4 v5, s[16:19], s96 offen sc1 lds
  s_add_u32 m0, s95, s27
  s_add_u32 s96, s94, s27
  buffer_load_dwordx4 v5, s[16:19], s96 offen sc1 lds
  s_add_u32 m0, s95, s84
  s_add_u32 s96, s94, s84
  buffer_load_dwordx4 v5, s[16:19], s96 offen sc1 lds
  s_mov_b32 s94, 634880
  s_mov_b32 s95, 61440
  s_cmp_eq_u32 s85, 1
  s_cmov_b32 s94, 614400
  s_cmov_b32 s95, 40960
  s_add_u32 s94, s94, s60
  s_add_u32 s95, s95, s56
  s_add_u32 m0, s95, s24
  s_add_u32 s96, s94, s24
  buffer_load_dwordx4 v5, s[16:19], s96 offen sc1 lds
  s_add_u32 m0, s95, s25
  s_add_u32 s96, s94, s25
  buffer_load_dwordx4 v5, s[16:19], s96 offen sc1 lds
  s_add_u32 m0, s95, s26
  s_add_u32 s96, s94, s26
  buffer_load_dwordx4 v5, s[16:19], s96 offen sc1 lds
  s_add_u32 m0, s95, s27
  s_add_u32 s96, s94, s27
  buffer_load_dwordx4 v5, s[16:19], s96 offen sc1 lds
  s_add_u32 m0, s95, s84
  s_add_u32 s96, s94, s84
  buffer_load_dwordx4 v5, s[16:19], s96 offen sc1 lds
  s_waitcnt vmcnt(10)
  s_barrier
  s_mov_b32 s94, 655360
  s_mov_b32 s95, 81920
  s_cmp_eq_u32 s85, 1
  s_cmov_b32 s94, 675840
  s_cmov_b32 s95, 102400
  s_add_u32 s94, s94, s60
  s_add_u32 s95, s95, s56
  s_add_u32 m0, s95, s24
  s_add_u32 s96, s94, s24
  buffer_load_dwordx4 v5, s[16:19], s96 offen sc1 lds
  s_add_u32 m0, s95, s25
  s_add_u32 s96, s94, s25
  buffer_load_dwordx4 v5, s[16:19], s96 offen sc1 lds
  s_add_u32 m0, s95, s26
  s_add_u32 s96, s94, s26
  buffer_load_dwordx4 v5, s[16:19], s96 offen sc1 lds
  s_add_u32 m0, s95, s27
  s_add_u32 s96, s94, s27
  buffer_load_dwordx4 v5, s[16:19], s96 offen sc1 lds
  s_add_u32 m0, s95, s84
  s_add_u32 s96, s94, s84
  buffer_load_dwordx4 v5, s[16:19], s96 offen sc1 lds
  s_mov_b32 s94, 675840
  s_mov_b32 s95, 102400
  s_cmp_eq_u32 s85, 1
  s_cmov_b32 s94, 655360
  s_cmov_b32 s95, 81920
  s_add_u32 s94, s94, s60
  s_add_u32 s95, s95, s56
  s_add_u32 m0, s95, s24
  s_add_u32 s96, s94, s24
  buffer_load_dwordx4 v5, s[16:19], s96 offen sc1 lds
  s_add_u32 m0, s95, s25
  s_add_u32 s96, s94, s25
  buffer_load_dwordx4 v5, s[16:19], s96 offen sc1 lds
  s_add_u32 m0, s95, s26
  s_add_u32 s96, s94, s26
  buffer_load_dwordx4 v5, s[16:19], s96 offen sc1 lds
  s_add_u32 m0, s95, s27
  s_add_u32 s96, s94, s27
  buffer_load_dwordx4 v5, s[16:19], s96 offen sc1 lds
  s_add_u32 m0, s95, s84
  s_add_u32 s96, s94, s84
  buffer_load_dwordx4 v5, s[16:19], s96 offen sc1 lds
  s_waitcnt vmcnt(10)
  s_barrier
  s_mov_b32 s94, 696320
  s_mov_b32 s95, 122880
  s_cmp_eq_u32 s85, 1
  s_cmov_b32 s94, 716800
  s_cmov_b32 s95, 0
  s_add_u32 s94, s94, s60
  s_add_u32 s95, s95, s56
  s_add_u32 m0, s95, s24
  s_add_u32 s96, s94, s24
  buffer_load_dwordx4 v5, s[16:19], s96 offen sc1 lds
  s_add_u32 m0, s95, s25
  s_add_u32 s96, s94, s25
  buffer_load_dwordx4 v5, s[16:19], s96 offen sc1 lds
  s_add_u32 m0, s95, s26
  s_add_u32 s96, s94, s26
  buffer_load_dwordx4 v5, s[16:19], s96 offen sc1 lds
  s_add_u32 m0, s95, s27
  s_add_u32 s96, s94, s27
  buffer_load_dwordx4 v5, s[16:19], s96 offen sc1 lds
  s_add_u32 m0, s95, s84
  s_add_u32 s96, s94, s84
  buffer_load_dwordx4 v5, s[16:19], s96 offen sc1 lds
  s_mov_b32 s94, 716800
  s_mov_b32 s95, 0
  s_cmp_eq_u32 s85, 1
  s_cmov_b32 s94, 696320
  s_cmov_b32 s95, 122880
  s_add_u32 s94, s94, s60
  s_add_u32 s95, s95, s56
  s_add_u32 m0, s95, s24
  s_add_u32 s96, s94, s24
  buffer_load_dwordx4 v5, s[16:19], s96 offen sc1 lds
  s_add_u32 m0, s95, s25
  s_add_u32 s96, s94, s25
  buffer_load_dwordx4 v5, s[16:19], s96 offen sc1 lds
  s_add_u32 m0, s95, s26
  s_add_u32 s96, s94, s26
  buffer_load_dwordx4 v5, s[16:19], s96 offen sc1 lds
  s_add_u32 m0, s95, s27
  s_add_u32 s96, s94, s27
  buffer_load_dwordx4 v5, s[16:19], s96 offen sc1 lds
  s_add_u32 m0, s95, s84
  s_add_u32 s96, s94, s84
  buffer_load_dwordx4 v5, s[16:19], s96 offen sc1 lds
  s_waitcnt vmcnt(10)
  s_barrier
  s_mov_b32 s94, 737280
  s_mov_b32 s95, 20480
  s_cmp_eq_u32 s85, 1
  s_cmov_b32 s94, 757760
  s_cmov_b32 s95, 40960
  s_add_u32 s94, s94, s60
  s_add_u32 s95, s95, s56
  s_add_u32 m0, s95, s24
  s_add_u32 s96, s94, s24
  buffer_load_dwordx4 v5, s[16:19], s96 offen sc1 lds
  s_add_u32 m0, s95, s25
  s_add_u32 s96, s94, s25
  buffer_load_dwordx4 v5, s[16:19], s96 offen sc1 lds
  s_add_u32 m0, s95, s26
  s_add_u32 s96, s94, s26
  buffer_load_dwordx4 v5, s[16:19], s96 offen sc1 lds
  s_add_u32 m0, s95, s27
  s_add_u32 s96, s94, s27
  buffer_load_dwordx4 v5, s[16:19], s96 offen sc1 lds
  s_add_u32 m0, s95, s84
  s_add_u32 s96, s94, s84
  buffer_load_dwordx4 v5, s[16:19], s96 offen sc1 lds
  s_mov_b32 s94, 757760
  s_mov_b32 s95, 40960
  s_cmp_eq_u32 s85, 1
  s_cmov_b32 s94, 737280
  s_cmov_b32 s95, 20480
  s_add_u32 s94, s94, s60
  s_add_u32 s95, s95, s56
  s_add_u32 m0, s95, s24
  s_add_u32 s96, s94, s24
  buffer_load_dwordx4 v5, s[16:19], s96 offen sc1 lds
  s_add_u32 m0, s95, s25
  s_add_u32 s96, s94, s25
  buffer_load_dwordx4 v5, s[16:19], s96 offen sc1 lds
  s_add_u32 m0, s95, s26
  s_add_u32 s96, s94, s26
  buffer_load_dwordx4 v5, s[16:19], s96 offen sc1 lds
  s_add_u32 m0, s95, s27
  s_add_u32 s96, s94, s27
  buffer_load_dwordx4 v5, s[16:19], s96 offen sc1 lds
  s_add_u32 m0, s95, s84
  s_add_u32 s96, s94, s84
  buffer_load_dwordx4 v5, s[16:19], s96 offen sc1 lds
  s_waitcnt vmcnt(10)
  s_barrier
  s_mov_b32 s94, 778240
  s_mov_b32 s95, 61440
  s_add_u32 s94, s94, s60
  s_add_u32 s95, s95, s56
  s_add_u32 m0, s95, s24
  s_add_u32 s96, s94, s24
  buffer_load_dwordx4 v5, s[16:19], s96 offen sc1 lds
  s_add_u32 m0, s95, s25
  s_add_u32 s96, s94, s25
  buffer_load_dwordx4 v5, s[16:19], s96 offen sc1 lds
  s_add_u32 m0, s95, s26
  s_add_u32 s96, s94, s26
  buffer_load_dwordx4 v5, s[16:19], s96 offen sc1 lds
  s_add_u32 m0, s95, s27
  s_add_u32 s96, s94, s27
  buffer_load_dwordx4 v5, s[16:19], s96 offen sc1 lds
  s_add_u32 m0, s95, s84
  s_add_u32 s96, s94, s84
  buffer_load_dwordx4 v5, s[16:19], s96 offen sc1 lds
  s_waitcnt vmcnt(0)
  s_barrier
  s_branch L_fin
L_hsp:
  s_waitcnt lgkmcnt(0)
  s_add_u32 s94, s86, 0xb9c000
  s_addc_u32 s95, s87, 0
  s_load_dword s99, s[94:95], 0
  s_mov_b32 s6, 0
  s_lshr_b32 s50, s5, 2
  v_mov_b32 v4, 1
  s_mov_b32 s8, s64
  s_and_b32 s9, s65, 0xffff
  s_mov_b32 s10, 0x280000
  s_mov_b32 s11, 0x20000
L_spare:
  s_mov_b32 s16, s86
  s_and_b32 s17, s87, 0xffff
  s_mov_b32 s18, 0x10000000
  s_mov_b32 s19, 0x20000
  s_mov_b32 s20, s82
  s_and_b32 s21, s83, 0xffff
  s_mov_b32 s22, 0x280000
  s_mov_b32 s23, 0x20000
  s_waitcnt lgkmcnt(0)
  s_mul_i32 s99, s99, 0x9e3779b1
  s_add_u32 s99, s99, 0x7f4a7c15
  v_mov_b32 v252, s99
  s_cmp_ge_u32 s3, 4
  s_cbranch_scc1 L_sp1
  s_cmp_eq_u32 s3, 1
  s_cbranch_scc1 I_49
  s_cmp_eq_u32 s3, 2
  s_cbranch_scc1 I_50
  s_mov_b32 s96, 0xffff0000
  v_mov_b32 v206, 0
  v_mov_b32 v207, 0
  v_mov_b32 v208, 0
  v_mov_b32 v209, 0
  s_waitcnt vmcnt(0)
  v_lshlrev_b32 v214, 16, v224
  v_and_b32 v215, s96, v224
  v_pk_add_f32 v[206:207], v[206:207], v[214:215]
  v_pk_fma_f32 v[208:209], v[214:215], v[214:215], v[208:209]
  v_lshlrev_b32 v216, 16, v225
  v_and_b32 v217, s96, v225
  v_pk_add_f32 v[206:207], v[206:207], v[216:217]
  v_pk_fma_f32 v[208:209], v[216:217], v[216:217], v[208:209]
  v_lshlrev_b32 v214, 16, v226
  v_and_b32 v215, s96, v226
  v_pk_add_f32 v[206:207], v[206:207], v[214:215]
  v_pk_fma_f32 v[208:209], v[214:215], v[214:215], v[208:209]
  v_lshlrev_b32 v216, 16, v227
  v_and_b32 v217, s96, v227
  v_pk_add_f32 v[206:207], v[206:207], v[216:217]
  v_pk_fma_f32 v[208:209], v[216:217], v[216:217], v[208:209]
  v_lshlrev_b32 v214, 16, v228
  v_and_b32 v215, s96, v228
  v_pk_add_f32 v[206:207], v[206:207], v[214:215]
  v_pk_fma_f32 v[208:209], v[214:215], v[214:215], v[208:209]
  v_lshlrev_b32 v216, 16, v229
  v_and_b32 v217, s96, v229
  v_pk_add_f32 v[206:207], v[206:207], v[216:217]
  v_pk_fma_f32 v[208:209], v[216:217], v[216:217], v[208:209]
  v_lshlrev_b32 v214, 16, v230
  v_and_b32 v215, s96, v230
  v_pk_add_f32 v[206:207], v[206:207], v[214:215]
  v_pk_fma_f32 v[208:209], v[214:215], v[214:215], v[208:209]
  v_lshlrev_b32 v216, 16, v231
  v_and_b32 v217, s96, v231
  v_pk_add_f32 v[206:207], v[206:207], v[216:217]
  v_pk_fma_f32 v[208:209], v[216:217], v[216:217], v[208:209]
  v_lshlrev_b32 v214, 16, v232
  v_and_b32 v215, s96, v232
  v_pk_add_f32 v[206:207], v[206:207], v[214:215]
  v_pk_fma_f32 v[208:209], v[214:215], v[214:215], v[208:209]
  v_lshlrev_b32 v216, 16, v233
  v_and_b32 v217, s96, v233
  v_pk_add_f32 v[206:207], v[206:207], v[216:217]
  v_pk_fma_f32 v[208:209], v[216:217], v[216:217], v[208:209]
  v_lshlrev_b32 v214, 16, v234
  v_and_b32 v215, s96, v234
  v_pk_add_f32 v[206:207], v[206:207], v[214:215]
  v_pk_fma_f32 v[208:209], v[214:215], v[214:215], v[208:209]
  v_lshlrev_b32 v216, 16, v235
  v_and_b32 v217, s96, v235
  v_pk_add_f32 v[206:207], v[206:207], v[216:217]
  v_pk_fma_f32 v[208:209], v[216:217], v[216:217], v[208:209]
  v_lshlrev_b32 v214, 16, v236
  v_and_b32 v215, s96, v236
  v_pk_add_f32 v[206:207], v[206:207], v[214:215]
  v_pk_fma_f32 v[208:209], v[214:215], v[214:215], v[208:209]
  v_lshlrev_b32 v216, 16, v237
  v_and_b32 v217, s96, v237
  v_pk_add_f32 v[206:207], v[206:207], v[216:217]
  v_pk_fma_f32 v[208:209], v[216:217], v[216:217], v[208:209]
  v_lshlrev_b32 v214, 16, v238
  v_and_b32 v215, s96, v238
  v_pk_add_f32 v[206:207], v[206:207], v[214:215]
  v_pk_fma_f32 v[208:209], v[214:215], v[214:215], v[208:209]
  v_lshlrev_b32 v216, 16, v239
  v_and_b32 v217, s96, v239
  v_pk_add_f32 v[206:207], v[206:207], v[216:217]
  v_pk_fma_f32 v[208:209], v[216:217], v[216:217], v[208:209]
  v_lshlrev_b32 v214, 16, v240
  v_and_b32 v215, s96, v240
  v_pk_add_f32 v[206:207], v[206:207], v[214:215]
  v_pk_fma_f32 v[208:209], v[214:215], v[214:215], v[208:209]
  v_lshlrev_b32 v216, 16, v241
  v_and_b32 v217, s96, v241
  v_pk_add_f32 v[206:207], v[206:207], v[216:217]
  v_pk_fma_f32 v[208:209], v[216:217], v[216:217], v[208:209]
  v_lshlrev_b32 v214, 16, v242
  v_and_b32 v215, s96, v242
  v_pk_add_f32 v[206:207], v[206:207], v[214:215]
  v_pk_fma_f32 v[208:209], v[214:215], v[214:215], v[208:209]
  v_lshlrev_b32 v216, 16, v243
  v_and_b32 v217, s96, v243
  v_pk_add_f32 v[206:207], v[206:207], v[216:217]
  v_pk_fma_f32 v[208:209], v[216:217], v[216:217], v[208:209]
  v_add_f32 v206, v206, v207
  v_add_f32 v208, v208, v209
  s_nop 0
  v_add_f32_dpp v206, v206, v206 quad_perm:[1,0,3,2] row_mask:0xf bank_mask:0xf
  v_add_f32_dpp v208, v208, v208 quad_perm:[1,0,3,2] row_mask:0xf bank_mask:0xf
  s_nop 0
  v_add_f32_dpp v206, v206, v206 quad_perm:[2,3,0,1] row_mask:0xf bank_mask:0xf
  v_add_f32_dpp v208, v208, v208 quad_perm:[2,3,0,1] row_mask:0xf bank_mask:0xf
  s_nop 0
  v_add_f32_dpp v206, v206, v206 row_half_mirror row_mask:0xf bank_mask:0xf
  v_add_f32_dpp v208, v208, v208 row_half_mirror row_mask:0xf bank_mask:0xf
  s_nop 0
  v_add_f32_dpp v206, v206, v206 row_mirror row_mask:0xf bank_mask:0xf
  v_add_f32_dpp v208, v208, v208 row_mirror row_mask:0xf bank_mask:0xf
  v_mul_f32 v206, 0x3acccccd, v206
  v_mul_f32 v208, 0x3acccccd, v208
  v_fma_f32 v208, -v206, v206, v208
  v_max_f32 v208, 0, v208
  v_add_f32 v207, 0x3727c5ac, v208
  v_rsq_f32 v207, v207
  s_nop 0
  v_mul_f32 v206, v206, v207
  v_lshlrev_b32 v201, 4, v201
  s_mov_b32 s95, 0xb20000
  v_mov_b32 v208, s99
  v_mov_b32 v209, s99
  s_mov_b32 exec_lo, 0x00010001
  s_mov_b32 exec_hi, 0x00010001
  buffer_store_dwordx4 v[206:209], v201, s[16:19], s95 offen sc1
  s_mov_b64 exec, -1
  s_branch I_51
I_49:
  s_waitcnt vmcnt(0)
  v_cmp_gt_u32 vcc, 50, v1
  s_nop 0
  s_and_saveexec_b64 s[96:97], vcc
  ds_write_b128 v201, v[206:209] offset:2048
  s_mov_b64 exec, -1
  s_getreg_b32 s94, hwreg(HW_REG_XCC_ID, 0, 4)
  s_xor_b32 s94, s94, s99
  s_lshl_b32 s95, s4, 5
  s_add_u32 s95, s95, s5
  s_lshl_b32 s95, s95, 2
  s_add_u32 s95, s95, 0xb9b000
  v_mov_b32 v205, s94
  v_mov_b32 v204, 0
  v_lshlrev_b32 v200, 4, v1
  s_mov_b64 exec, 1
  buffer_store_dword v205, v204, s[16:19], s95 offen sc1
  s_mov_b64 exec, -1
  v_mov_b32 v218, -1
  v_mov_b32 v219, -1
  v_mov_b32 v220, -1
  v_mov_b32 v221, -1
  s_mul_i32 s94, s2, 1280
  s_add_u32 s94, s94, 0xb40000
  buffer_store_dwordx4 v[218:221], v200, s[16:19], s94 offen sc1
  s_mov_b64 exec, 0xffff
  buffer_store_dwordx4 v[218:221], v200, s[16:19], s94 offen offset:1024 sc1
  s_mov_b64 exec, -1
I_50:
  s_cmp_ge_u32 s2, 200
  s_cbranch_scc1 I_51
  s_and_b32 s94, s3, 1
  s_lshl_b32 s63, s94, 12
  s_add_u32 s63, s63, 131072
  v_mov_b32 v218, 0x3f803f80
  v_mov_b32 v219, 0x3f803f80
  v_mov_b32 v220, 0x3f803f80
  v_mov_b32 v221, 0x3f803f80
  v_lshlrev_b32 v222, 4, v1
  v_lshlrev_b32 v223, 4, v2
  v_bfe_u32 v224, v1, 2, 2
  v_lshl_add_u32 v224, v2, 3, v224
  v_lshlrev_b32 v224, 7, v224
  v_and_b32 v225, 3, v1
  v_lshl_add_u32 v224, v225, 3, v224
  s_cmp_eq_u32 s3, 1
  s_cbranch_scc1 I_51w
  s_waitcnt vmcnt(0)
I_51w:
  v_add_u32 v225, s63, v224
  ds_read_b64_tr_b16 v[230:231], v225 offset:0
  ds_read_b64_tr_b16 v[232:233], v225 offset:512
  ds_read_b64_tr_b16 v[234:235], v225 offset:32
  ds_read_b64_tr_b16 v[236:237], v225 offset:544
  ds_read_b64_tr_b16 v[238:239], v225 offset:64
  ds_read_b64_tr_b16 v[240:241], v225 offset:576
  ds_read_b64_tr_b16 v[242:243], v225 offset:96
  ds_read_b64_tr_b16 v[244:245], v225 offset:608
  s_waitcnt lgkmcnt(0)
  buffer_store_dwordx4 v[230:233], v222, s[16:19], s24 offen sc1
  buffer_store_dwordx4 v[234:237], v222, s[16:19], s25 offen sc1
  buffer_store_dwordx4 v[238:241], v222, s[16:19], s26 offen sc1
  buffer_store_dwordx4 v[242:245], v222, s[16:19], s27 offen sc1
  s_cmp_eq_u32 s3, 2
  s_cbranch_scc1 I_51
  v_mfma_f32_16x16x32_bf16 v[200:203], v[230:233], v[218:221], 0
  v_mfma_f32_16x16x32_bf16 v[204:207], v[234:237], v[218:221], 0
  v_mfma_f32_16x16x32_bf16 v[208:211], v[238:241], v[218:221], 0
  v_mfma_f32_16x16x32_bf16 v[212:215], v[242:245], v[218:221], 0
  s_mov_b32 exec_lo, 0x00010001
  s_mov_b32 exec_hi, 0x00010001
  s_nop 2
  buffer_store_dwordx4 v[200:203], v223, s[16:19], s90 offen sc1
  buffer_store_dwordx4 v[204:207], v223, s[16:19], s91 offen sc1
  buffer_store_dwordx4 v[208:211], v223, s[16:19], s88 offen sc1
  buffer_store_dwordx4 v[212:215], v223, s[16:19], s89 offen sc1
  s_mov_b64 exec, -1
NC_54:
  s_nop 1
I_51:
L_sp1:
  s_lshl_b32 s63, s4, 4
  s_lshl_b32 s32, s48, 3
  s_add_u32 s63, s63, s32
  s_add_u32 s63, s63, s3
  v_mov_b32 v24, 0x3f803f80
  v_mov_b32 v25, 0x3f803f80
  v_mov_b32 v26, 0x3f803f80
  v_mov_b32 v27, 0x3f803f80
  v_lshlrev_b32 v28, 4, v1
  v_lshlrev_b32 v29, 4, v2
  v_bfe_u32 v30, v1, 2, 2
  v_lshl_add_u32 v30, v2, 3, v30
  v_lshlrev_b32 v30, 7, v30
  v_and_b32 v31, 3, v1
  v_lshl_add_u32 v30, v31, 3, v30
  s_add_u32 s40, s63, 400
  s_min_u32 s40, s40, 599
  s_mov_b32 s44, 2
  s_mov_b32 s33, 400
  s_mov_b32 s28, s76
  s_mov_b32 s29, s77
  s_sub_u32 s45, s40, s33
  s_and_b32 s29, s29, 0xffff
  s_mov_b32 s30, 819200
  s_mov_b32 s31, 0x20000
  s_cmp_eq_u32 s44, 3
  s_mov_b32 s43, 1280
  s_cmov_b32 s43, 3072
  s_cmp_eq_u32 s44, 4
  s_mov_b32 s33, 52429
  s_cmov_b32 s33, 21846
  s_mul_i32 s41, s45, s33
  s_lshr_b32 s41, s41, 20
  s_cmp_eq_u32 s44, 4
  s_cselect_b32 s33, 48, 20
  s_mul_i32 s33, s41, s33
  s_sub_u32 s42, s45, s33
  s_lshl_b32 s62, s3, 14
  s_add_u32 s62, s62, 0
  v_lshrrev_b32 v20, 3, v1
  v_mul_lo_u32 v20, v20, s43
  v_and_b32 v21, 7, v1
  v_lshl_add_u32 v20, v21, 4, v20
  s_mul_i32 s45, s42, s43
  s_lshl_b32 s45, s45, 5
  s_lshl_b32 s33, s41, 7
  s_add_u32 s45, s45, s33
  s_lshl_b32 s34, s43, 3
  s_add_u32 m0, s62, 0
  s_nop 0
  buffer_load_dwordx4 v20, s[28:31], s45 offen nt lds
  s_add_u32 s45, s45, s34
  s_add_u32 m0, s62, 1024
  s_nop 0
  buffer_load_dwordx4 v20, s[28:31], s45 offen nt lds
  s_add_u32 s45, s45, s34
  s_add_u32 m0, s62, 2048
  s_nop 0
  buffer_load_dwordx4 v20, s[28:31], s45 offen nt lds
  s_add_u32 s45, s45, s34
  s_add_u32 m0, s62, 3072
  s_nop 0
  buffer_load_dwordx4 v20, s[28:31], s45 offen nt lds
  s_add_u32 s40, s63, 528
  s_min_u32 s40, s40, 599
  s_mov_b32 s44, 2
  s_mov_b32 s33, 400
  s_mov_b32 s28, s76
  s_mov_b32 s29, s77
  s_sub_u32 s45, s40, s33
  s_and_b32 s29, s29, 0xffff
  s_mov_b32 s30, 819200
  s_mov_b32 s31, 0x20000
  s_cmp_eq_u32 s44, 3
  s_mov_b32 s43, 1280
  s_cmov_b32 s43, 3072
  s_cmp_eq_u32 s44, 4
  s_mov_b32 s33, 52429
  s_cmov_b32 s33, 21846
  s_mul_i32 s41, s45, s33
  s_lshr_b32 s41, s41, 20
  s_cmp_eq_u32 s44, 4
  s_cselect_b32 s33, 48, 20
  s_mul_i32 s33, s41, s33
  s_sub_u32 s42, s45, s33
  s_lshl_b32 s62, s3, 14
  s_add_u32 s62, s62, 4096
  v_lshrrev_b32 v20, 3, v1
  v_mul_lo_u32 v20, v20, s43
  v_and_b32 v21, 7, v1
  v_lshl_add_u32 v20, v21, 4, v20
  s_mul_i32 s45, s42, s43
  s_lshl_b32 s45, s45, 5
  s_lshl_b32 s33, s41, 7
  s_add_u32 s45, s45, s33
  s_lshl_b32 s34, s43, 3
  s_add_u32 m0, s62, 0
  s_nop 0
  buffer_load_dwordx4 v20, s[28:31], s45 offen nt lds
  s_add_u32 s45, s45, s34
  s_add_u32 m0, s62, 1024
  s_nop 0
  buffer_load_dwordx4 v20, s[28:31], s45 offen nt lds
  s_add_u32 s45, s45, s34
  s_add_u32 m0, s62, 2048
  s_nop 0
  buffer_load_dwordx4 v20, s[28:31], s45 offen nt lds
  s_add_u32 s45, s45, s34
  s_add_u32 m0, s62, 3072
  s_nop 0
  buffer_load_dwordx4 v20, s[28:31], s45 offen nt lds
  v_lshlrev_b32 v22, 7, v1
  v_add_u32 v22, s63, v22
  v_min_u32 v22, 199, v22
  v_lshlrev_b32 v22, 2, v22
  s_mov_b32 s61, 0xb99640
  s_add_u32 s40, s63, 400
  s_min_u32 s40, s40, 599
  s_mov_b32 s44, 2
  s_mov_b32 s33, 400
  s_mov_b32 s28, s76
  s_mov_b32 s29, s77
  s_sub_u32 s45, s40, s33
  s_and_b32 s29, s29, 0xffff
  s_mov_b32 s30, 819200
  s_mov_b32 s31, 0x20000
  s_cmp_eq_u32 s44, 3
  s_mov_b32 s43, 1280
  s_cmov_b32 s43, 3072
  s_cmp_eq_u32 s44, 4
  s_mov_b32 s33, 52429
  s_cmov_b32 s33, 21846
  s_mul_i32 s41, s45, s33
  s_lshr_b32 s41, s41, 20
  s_cmp_eq_u32 s44, 4
  s_cselect_b32 s33, 48, 20
  s_mul_i32 s33, s41, s33
  s_sub_u32 s42, s45, s33
  s_lshl_b32 s62, s3, 14
  s_add_u32 s62, s62, 0
  s_waitcnt vmcnt(4)
  v_add_u32 v31, s62, v30
  ds_read_b64_tr_b16 v[36:37], v31 offset:0
  ds_read_b64_tr_b16 v[38:39], v31 offset:512
  ds_read_b64_tr_b16 v[40:41], v31 offset:32
  ds_read_b64_tr_b16 v[42:43], v31 offset:544
  ds_read_b64_tr_b16 v[44:45], v31 offset:64
  ds_read_b64_tr_b16 v[46:47], v31 offset:576
  ds_read_b64_tr_b16 v[48:49], v31 offset:96
  ds_read_b64_tr_b16 v[50:51], v31 offset:608
  s_mul_i32 s36, s42, 5120
  s_mul_i32 s45, s44, 102400
  s_add_u32 s36, s36, s45
  s_add_u32 s36, s36, 0xc00000
  s_lshl_b32 s34, s41, 2
  s_add_u32 s34, s34, 0
  s_mul_i32 s45, s34, 52
  s_lshr_b32 s45, s45, 8
  s_mul_i32 s33, s45, 5
  s_sub_u32 s33, s34, s33
  s_and_b32 s34, s45, 1
  s_sub_u32 s33, s33, s34
  s_cmp_lt_i32 s33, 0
  s_cselect_b32 s33, 4, s33
  s_mul_i32 s34, s45, 798720
  s_lshl_b32 s35, s33, 10
  s_add_u32 s34, s34, s35
  s_add_u32 s46, s34, s36
  s_lshl_b32 s34, s41, 2
  s_add_u32 s34, s34, 1
  s_mul_i32 s45, s34, 52
  s_lshr_b32 s45, s45, 8
  s_mul_i32 s33, s45, 5
  s_sub_u32 s33, s34, s33
  s_and_b32 s34, s45, 1
  s_sub_u32 s33, s33, s34
  s_cmp_lt_i32 s33, 0
  s_cselect_b32 s33, 4, s33
  s_mul_i32 s34, s45, 798720
  s_lshl_b32 s35, s33, 10
  s_add_u32 s34, s34, s35
  s_add_u32 s47, s34, s36
  s_lshl_b32 s34, s41, 2
  s_add_u32 s34, s34, 2
  s_mul_i32 s45, s34, 52
  s_lshr_b32 s45, s45, 8
  s_mul_i32 s33, s45, 5
  s_sub_u32 s33, s34, s33
  s_and_b32 s34, s45, 1
  s_sub_u32 s33, s33, s34
  s_cmp_lt_i32 s33, 0
  s_cselect_b32 s33, 4, s33
  s_mul_i32 s34, s45, 798720
  s_lshl_b32 s35, s33, 10
  s_add_u32 s34, s34, s35
  s_add_u32 s92, s34, s36
  s_lshl_b32 s34, s41, 2
  s_add_u32 s34, s34, 3
  s_mul_i32 s45, s34, 52
  s_lshr_b32 s45, s45, 8
  s_mul_i32 s33, s45, 5
  s_sub_u32 s33, s34, s33
  s_and_b32 s34, s45, 1
  s_sub_u32 s33, s33, s34
  s_cmp_lt_i32 s33, 0
  s_cselect_b32 s33, 4, s33
  s_mul_i32 s34, s45, 798720
  s_lshl_b32 s35, s33, 10
  s_add_u32 s34, s34, s35
  s_add_u32 s93, s34, s36
  s_waitcnt lgkmcnt(0)
  buffer_store_dwordx4 v[36:39], v28, s[16:19], s46 offen sc1
  buffer_store_dwordx4 v[40:43], v28, s[16:19], s47 offen sc1
  buffer_store_dwordx4 v[44:47], v28, s[16:19], s92 offen sc1
  buffer_store_dwordx4 v[48:51], v28, s[16:19], s93 offen sc1
  s_add_u32 s40, s63, 528
  s_min_u32 s40, s40, 599
  s_mov_b32 s44, 2
  s_mov_b32 s33, 400
  s_mov_b32 s28, s76
  s_mov_b32 s29, s77
  s_sub_u32 s45, s40, s33
  s_and_b32 s29, s29, 0xffff
  s_mov_b32 s30, 819200
  s_mov_b32 s31, 0x20000
  s_cmp_eq_u32 s44, 3
  s_mov_b32 s43, 1280
  s_cmov_b32 s43, 3072
  s_cmp_eq_u32 s44, 4
  s_mov_b32 s33, 52429
  s_cmov_b32 s33, 21846
  s_mul_i32 s41, s45, s33
  s_lshr_b32 s41, s41, 20
  s_cmp_eq_u32 s44, 4
  s_cselect_b32 s33, 48, 20
  s_mul_i32 s33, s41, s33
  s_sub_u32 s42, s45, s33
  s_lshl_b32 s62, s3, 14
  s_add_u32 s62, s62, 4096
  s_waitcnt vmcnt(4)
  v_add_u32 v31, s62, v30
  ds_read_b64_tr_b16 v[36:37], v31 offset:0
  ds_read_b64_tr_b16 v[38:39], v31 offset:512
  ds_read_b64_tr_b16 v[40:41], v31 offset:32
  ds_read_b64_tr_b16 v[42:43], v31 offset:544
  ds_read_b64_tr_b16 v[44:45], v31 offset:64
  ds_read_b64_tr_b16 v[46:47], v31 offset:576
  ds_read_b64_tr_b16 v[48:49], v31 offset:96
  ds_read_b64_tr_b16 v[50:51], v31 offset:608
  s_mul_i32 s36, s42, 5120
  s_mul_i32 s45, s44, 102400
  s_add_u32 s36, s36, s45
  s_add_u32 s36, s36, 0xc00000
  s_lshl_b32 s34, s41, 2
  s_add_u32 s34, s34, 0
  s_mul_i32 s45, s34, 52
  s_lshr_b32 s45, s45, 8
  s_mul_i32 s33, s45, 5
  s_sub_u32 s33, s34, s33
  s_and_b32 s34, s45, 1
  s_sub_u32 s33, s33, s34
  s_cmp_lt_i32 s33, 0
  s_cselect_b32 s33, 4, s33
  s_mul_i32 s34, s45, 798720
  s_lshl_b32 s35, s33, 10
  s_add_u32 s34, s34, s35
  s_add_u32 s46, s34, s36
  s_lshl_b32 s34, s41, 2
  s_add_u32 s34, s34, 1
  s_mul_i32 s45, s34, 52
  s_lshr_b32 s45, s45, 8
  s_mul_i32 s33, s45, 5
  s_sub_u32 s33, s34, s33
  s_and_b32 s34, s45, 1
  s_sub_u32 s33, s33, s34
  s_cmp_lt_i32 s33, 0
  s_cselect_b32 s33, 4, s33
  s_mul_i32 s34, s45, 798720
  s_lshl_b32 s35, s33, 10
  s_add_u32 s34, s34, s35
  s_add_u32 s47, s34, s36
  s_lshl_b32 s34, s41, 2
  s_add_u32 s34, s34, 2
  s_mul_i32 s45, s34, 52
  s_lshr_b32 s45, s45, 8
  s_mul_i32 s33, s45, 5
  s_sub_u32 s33, s34, s33
  s_and_b32 s34, s45, 1
  s_sub_u32 s33, s33, s34
  s_cmp_lt_i32 s33, 0
  s_cselect_b32 s33, 4, s33
  s_mul_i32 s34, s45, 798720
  s_lshl_b32 s35, s33, 10
  s_add_u32 s34, s34, s35
  s_add_u32 s92, s34, s36
  s_lshl_b32 s34, s41, 2
  s_add_u32 s34, s34, 3
  s_mul_i32 s45, s34, 52
  s_lshr_b32 s45, s45, 8
  s_mul_i32 s33, s45, 5
  s_sub_u32 s33, s34, s33
  s_and_b32 s34, s45, 1
  s_sub_u32 s33, s33, s34
  s_cmp_lt_i32 s33, 0
  s_cselect_b32 s33, 4, s33
  s_mul_i32 s34, s45, 798720
  s_lshl_b32 s35, s33, 10
  s_add_u32 s34, s34, s35
  s_add_u32 s93, s34, s36
  s_waitcnt lgkmcnt(0)
  buffer_store_dwordx4 v[36:39], v28, s[16:19], s46 offen sc1
  buffer_store_dwordx4 v[40:43], v28, s[16:19], s47 offen sc1
  buffer_store_dwordx4 v[44:47], v28, s[16:19], s92 offen sc1
  buffer_store_dwordx4 v[48:51], v28, s[16:19], s93 offen sc1
  s_waitcnt vmcnt(0)
  s_mov_b64 exec, 3
  buffer_store_dword v252, v22, s[16:19], s61 offen sc1
  s_mov_b64 exec, -1
  v_and_b32 v36, 31, v1
  v_lshlrev_b32 v36, 2, v36
  s_lshl_b32 s98, s4, 7
  s_add_u32 s98, s98, 0xb9b000
  buffer_load_dword v34, v36, s[16:19], s98 offen sc1
  s_waitcnt vmcnt(0)
  s_waitcnt lgkmcnt(0)
  s_barrier
  s_cmp_ge_u32 s3, 4
  s_cbranch_scc1 L_hs2
  s_mov_b32 s7, 400000
  s_waitcnt vmcnt(63)
  s_branch PE_61
P_59:
  buffer_load_dword v34, v36, s[16:19], s98 offen sc1
  s_waitcnt vmcnt(0)
PE_61:
  v_xor_b32 v34, s99, v34
  v_cmp_lt_u32 vcc, 15, v34
  s_nop 0
  s_cbranch_vccz PD_60
  s_sleep 20
  s_sub_u32 s7, s7, 1
  s_cbranch_scc0 P_59
PD_60:
  s_getreg_b32 s94, hwreg(HW_REG_XCC_ID, 0, 4)
  v_cmp_ne_u32 vcc, s94, v34
  s_nop 1
  s_cmp_eq_u64 vcc, 0
  s_cselect_b32 s6, 1, 0
  s_branch L_c3
L_hs2:
  s_mul_i32 s60, s50, 798720
  s_add_u32 s60, s60, 0xc00000
  s_mul_i32 s56, s57, 5120
  s_lshr_b32 s94, s4, 1
  s_add_u32 s95, s94, 0
  s_cmp_ge_u32 s95, 5
  s_cselect_b32 s96, 5, 0
  s_sub_u32 s95, s95, s96
  s_lshl_b32 s24, s95, 10
  s_add_u32 s95, s94, 1
  s_cmp_ge_u32 s95, 5
  s_cselect_b32 s96, 5, 0
  s_sub_u32 s95, s95, s96
  s_lshl_b32 s25, s95, 10
  s_add_u32 s95, s94, 2
  s_cmp_ge_u32 s95, 5
  s_cselect_b32 s96, 5, 0
  s_sub_u32 s95, s95, s96
  s_lshl_b32 s26, s95, 10
  s_add_u32 s95, s94, 3
  s_cmp_ge_u32 s95, 5
  s_cselect_b32 s96, 5, 0
  s_sub_u32 s95, s95, s96
  s_lshl_b32 s27, s95, 10
  s_add_u32 s95, s94, 4
  s_cmp_ge_u32 s95, 5
  s_cselect_b32 s96, 5, 0
  s_sub_u32 s95, s95, s96
  s_lshl_b32 s84, s95, 10
  s_and_b32 s85, s4, 1
  s_mul_i32 s72, s4, 11
  s_lshr_b32 s72, s72, 5
  s_mul_i32 s72, s72, 3
  s_sub_u32 s72, s4, s72
  v_lshlrev_b32 v5, 4, v1
  v_add_u32 v5, s56, v5
  v_mov_b32 v40, v34
  s_mul_i32 s42, s50, 5
  s_lshr_b32 s42, s42, 2
  s_mul_i32 s43, s42, 80
  s_add_u32 s43, s43, 0xb99000
  v_min_u32 v30, 39, v1
  v_lshlrev_b32 v30, 2, v30
  s_mov_b32 s7, 400000
P_62:
  buffer_load_dword v32, v30, s[16:19], s43 offen offset:0 sc1
  s_waitcnt vmcnt(0)
PE_64:
  v_cmp_ne_u32 vcc, s99, v32
  s_nop 0
  s_cbranch_vccz PD_63
  s_sleep 50
  s_sub_u32 s7, s7, 1
  s_cbranch_scc0 P_62
PD_63:
  s_add_u32 s94, s60, 0
  s_add_u32 m0, s56, 0
  s_nop 0
  buffer_load_dwordx4 v5, s[16:19], s94 offen offset:0 sc1 lds
  buffer_load_dwordx4 v5, s[16:19], s94 offen offset:1024 sc1 lds
  buffer_load_dwordx4 v5, s[16:19], s94 offen offset:2048 sc1 lds
  buffer_load_dwordx4 v5, s[16:19], s94 offen offset:3072 sc1 lds
  s_add_u32 s94, s94, 4096
  s_add_u32 m0, s56, 4096
  s_nop 0
  buffer_load_dwordx4 v5, s[16:19], s94 offen sc1 lds
  s_add_u32 s94, s60, 20480
  s_add_u32 m0, s56, 20480
  s_nop 0
  buffer_load_dwordx4 v5, s[16:19], s94 offen offset:0 sc1 lds
  buffer_load_dwordx4 v5, s[16:19], s94 offen offset:1024 sc1 lds
  buffer_load_dwordx4 v5, s[16:19], s94 offen offset:2048 sc1 lds
  buffer_load_dwordx4 v5, s[16:19], s94 offen offset:3072 sc1 lds
  s_add_u32 s94, s94, 4096
  s_add_u32 m0, s56, 24576
  s_nop 0
  buffer_load_dwordx4 v5, s[16:19], s94 offen sc1 lds
  s_add_u32 s94, s60, 40960
  s_add_u32 m0, s56, 40960
  s_nop 0
  buffer_load_dwordx4 v5, s[16:19], s94 offen offset:0 sc1 lds
  buffer_load_dwordx4 v5, s[16:19], s94 offen offset:1024 sc1 lds
  buffer_load_dwordx4 v5, s[16:19], s94 offen offset:2048 sc1 lds
  buffer_load_dwordx4 v5, s[16:19], s94 offen offset:3072 sc1 lds
  s_add_u32 s94, s94, 4096
  s_add_u32 m0, s56, 45056
  s_nop 0
  buffer_load_dwordx4 v5, s[16:19], s94 offen sc1 lds
  v_mov_b32 v34, v40
  s_mov_b32 s59, 0
  s_branch L_h3
L_C1:
  s_mov_b32 s6, 0
  s_lshr_b32 s50, s5, 2
  v_mov_b32 v4, 1
  s_cmp_ge_u32 s5, 30
  s_cbranch_scc1 L_spare
  s_lshr_b32 s32, s3, 1
  s_and_b32 s33, s3, 1
  s_lshl_b32 s34, s32, 13
  s_add_u32 s34, s34, 0x10000
  v_lshlrev_b32 v12, 7, v3
  v_add_u32 v12, s34, v12
  v_lshrrev_b32 v13, 1, v3
  v_xor_b32 v13, v13, v2
  v_xor_b32 v14, 0, v13
  v_lshl_add_u32 v8, v14, 4, v12
  v_xor_b32 v14, 4, v13
  v_lshl_add_u32 v9, v14, 4, v12
  v_bfe_u32 v14, v1, 2, 2
  v_lshl_add_u32 v15, v2, 3, v14
  v_lshlrev_b32 v15, 8, v15
  v_and_b32 v16, 3, v1
  v_lshl_add_u32 v15, v16, 4, v15
  v_add_u32 v15, 0x14000, v15
  s_lshl_b32 s34, s33, 1
  s_add_u32 s34, s34, s32
  s_xor_b32 s35, s34, 0
  v_xor_b32 v16, s35, v14
  v_lshl_add_u32 v10, v16, 6, v15
  s_xor_b32 s35, s34, 1
  v_xor_b32 v16, s35, v14
  v_lshl_add_u32 v11, v16, 6, v15
  v_mov_b32 v56, 0x3f803f80
  v_mov_b32 v57, 0x3f803f80
  v_mov_b32 v58, 0x3f803f80
  v_mov_b32 v59, 0x3f803f80
  v_mov_b64 v[64:65], 0
  v_mov_b64 v[66:67], 0
  v_mov_b64 v[68:69], 0
  v_mov_b64 v[70:71], 0
  v_mov_b64 v[72:73], 0
  v_mov_b64 v[74:75], 0
  v_mov_b64 v[76:77], 0
  v_mov_b64 v[78:79], 0
  v_mov_b64 v[80:81], 0
  v_mov_b64 v[82:83], 0
  v_mov_b64 v[84:85], 0
  v_mov_b64 v[86:87], 0
  v_mov_b64 v[88:89], 0
  v_mov_b64 v[90:91], 0
  v_mov_b64 v[92:93], 0
  v_mov_b64 v[94:95], 0
  v_mov_b64 v[96:97], 0
  v_mov_b64 v[98:99], 0
  v_mov_b64 v[100:101], 0
  v_mov_b64 v[102:103], 0
  v_mov_b64 v[104:105], 0
  v_mov_b64 v[106:107], 0
  v_mov_b64 v[108:109], 0
  v_mov_b64 v[110:111], 0
  v_mov_b64 v[112:113], 0
  v_mov_b64 v[114:115], 0
  v_mov_b64 v[116:117], 0
  v_mov_b64 v[118:119], 0
  v_mov_b64 v[120:121], 0
  v_mov_b64 v[122:123], 0
  v_mov_b64 v[124:125], 0
  v_mov_b64 v[126:127], 0
  v_mov_b64 v[128:129], 0
  v_mov_b64 v[130:131], 0
  v_mov_b64 v[132:133], 0
  v_mov_b64 v[134:135], 0
  s_mov_b32 s16, s86
  s_and_b32 s17, s87, 0xffff
  s_mov_b32 s18, 0x10000000
  s_mov_b32 s19, 0x20000
  s_mov_b32 s20, s82
  s_and_b32 s21, s83, 0xffff
  s_mov_b32 s22, 0x280000
  s_mov_b32 s23, 0x20000
  s_waitcnt lgkmcnt(0)
  s_mul_i32 s99, s99, 0x9e3779b1
  s_add_u32 s99, s99, 0x7f4a7c15
  v_mov_b32 v252, s99
  s_mov_b32 s59, 0
  s_mov_b32 s60, 0x1ffff
  s_lshl_b32 s34, s61, 7
  s_lshl_b32 s35, s32, 6
  s_add_u32 s34, s34, s35
  s_lshl_b32 s42, s34, 4
  s_add_u32 s42, s42, 0xb20000
  v_lshlrev_b32 v36, 4, v3
  v_lshlrev_b32 v40, 4, v1
  s_lshl_b32 s36, s33, 8
  s_add_u32 s36, s36, 148992
  s_lshl_b32 s37, s32, 7
  s_add_u32 s38, s36, s37
  v_lshlrev_b32 v37, 4, v2
  v_add_u32 v38, s38, v37
  s_xor_b32 s37, s37, 128
  s_add_u32 s38, s36, s37
  v_add_u32 v39, s38, v37
  s_lshr_b32 s34, s34, 4
  s_mul_i32 s34, s34, 20480
  s_lshl_b32 s35, s62, 12
  s_lshl_b32 s36, s33, 11
  s_add_u32 s34, s34, s35
  s_add_u32 s34, s34, s36
  s_mov_b32 s35, 0x0
  s_cmp_ge_u32 s62, 5
  s_cmov_b32 s35, 0x27b000
  s_cmp_ge_u32 s62, 10
  s_cmov_b32 s35, 0xffff6000
  s_cselect_b32 s28, s20, s16
  s_cselect_b32 s29, s21, s17
  s_cselect_b32 s30, s22, s18
  s_mov_b32 s31, 0x20000
  s_add_u32 s36, s34, s35
  s_add_u32 s37, s36, 20480
  s_add_u32 s38, s36, 40960
  s_add_u32 s39, s36, 61440
  s_lshl_b32 s35, s32, 10
  v_add_u32 v46, s35, v40
  v_xor_b32 v47, 0x400, v46
  s_lshl_b32 s40, s61, 1
  s_add_u32 s40, s40, s32
  s_lshl_b32 s40, s40, 5
  s_lshl_b32 s41, s62, 1
  s_add_u32 s40, s40, s41
  s_add_u32 s40, s40, s33
  s_lshl_b32 s40, s40, 2
  s_add_u32 s40, s40, 0xb98000
  v_mov_b32 v41, 0
  v_mov_b32 v42, 0
  s_mov_b32 s98, 0
  v_mul_u32_u24 v43, 20480, v2
  v_lshl_add_u32 v43, v3, 7, v43
  s_cmp_eq_u32 s3, 1
  s_cbranch_scc1 I_65
  s_cmp_eq_u32 s3, 2
  s_cbranch_scc1 I_66
  s_mov_b32 s96, 0xffff0000
  v_mov_b32 v206, 0
  v_mov_b32 v207, 0
  v_mov_b32 v208, 0
  v_mov_b32 v209, 0
  s_waitcnt vmcnt(0)
  v_lshlrev_b32 v214, 16, v224
  v_and_b32 v215, s96, v224
  v_pk_add_f32 v[206:207], v[206:207], v[214:215]
  v_pk_fma_f32 v[208:209], v[214:215], v[214:215], v[208:209]
  v_lshlrev_b32 v216, 16, v225
  v_and_b32 v217, s96, v225
  v_pk_add_f32 v[206:207], v[206:207], v[216:217]
  v_pk_fma_f32 v[208:209], v[216:217], v[216:217], v[208:209]
  v_lshlrev_b32 v214, 16, v226
  v_and_b32 v215, s96, v226
  v_pk_add_f32 v[206:207], v[206:207], v[214:215]
  v_pk_fma_f32 v[208:209], v[214:215], v[214:215], v[208:209]
  v_lshlrev_b32 v216, 16, v227
  v_and_b32 v217, s96, v227
  v_pk_add_f32 v[206:207], v[206:207], v[216:217]
  v_pk_fma_f32 v[208:209], v[216:217], v[216:217], v[208:209]
  v_lshlrev_b32 v214, 16, v228
  v_and_b32 v215, s96, v228
  v_pk_add_f32 v[206:207], v[206:207], v[214:215]
  v_pk_fma_f32 v[208:209], v[214:215], v[214:215], v[208:209]
  v_lshlrev_b32 v216, 16, v229
  v_and_b32 v217, s96, v229
  v_pk_add_f32 v[206:207], v[206:207], v[216:217]
  v_pk_fma_f32 v[208:209], v[216:217], v[216:217], v[208:209]
  v_lshlrev_b32 v214, 16, v230
  v_and_b32 v215, s96, v230
  v_pk_add_f32 v[206:207], v[206:207], v[214:215]
  v_pk_fma_f32 v[208:209], v[214:215], v[214:215], v[208:209]
  v_lshlrev_b32 v216, 16, v231
  v_and_b32 v217, s96, v231
  v_pk_add_f32 v[206:207], v[206:207], v[216:217]
  v_pk_fma_f32 v[208:209], v[216:217], v[216:217], v[208:209]
  v_lshlrev_b32 v214, 16, v232
  v_and_b32 v215, s96, v232
  v_pk_add_f32 v[206:207], v[206:207], v[214:215]
  v_pk_fma_f32 v[208:209], v[214:215], v[214:215], v[208:209]
  v_lshlrev_b32 v216, 16, v233
  v_and_b32 v217, s96, v233
  v_pk_add_f32 v[206:207], v[206:207], v[216:217]
  v_pk_fma_f32 v[208:209], v[216:217], v[216:217], v[208:209]
  v_lshlrev_b32 v214, 16, v234
  v_and_b32 v215, s96, v234
  v_pk_add_f32 v[206:207], v[206:207], v[214:215]
  v_pk_fma_f32 v[208:209], v[214:215], v[214:215], v[208:209]
  v_lshlrev_b32 v216, 16, v235
  v_and_b32 v217, s96, v235
  v_pk_add_f32 v[206:207], v[206:207], v[216:217]
  v_pk_fma_f32 v[208:209], v[216:217], v[216:217], v[208:209]
  v_lshlrev_b32 v214, 16, v236
  v_and_b32 v215, s96, v236
  v_pk_add_f32 v[206:207], v[206:207], v[214:215]
  v_pk_fma_f32 v[208:209], v[214:215], v[214:215], v[208:209]
  v_lshlrev_b32 v216, 16, v237
  v_and_b32 v217, s96, v237
  v_pk_add_f32 v[206:207], v[206:207], v[216:217]
  v_pk_fma_f32 v[208:209], v[216:217], v[216:217], v[208:209]
  v_lshlrev_b32 v214, 16, v238
  v_and_b32 v215, s96, v238
  v_pk_add_f32 v[206:207], v[206:207], v[214:215]
  v_pk_fma_f32 v[208:209], v[214:215], v[214:215], v[208:209]
  v_lshlrev_b32 v216, 16, v239
  v_and_b32 v217, s96, v239
  v_pk_add_f32 v[206:207], v[206:207], v[216:217]
  v_pk_fma_f32 v[208:209], v[216:217], v[216:217], v[208:209]
  v_lshlrev_b32 v214, 16, v240
  v_and_b32 v215, s96, v240
  v_pk_add_f32 v[206:207], v[206:207], v[214:215]
  v_pk_fma_f32 v[208:209], v[214:215], v[214:215], v[208:209]
  v_lshlrev_b32 v216, 16, v241
  v_and_b32 v217, s96, v241
  v_pk_add_f32 v[206:207], v[206:207], v[216:217]
  v_pk_fma_f32 v[208:209], v[216:217], v[216:217], v[208:209]
  v_lshlrev_b32 v214, 16, v242
  v_and_b32 v215, s96, v242
  v_pk_add_f32 v[206:207], v[206:207], v[214:215]
  v_pk_fma_f32 v[208:209], v[214:215], v[214:215], v[208:209]
  v_lshlrev_b32 v216, 16, v243
  v_and_b32 v217, s96, v243
  v_pk_add_f32 v[206:207], v[206:207], v[216:217]
  v_pk_fma_f32 v[208:209], v[216:217], v[216:217], v[208:209]
  v_add_f32 v206, v206, v207
  v_add_f32 v208, v208, v209
  s_nop 0
  v_add_f32_dpp v206, v206, v206 quad_perm:[1,0,3,2] row_mask:0xf bank_mask:0xf
  v_add_f32_dpp v208, v208, v208 quad_perm:[1,0,3,2] row_mask:0xf bank_mask:0xf
  s_nop 0
  v_add_f32_dpp v206, v206, v206 quad_perm:[2,3,0,1] row_mask:0xf bank_mask:0xf
  v_add_f32_dpp v208, v208, v208 quad_perm:[2,3,0,1] row_mask:0xf bank_mask:0xf
  s_nop 0
  v_add_f32_dpp v206, v206, v206 row_half_mirror row_mask:0xf bank_mask:0xf
  v_add_f32_dpp v208, v208, v208 row_half_mirror row_mask:0xf bank_mask:0xf
  s_nop 0
  v_add_f32_dpp v206, v206, v206 row_mirror row_mask:0xf bank_mask:0xf
  v_add_f32_dpp v208, v208, v208 row_mirror row_mask:0xf bank_mask:0xf
  v_mul_f32 v206, 0x3acccccd, v206
  v_mul_f32 v208, 0x3acccccd, v208
  v_fma_f32 v208, -v206, v206, v208
  v_max_f32 v208, 0, v208
  v_add_f32 v207, 0x3727c5ac, v208
  v_rsq_f32 v207, v207
  s_nop 0
  v_mul_f32 v206, v206, v207
  v_lshlrev_b32 v201, 4, v201
  s_mov_b32 s95, 0xb20000
  v_mov_b32 v208, s99
  v_mov_b32 v209, s99
  s_mov_b32 exec_lo, 0x00010001
  s_mov_b32 exec_hi, 0x00010001
  buffer_store_dwordx4 v[206:209], v201, s[16:19], s95 offen sc1
  s_mov_b64 exec, -1
  s_branch I_67
I_65:
  s_waitcnt vmcnt(0)
  v_cmp_gt_u32 vcc, 50, v1
  s_nop 0
  s_and_saveexec_b64 s[96:97], vcc
  ds_write_b128 v201, v[206:209] offset:2048
  s_mov_b64 exec, -1
  s_getreg_b32 s94, hwreg(HW_REG_XCC_ID, 0, 4)
  s_xor_b32 s94, s94, s99
  s_lshl_b32 s95, s4, 5
  s_add_u32 s95, s95, s5
  s_lshl_b32 s95, s95, 2
  s_add_u32 s95, s95, 0xb9b000
  v_mov_b32 v205, s94
  v_mov_b32 v204, 0
  v_lshlrev_b32 v200, 4, v1
  s_mov_b64 exec, 1
  buffer_store_dword v205, v204, s[16:19], s95 offen sc1
  s_mov_b64 exec, -1
  v_mov_b32 v218, -1
  v_mov_b32 v219, -1
  v_mov_b32 v220, -1
  v_mov_b32 v221, -1
  s_mul_i32 s94, s2, 1280
  s_add_u32 s94, s94, 0xb40000
  buffer_store_dwordx4 v[218:221], v200, s[16:19], s94 offen sc1
  s_mov_b64 exec, 0xffff
  buffer_store_dwordx4 v[218:221], v200, s[16:19], s94 offen offset:1024 sc1
  s_mov_b64 exec, -1
I_66:
  s_cmp_ge_u32 s2, 200
  s_cbranch_scc1 I_67
  s_and_b32 s94, s3, 1
  s_lshl_b32 s63, s94, 12
  s_add_u32 s63, s63, 131072
  v_mov_b32 v218, 0x3f803f80
  v_mov_b32 v219, 0x3f803f80
  v_mov_b32 v220, 0x3f803f80
  v_mov_b32 v221, 0x3f803f80
  v_lshlrev_b32 v222, 4, v1
  v_lshlrev_b32 v223, 4, v2
  v_bfe_u32 v224, v1, 2, 2
  v_lshl_add_u32 v224, v2, 3, v224
  v_lshlrev_b32 v224, 7, v224
  v_and_b32 v225, 3, v1
  v_lshl_add_u32 v224, v225, 3, v224
  s_cmp_eq_u32 s3, 1
  s_cbranch_scc1 I_67w
  s_waitcnt vmcnt(0)
I_67w:
  v_add_u32 v225, s63, v224
  ds_read_b64_tr_b16 v[230:231], v225 offset:0
  ds_read_b64_tr_b16 v[232:233], v225 offset:512
  ds_read_b64_tr_b16 v[234:235], v225 offset:32
  ds_read_b64_tr_b16 v[236:237], v225 offset:544
  ds_read_b64_tr_b16 v[238:239], v225 offset:64
  ds_read_b64_tr_b16 v[240:241], v225 offset:576
  ds_read_b64_tr_b16 v[242:243], v225 offset:96
  ds_read_b64_tr_b16 v[244:245], v225 offset:608
  s_waitcnt lgkmcnt(0)
  buffer_store_dwordx4 v[230:233], v222, s[16:19], s24 offen sc1
  buffer_store_dwordx4 v[234:237], v222, s[16:19], s25 offen sc1
  buffer_store_dwordx4 v[238:241], v222, s[16:19], s26 offen sc1
  buffer_store_dwordx4 v[242:245], v222, s[16:19], s27 offen sc1
  s_cmp_eq_u32 s3, 2
  s_cbranch_scc1 I_67
  v_mfma_f32_16x16x32_bf16 v[200:203], v[230:233], v[218:221], 0
  v_mfma_f32_16x16x32_bf16 v[204:207], v[234:237], v[218:221], 0
  v_mfma_f32_16x16x32_bf16 v[208:211], v[238:241], v[218:221], 0
  v_mfma_f32_16x16x32_bf16 v[212:215], v[242:245], v[218:221], 0
  s_mov_b32 exec_lo, 0x00010001
  s_mov_b32 exec_hi, 0x00010001
  s_nop 2
  buffer_store_dwordx4 v[200:203], v223, s[16:19], s90 offen sc1
  buffer_store_dwordx4 v[204:207], v223, s[16:19], s91 offen sc1
  buffer_store_dwordx4 v[208:211], v223, s[16:19], s88 offen sc1
  buffer_store_dwordx4 v[212:215], v223, s[16:19], s89 offen sc1
  s_mov_b64 exec, -1
NC_70:
  s_nop 1
I_67:
  s_waitcnt lgkmcnt(0)
  s_barrier
  ds_read_b128 v[136:139], v8 offset:0
  ds_read_b64_tr_b16 v[152:153], v10 offset:0
  ds_read_b64_tr_b16 v[154:155], v10 offset:1024
  ds_read_b128 v[140:143], v8 offset:2048
  ds_read_b64_tr_b16 v[156:157], v10 offset:8
  ds_read_b64_tr_b16 v[158:159], v10 offset:1032
  ds_read_b128 v[144:147], v8 offset:4096
  ds_read_b64_tr_b16 v[160:161], v11 offset:0
  ds_read_b64_tr_b16 v[162:163], v11 offset:1024
  ds_read_b128 v[148:151], v8 offset:6144
  ds_read_b64_tr_b16 v[164:165], v11 offset:8
  ds_read_b64_tr_b16 v[166:167], v11 offset:1032
  .p2align 6
LP_71:
  s_waitcnt lgkmcnt(0)
  v_mfma_f32_16x16x32_bf16 v[64:67], v[152:155], v[136:139], v[64:67]
  ds_read_b128 v[168:171], v9 offset:0
  v_mfma_f32_16x16x32_bf16 v[68:71], v[152:155], v[140:143], v[68:71]
  ds_read_b64_tr_b16 v[184:185], v10 offset:8192
  v_mfma_f32_16x16x32_bf16 v[72:75], v[152:155], v[144:147], v[72:75]
  ds_read_b64_tr_b16 v[186:187], v10 offset:9216
  v_mfma_f32_16x16x32_bf16 v[76:79], v[152:155], v[148:151], v[76:79]
  ds_read_b128 v[172:175], v9 offset:2048
  v_mfma_f32_16x16x32_bf16 v[80:83], v[156:159], v[136:139], v[80:83]
  ds_read_b64_tr_b16 v[188:189], v10 offset:8200
  v_mfma_f32_16x16x32_bf16 v[84:87], v[156:159], v[140:143], v[84:87]
  ds_read_b64_tr_b16 v[190:191], v10 offset:9224
  v_mfma_f32_16x16x32_bf16 v[88:91], v[156:159], v[144:147], v[88:91]
  ds_read_b128 v[176:179], v9 offset:4096
  v_mfma_f32_16x16x32_bf16 v[92:95], v[156:159], v[148:151], v[92:95]
  ds_read_b64_tr_b16 v[192:193], v11 offset:8192
  v_mfma_f32_16x16x32_bf16 v[96:99], v[160:163], v[136:139], v[96:99]
  ds_read_b64_tr_b16 v[194:195], v11 offset:9216
  v_mfma_f32_16x16x32_bf16 v[100:103], v[160:163], v[140:143], v[100:103]
  ds_read_b128 v[180:183], v9 offset:6144
  v_mfma_f32_16x16x32_bf16 v[104:107], v[160:163], v[144:147], v[104:107]
  ds_read_b64_tr_b16 v[196:197], v11 offset:8200
  v_mfma_f32_16x16x32_bf16 v[108:111], v[160:163], v[148:151], v[108:111]
  ds_read_b64_tr_b16 v[198:199], v11 offset:9224
  v_mfma_f32_16x16x32_bf16 v[112:115], v[164:167], v[136:139], v[112:115]
  v_add_u32 v8, 0x8000, v8
  v_and_b32 v8, s60, v8
  v_mfma_f32_16x16x32_bf16 v[116:119], v[164:167], v[140:143], v[116:119]
  v_add_u32 v9, 0x8000, v9
  v_and_b32 v9, s60, v9
  v_mfma_f32_16x16x32_bf16 v[120:123], v[164:167], v[144:147], v[120:123]
  v_add_u32 v10, 0x8000, v10
  v_and_b32 v10, s60, v10
  v_mfma_f32_16x16x32_bf16 v[124:127], v[164:167], v[148:151], v[124:127]
  v_add_u32 v11, 0x8000, v11
  v_and_b32 v11, s60, v11
  v_mfma_f32_16x16x32_bf16 v[128:131], v[152:155], v[56:59], v[128:131]
  v_mfma_f32_16x16x32_bf16 v[132:135], v[156:159], v[56:59], v[132:135]
  s_cmp_eq_u32 s59, 9
  s_cbranch_scc1 FN_75
R2_74:
  s_waitcnt lgkmcnt(0)
  s_barrier
  v_mfma_f32_16x16x32_bf16 v[64:67], v[184:187], v[168:171], v[64:67]
  ds_read_b128 v[136:139], v8 offset:0
  v_mfma_f32_16x16x32_bf16 v[68:71], v[184:187], v[172:175], v[68:71]
  ds_read_b64_tr_b16 v[152:153], v10 offset:0
  v_mfma_f32_16x16x32_bf16 v[72:75], v[184:187], v[176:179], v[72:75]
  ds_read_b64_tr_b16 v[154:155], v10 offset:1024
  v_mfma_f32_16x16x32_bf16 v[76:79], v[184:187], v[180:183], v[76:79]
  ds_read_b128 v[140:143], v8 offset:2048
  v_mfma_f32_16x16x32_bf16 v[80:83], v[188:191], v[168:171], v[80:83]
  ds_read_b64_tr_b16 v[156:157], v10 offset:8
  v_mfma_f32_16x16x32_bf16 v[84:87], v[188:191], v[172:175], v[84:87]
  ds_read_b64_tr_b16 v[158:159], v10 offset:1032
  v_mfma_f32_16x16x32_bf16 v[88:91], v[188:191], v[176:179], v[88:91]
  ds_read_b128 v[144:147], v8 offset:4096
  v_mfma_f32_16x16x32_bf16 v[92:95], v[188:191], v[180:183], v[92:95]
  ds_read_b64_tr_b16 v[160:161], v11 offset:0
  v_mfma_f32_16x16x32_bf16 v[96:99], v[192:195], v[168:171], v[96:99]
  ds_read_b64_tr_b16 v[162:163], v11 offset:1024
  v_mfma_f32_16x16x32_bf16 v[100:103], v[192:195], v[172:175], v[100:103]
  ds_read_b128 v[148:151], v8 offset:6144
  v_mfma_f32_16x16x32_bf16 v[104:107], v[192:195], v[176:179], v[104:107]
  ds_read_b64_tr_b16 v[164:165], v11 offset:8
  v_mfma_f32_16x16x32_bf16 v[108:111], v[192:195], v[180:183], v[108:111]
  ds_read_b64_tr_b16 v[166:167], v11 offset:1032
  v_mfma_f32_16x16x32_bf16 v[112:115], v[196:199], v[168:171], v[112:115]
  v_mfma_f32_16x16x32_bf16 v[116:119], v[196:199], v[172:175], v[116:119]
  v_mfma_f32_16x16x32_bf16 v[120:123], v[196:199], v[176:179], v[120:123]
  v_mfma_f32_16x16x32_bf16 v[124:127], v[196:199], v[180:183], v[124:127]
  v_mfma_f32_16x16x32_bf16 v[128:131], v[184:187], v[56:59], v[128:131]
  v_mfma_f32_16x16x32_bf16 v[132:135], v[188:191], v[56:59], v[132:135]
  s_add_u32 s59, s59, 1
  s_cmp_eq_u32 s59, 1
  s_cbranch_scc1 X1_72
  s_cmp_lg_u32 s59, 7
  s_cbranch_scc1 LP_71
  v_and_b32 v42, 31, v1
  v_lshlrev_b32 v42, 2, v42
  s_lshl_b32 s98, s4, 7
  s_add_u32 s98, s98, 0xb9b000
  buffer_load_dword v44, v42, s[16:19], s98 offen sc1
  buffer_load_dwordx4 v[20:23], v36, s[16:19], s42 offen offset:0 sc1
  buffer_load_dwordx4 v[24:27], v36, s[16:19], s42 offen offset:256 sc1
  buffer_load_dwordx4 v[28:31], v36, s[16:19], s42 offen offset:512 sc1
  buffer_load_dwordx4 v[32:35], v36, s[16:19], s42 offen offset:768 sc1
  buffer_load_dword v19, v41, s[16:19], s40 offen sc1
  s_branch LP_71
X1_72:
  s_sub_u32 s94, s3, 1
  s_cmp_gt_u32 s94, 1
  s_cbranch_scc1 LP_71
  s_cmp_ge_u32 s2, 200
  s_cbranch_scc1 LP_71
  s_and_b32 s94, s3, 1
  s_mul_i32 s94, s94, 200
  s_add_u32 s94, s94, s2
  s_lshl_b32 s94, s94, 2
  s_add_u32 s94, s94, 0xb99000
  s_waitcnt vmcnt(0)
  s_mov_b64 exec, 1
  buffer_store_dword v252, v41, s[16:19], s94 offen sc1
  s_mov_b64 exec, -1
  s_branch LP_71
FN_75:
  s_waitcnt lgkmcnt(0)
  v_mfma_f32_16x16x32_bf16 v[64:67], v[184:187], v[168:171], v[64:67]
  v_mfma_f32_16x16x32_bf16 v[68:71], v[184:187], v[172:175], v[68:71]
  v_mfma_f32_16x16x32_bf16 v[72:75], v[184:187], v[176:179], v[72:75]
  v_mfma_f32_16x16x32_bf16 v[76:79], v[184:187], v[180:183], v[76:79]
  v_mfma_f32_16x16x32_bf16 v[80:83], v[188:191], v[168:171], v[80:83]
  v_mfma_f32_16x16x32_bf16 v[84:87], v[188:191], v[172:175], v[84:87]
  v_mfma_f32_16x16x32_bf16 v[88:91], v[188:191], v[176:179], v[88:91]
  v_mfma_f32_16x16x32_bf16 v[92:95], v[188:191], v[180:183], v[92:95]
  v_mfma_f32_16x16x32_bf16 v[96:99], v[192:195], v[168:171], v[96:99]
  v_mfma_f32_16x16x32_bf16 v[100:103], v[192:195], v[172:175], v[100:103]
  v_mfma_f32_16x16x32_bf16 v[104:107], v[192:195], v[176:179], v[104:107]
  v_mfma_f32_16x16x32_bf16 v[108:111], v[192:195], v[180:183], v[108:111]
  v_mfma_f32_16x16x32_bf16 v[112:115], v[196:199], v[168:171], v[112:115]
  v_mfma_f32_16x16x32_bf16 v[116:119], v[196:199], v[172:175], v[116:119]
  v_mfma_f32_16x16x32_bf16 v[120:123], v[196:199], v[176:179], v[120:123]
  v_mfma_f32_16x16x32_bf16 v[124:127], v[196:199], v[180:183], v[124:127]
  v_mfma_f32_16x16x32_bf16 v[128:131], v[184:187], v[56:59], v[128:131]
  v_mfma_f32_16x16x32_bf16 v[132:135], v[188:191], v[56:59], v[132:135]
  s_nop 6
  ds_write_b128 v38, v[128:131] offset:0
  ds_write_b128 v38, v[132:135] offset:64
  s_mov_b32 s7, 400000
  s_waitcnt vmcnt(0)
  s_branch PE_78
P_76:
  buffer_load_dword v44, v42, s[16:19], s98 offen sc1
  s_waitcnt vmcnt(0)
PE_78:
  v_xor_b32 v44, s99, v44
  v_cmp_lt_u32 vcc, 15, v44
  s_nop 0
  s_cbranch_vccz PD_77
  s_sleep 20
  s_sub_u32 s7, s7, 1
  s_cbranch_scc0 P_76
PD_77:
  s_getreg_b32 s94, hwreg(HW_REG_XCC_ID, 0, 4)
  v_cmp_ne_u32 vcc, s94, v44
  s_nop 1
  s_cmp_eq_u64 vcc, 0
  s_cselect_b32 s6, 1, 0
  s_mov_b32 s7, 400000
  s_waitcnt vmcnt(0)
  s_branch PE_81
P_79:
  buffer_load_dwordx4 v[20:23], v36, s[16:19], s42 offen offset:0 sc1
  buffer_load_dwordx4 v[24:27], v36, s[16:19], s42 offen offset:256 sc1
  buffer_load_dwordx4 v[28:31], v36, s[16:19], s42 offen offset:512 sc1
  buffer_load_dwordx4 v[32:35], v36, s[16:19], s42 offen offset:768 sc1
  s_waitcnt vmcnt(0)
PE_81:
  v_xor_b32 v22, s99, v22
  v_xor_b32 v26, s99, v26
  v_xor_b32 v30, s99, v30
  v_xor_b32 v34, s99, v34
  v_or3_b32 v22, v22, v26, v30
  v_or_b32 v22, v22, v34
  v_cmp_ne_u32 vcc, 0, v22
  s_nop 0
  s_cbranch_vccz PD_80
  s_sleep 2
  s_sub_u32 s7, s7, 1
  s_cbranch_scc0 P_79
PD_80:
  v_pk_mul_f32 v[64:65], v[64:65], v[20:21] op_sel:[0,1] op_sel_hi:[1,1]
  v_pk_mul_f32 v[66:67], v[66:67], v[20:21] op_sel:[0,1] op_sel_hi:[1,1]
  v_pk_fma_f32 v[64:65], v[128:129], v[20:21], v[64:65] op_sel_hi:[1,0,1] neg_lo:[0,1,0] neg_hi:[0,1,0]
  v_pk_fma_f32 v[66:67], v[130:131], v[20:21], v[66:67] op_sel_hi:[1,0,1] neg_lo:[0,1,0] neg_hi:[0,1,0]
  v_pk_mul_f32 v[80:81], v[80:81], v[20:21] op_sel:[0,1] op_sel_hi:[1,1]
  v_pk_mul_f32 v[82:83], v[82:83], v[20:21] op_sel:[0,1] op_sel_hi:[1,1]
  v_pk_fma_f32 v[80:81], v[132:133], v[20:21], v[80:81] op_sel_hi:[1,0,1] neg_lo:[0,1,0] neg_hi:[0,1,0]
  v_pk_fma_f32 v[82:83], v[134:135], v[20:21], v[82:83] op_sel_hi:[1,0,1] neg_lo:[0,1,0] neg_hi:[0,1,0]
  v_cvt_pk_bf16_f32 v136, v64, v65
  v_cvt_pk_bf16_f32 v137, v66, v67
  v_cvt_pk_bf16_f32 v138, v80, v81
  v_cvt_pk_bf16_f32 v139, v82, v83
  buffer_store_dwordx4 v[136:139], v46, s[28:31], s36 offen sc1
  v_pk_mul_f32 v[68:69], v[68:69], v[24:25] op_sel:[0,1] op_sel_hi:[1,1]
  v_pk_mul_f32 v[70:71], v[70:71], v[24:25] op_sel:[0,1] op_sel_hi:[1,1]
  v_pk_fma_f32 v[68:69], v[128:129], v[24:25], v[68:69] op_sel_hi:[1,0,1] neg_lo:[0,1,0] neg_hi:[0,1,0]
  v_pk_fma_f32 v[70:71], v[130:131], v[24:25], v[70:71] op_sel_hi:[1,0,1] neg_lo:[0,1,0] neg_hi:[0,1,0]
  v_pk_mul_f32 v[84:85], v[84:85], v[24:25] op_sel:[0,1] op_sel_hi:[1,1]
  v_pk_mul_f32 v[86:87], v[86:87], v[24:25] op_sel:[0,1] op_sel_hi:[1,1]
  v_pk_fma_f32 v[84:85], v[132:133], v[24:25], v[84:85] op_sel_hi:[1,0,1] neg_lo:[0,1,0] neg_hi:[0,1,0]
  v_pk_fma_f32 v[86:87], v[134:135], v[24:25], v[86:87] op_sel_hi:[1,0,1] neg_lo:[0,1,0] neg_hi:[0,1,0]
  v_cvt_pk_bf16_f32 v140, v68, v69
  v_cvt_pk_bf16_f32 v141, v70, v71
  v_cvt_pk_bf16_f32 v142, v84, v85
  v_cvt_pk_bf16_f32 v143, v86, v87
  buffer_store_dwordx4 v[140:143], v46, s[28:31], s37 offen sc1
  v_pk_mul_f32 v[72:73], v[72:73], v[28:29] op_sel:[0,1] op_sel_hi:[1,1]
  v_pk_mul_f32 v[74:75], v[74:75], v[28:29] op_sel:[0,1] op_sel_hi:[1,1]
  v_pk_fma_f32 v[72:73], v[128:129], v[28:29], v[72:73] op_sel_hi:[1,0,1] neg_lo:[0,1,0] neg_hi:[0,1,0]
  v_pk_fma_f32 v[74:75], v[130:131], v[28:29], v[74:75] op_sel_hi:[1,0,1] neg_lo:[0,1,0] neg_hi:[0,1,0]
  v_pk_mul_f32 v[88:89], v[88:89], v[28:29] op_sel:[0,1] op_sel_hi:[1,1]
  v_pk_mul_f32 v[90:91], v[90:91], v[28:29] op_sel:[0,1] op_sel_hi:[1,1]
  v_pk_fma_f32 v[88:89], v[132:133], v[28:29], v[88:89] op_sel_hi:[1,0,1] neg_lo:[0,1,0] neg_hi:[0,1,0]
  v_pk_fma_f32 v[90:91], v[134:135], v[28:29], v[90:91] op_sel_hi:[1,0,1] neg_lo:[0,1,0] neg_hi:[0,1,0]
  v_cvt_pk_bf16_f32 v144, v72, v73
  v_cvt_pk_bf16_f32 v145, v74, v75
  v_cvt_pk_bf16_f32 v146, v88, v89
  v_cvt_pk_bf16_f32 v147, v90, v91
  buffer_store_dwordx4 v[144:147], v46, s[28:31], s38 offen sc1
  s_waitcnt lgkmcnt(0)
  s_barrier
  ds_read_b128 v[48:51], v39 offset:0
  ds_read_b128 v[52:55], v39 offset:64
  v_pk_mul_f32 v[76:77], v[76:77], v[32:33] op_sel:[0,1] op_sel_hi:[1,1]
  v_pk_mul_f32 v[78:79], v[78:79], v[32:33] op_sel:[0,1] op_sel_hi:[1,1]
  v_pk_fma_f32 v[76:77], v[128:129], v[32:33], v[76:77] op_sel_hi:[1,0,1] neg_lo:[0,1,0] neg_hi:[0,1,0]
  v_pk_fma_f32 v[78:79], v[130:131], v[32:33], v[78:79] op_sel_hi:[1,0,1] neg_lo:[0,1,0] neg_hi:[0,1,0]
  v_pk_mul_f32 v[92:93], v[92:93], v[32:33] op_sel:[0,1] op_sel_hi:[1,1]
  v_pk_mul_f32 v[94:95], v[94:95], v[32:33] op_sel:[0,1] op_sel_hi:[1,1]
  v_pk_fma_f32 v[92:93], v[132:133], v[32:33], v[92:93] op_sel_hi:[1,0,1] neg_lo:[0,1,0] neg_hi:[0,1,0]
  v_pk_fma_f32 v[94:95], v[134:135], v[32:33], v[94:95] op_sel_hi:[1,0,1] neg_lo:[0,1,0] neg_hi:[0,1,0]
  v_cvt_pk_bf16_f32 v148, v76, v77
  v_cvt_pk_bf16_f32 v149, v78, v79
  v_cvt_pk_bf16_f32 v150, v92, v93
  v_cvt_pk_bf16_f32 v151, v94, v95
  buffer_store_dwordx4 v[148:151], v46, s[28:31], s39 offen sc1
  s_waitcnt lgkmcnt(0)
  v_pk_mul_f32 v[96:97], v[96:97], v[20:21] op_sel:[0,1] op_sel_hi:[1,1]
  v_pk_mul_f32 v[98:99], v[98:99], v[20:21] op_sel:[0,1] op_sel_hi:[1,1]
  v_pk_fma_f32 v[96:97], v[48:49], v[20:21], v[96:97] op_sel_hi:[1,0,1] neg_lo:[0,1,0] neg_hi:[0,1,0]
  v_pk_fma_f32 v[98:99], v[50:51], v[20:21], v[98:99] op_sel_hi:[1,0,1] neg_lo:[0,1,0] neg_hi:[0,1,0]
  v_pk_mul_f32 v[112:113], v[112:113], v[20:21] op_sel:[0,1] op_sel_hi:[1,1]
  v_pk_mul_f32 v[114:115], v[114:115], v[20:21] op_sel:[0,1] op_sel_hi:[1,1]
  v_pk_fma_f32 v[112:113], v[52:53], v[20:21], v[112:113] op_sel_hi:[1,0,1] neg_lo:[0,1,0] neg_hi:[0,1,0]
  v_pk_fma_f32 v[114:115], v[54:55], v[20:21], v[114:115] op_sel_hi:[1,0,1] neg_lo:[0,1,0] neg_hi:[0,1,0]
  v_cvt_pk_bf16_f32 v152, v96, v97
  v_cvt_pk_bf16_f32 v153, v98, v99
  v_cvt_pk_bf16_f32 v154, v112, v113
  v_cvt_pk_bf16_f32 v155, v114, v115
  buffer_store_dwordx4 v[152:155], v47, s[28:31], s36 offen sc1
  v_pk_mul_f32 v[100:101], v[100:101], v[24:25] op_sel:[0,1] op_sel_hi:[1,1]
  v_pk_mul_f32 v[102:103], v[102:103], v[24:25] op_sel:[0,1] op_sel_hi:[1,1]
  v_pk_fma_f32 v[100:101], v[48:49], v[24:25], v[100:101] op_sel_hi:[1,0,1] neg_lo:[0,1,0] neg_hi:[0,1,0]
  v_pk_fma_f32 v[102:103], v[50:51], v[24:25], v[102:103] op_sel_hi:[1,0,1] neg_lo:[0,1,0] neg_hi:[0,1,0]
  v_pk_mul_f32 v[116:117], v[116:117], v[24:25] op_sel:[0,1] op_sel_hi:[1,1]
  v_pk_mul_f32 v[118:119], v[118:119], v[24:25] op_sel:[0,1] op_sel_hi:[1,1]
  v_pk_fma_f32 v[116:117], v[52:53], v[24:25], v[116:117] op_sel_hi:[1,0,1] neg_lo:[0,1,0] neg_hi:[0,1,0]
  v_pk_fma_f32 v[118:119], v[54:55], v[24:25], v[118:119] op_sel_hi:[1,0,1] neg_lo:[0,1,0] neg_hi:[0,1,0]
  v_cvt_pk_bf16_f32 v156, v100, v101
  v_cvt_pk_bf16_f32 v157, v102, v103
  v_cvt_pk_bf16_f32 v158, v116, v117
  v_cvt_pk_bf16_f32 v159, v118, v119
  buffer_store_dwordx4 v[156:159], v47, s[28:31], s37 offen sc1
  v_pk_mul_f32 v[104:105], v[104:105], v[28:29] op_sel:[0,1] op_sel_hi:[1,1]
  v_pk_mul_f32 v[106:107], v[106:107], v[28:29] op_sel:[0,1] op_sel_hi:[1,1]
  v_pk_fma_f32 v[104:105], v[48:49], v[28:29], v[104:105] op_sel_hi:[1,0,1] neg_lo:[0,1,0] neg_hi:[0,1,0]
  v_pk_fma_f32 v[106:107], v[50:51], v[28:29], v[106:107] op_sel_hi:[1,0,1] neg_lo:[0,1,0] neg_hi:[0,1,0]
  v_pk_mul_f32 v[120:121], v[120:121], v[28:29] op_sel:[0,1] op_sel_hi:[1,1]
  v_pk_mul_f32 v[122:123], v[122:123], v[28:29] op_sel:[0,1] op_sel_hi:[1,1]
  v_pk_fma_f32 v[120:121], v[52:53], v[28:29], v[120:121] op_sel_hi:[1,0,1] neg_lo:[0,1,0] neg_hi:[0,1,0]
  v_pk_fma_f32 v[122:123], v[54:55], v[28:29], v[122:123] op_sel_hi:[1,0,1] neg_lo:[0,1,0] neg_hi:[0,1,0]
  v_cvt_pk_bf16_f32 v160, v104, v105
  v_cvt_pk_bf16_f32 v161, v106, v107
  v_cvt_pk_bf16_f32 v162, v120, v121
  v_cvt_pk_bf16_f32 v163, v122, v123
  buffer_store_dwordx4 v[160:163], v47, s[28:31], s38 offen sc1
  v_pk_mul_f32 v[108:109], v[108:109], v[32:33] op_sel:[0,1] op_sel_hi:[1,1]
  v_pk_mul_f32 v[110:111], v[110:111], v[32:33] op_sel:[0,1] op_sel_hi:[1,1]
  v_pk_fma_f32 v[108:109], v[48:49], v[32:33], v[108:109] op_sel_hi:[1,0,1] neg_lo:[0,1,0] neg_hi:[0,1,0]
  v_pk_fma_f32 v[110:111], v[50:51], v[32:33], v[110:111] op_sel_hi:[1,0,1] neg_lo:[0,1,0] neg_hi:[0,1,0]
  v_pk_mul_f32 v[124:125], v[124:125], v[32:33] op_sel:[0,1] op_sel_hi:[1,1]
  v_pk_mul_f32 v[126:127], v[126:127], v[32:33] op_sel:[0,1] op_sel_hi:[1,1]
  v_pk_fma_f32 v[124:125], v[52:53], v[32:33], v[124:125] op_sel_hi:[1,0,1] neg_lo:[0,1,0] neg_hi:[0,1,0]
  v_pk_fma_f32 v[126:127], v[54:55], v[32:33], v[126:127] op_sel_hi:[1,0,1] neg_lo:[0,1,0] neg_hi:[0,1,0]
  v_cvt_pk_bf16_f32 v164, v108, v109
  v_cvt_pk_bf16_f32 v165, v110, v111
  v_cvt_pk_bf16_f32 v166, v124, v125
  v_cvt_pk_bf16_f32 v167, v126, v127
  buffer_store_dwordx4 v[164:167], v47, s[28:31], s39 offen sc1
  s_cmp_eq_u32 s6, 0
  s_cbranch_scc1 SL_82
  s_waitcnt vmcnt(0)
  s_mov_b64 exec, 1
  buffer_store_dword v252, v41, s[16:19], s40 offen
  s_mov_b64 exec, -1
  s_branch SE_83
SL_82:
  s_nop 1
  s_waitcnt vmcnt(0)
  s_mov_b64 exec, 1
  buffer_store_dword v252, v41, s[16:19], s40 offen sc1
  s_mov_b64 exec, -1
SE_83:
L_c3:
  s_setprio 1
  s_lshr_b32 s58, s5, 1
  s_mul_i32 s58, s58, 5
  s_lshl_b32 s32, s48, 1
  s_add_u32 s58, s58, s32
  v_bfe_u32 v6, v1, 2, 2
  v_and_b32 v7, 3, v1
  s_mul_i32 s32, s48, 160
  s_sub_u32 s32, 145408, s32
  v_mul_u32_u24 v8, 40, v6
  v_add_u32 v8, s32, v8
  v_mov_b32 v9, 0x23000
  v_cmp_eq_u32 vcc, v7, v2
  s_nop 1
  v_cndmask_b32 v8, v9, v8, vcc
  ds_read_b64_tr_b16 v[28:29], v8 offset:0
  ds_read_b64_tr_b16 v[30:31], v8 offset:160
  ds_read_b64_tr_b16 v[32:33], v8 offset:8
  ds_read_b64_tr_b16 v[34:35], v8 offset:168
  ds_read_b64_tr_b16 v[36:37], v8 offset:16
  ds_read_b64_tr_b16 v[38:39], v8 offset:176
  ds_read_b64_tr_b16 v[40:41], v8 offset:24
  ds_read_b64_tr_b16 v[42:43], v8 offset:184
  ds_read_b64_tr_b16 v[44:45], v8 offset:32
  ds_read_b64_tr_b16 v[46:47], v8 offset:192
  s_waitcnt lgkmcnt(5)
  ds_read_b64_tr_b16 v[48:49], v8 offset:320
  ds_read_b64_tr_b16 v[50:51], v8 offset:480
  ds_read_b64_tr_b16 v[52:53], v8 offset:328
  ds_read_b64_tr_b16 v[54:55], v8 offset:488
  ds_read_b64_tr_b16 v[56:57], v8 offset:336
  ds_read_b64_tr_b16 v[58:59], v8 offset:496
  ds_read_b64_tr_b16 v[60:61], v8 offset:344
  ds_read_b64_tr_b16 v[62:63], v8 offset:504
  ds_read_b64_tr_b16 v[64:65], v8 offset:352
  ds_read_b64_tr_b16 v[66:67], v8 offset:512
  s_lshl_b32 s49, s4, 2
  s_add_u32 s49, s49, s57
  v_and_b32 v10, 1, v1
  v_lshlrev_b32 v10, 1, v10
  v_bfe_u32 v11, v1, 1, 1
  v_mul_u32_u24 v11, 80, v11
  v_add3_u32 v10, v10, v11, s58
  v_add_u32 v10, 80, v10
  v_lshrrev_b32 v10, 3, v10
  v_lshlrev_b32 v10, 2, v10
  s_lshl_b32 s32, s49, 7
  s_add_u32 s32, s32, 0xb98000
  v_mul_u32_u24 v12, 20480, v2
  v_lshl_add_u32 v12, v3, 4, v12
  s_mul_i32 s33, s49, 81920
  s_lshl_b32 s34, s58, 8
  s_add_u32 s34, s33, s34
  s_add_u32 s33, s34, 2621440
  s_lshl_b32 s35, s57, 6
  v_add_u32 v13, s35, v1
  v_mul_u32_u24 v14, 48, v13
  v_add_u32 v14, 0x24800, v14
  v_mul_u32_u24 v13, 80, v13
  v_add_u32 v13, 0x19000, v13
  s_mov_b32 s7, 400000
P_84:
  buffer_load_dword v11, v10, s[16:19], s32 offen sc1
  s_waitcnt vmcnt(0)
PE_86:
  v_cmp_ne_u32 vcc, s99, v11
  s_nop 0
  s_cbranch_vccz PD_85
  s_sub_u32 s7, s7, 1
  s_cbranch_scc0 P_84
PD_85:
  buffer_load_dwordx4 v[68:71], v12, s[16:19], s33 offen offset:0 sc1
  buffer_load_dwordx4 v[72:75], v12, s[16:19], s33 offen offset:256 sc1
  buffer_load_dwordx4 v[76:79], v12, s[16:19], s33 offen offset:512 sc1
  buffer_load_dwordx4 v[100:103], v12, s[20:23], s34 offen offset:0 sc1
  buffer_load_dwordx4 v[104:107], v12, s[20:23], s34 offen offset:256 sc1
  buffer_load_dwordx4 v[108:111], v12, s[20:23], s34 offen offset:512 sc1
  v_mov_b32 v15, 0x23be0
  s_mov_b64 exec, 1
  ds_add_u32 v15, v4
  s_mov_b64 exec, -1
  s_waitcnt lgkmcnt(0)
  s_waitcnt vmcnt(5)
  v_mfma_f32_16x16x32_bf16 v[80:83], v[28:31], v[68:71], 0
  v_mfma_f32_16x16x32_bf16 v[84:87], v[32:35], v[68:71], 0
  v_mfma_f32_16x16x32_bf16 v[88:91], v[36:39], v[68:71], 0
  v_mfma_f32_16x16x32_bf16 v[92:95], v[40:43], v[68:71], 0
  v_mfma_f32_16x16x32_bf16 v[96:99], v[44:47], v[68:71], 0
  ds_read_b64_tr_b16 v[28:29], v8 offset:640
  ds_read_b64_tr_b16 v[30:31], v8 offset:800
  ds_read_b64_tr_b16 v[32:33], v8 offset:648
  ds_read_b64_tr_b16 v[34:35], v8 offset:808
  ds_read_b64_tr_b16 v[36:37], v8 offset:656
  ds_read_b64_tr_b16 v[38:39], v8 offset:816
  ds_read_b64_tr_b16 v[40:41], v8 offset:664
  ds_read_b64_tr_b16 v[42:43], v8 offset:824
  ds_read_b64_tr_b16 v[44:45], v8 offset:672
  ds_read_b64_tr_b16 v[46:47], v8 offset:832
  s_waitcnt vmcnt(4)
  v_mfma_f32_16x16x32_bf16 v[80:83], v[48:51], v[72:75], v[80:83]
  v_mfma_f32_16x16x32_bf16 v[84:87], v[52:55], v[72:75], v[84:87]
  v_mfma_f32_16x16x32_bf16 v[88:91], v[56:59], v[72:75], v[88:91]
  v_mfma_f32_16x16x32_bf16 v[92:95], v[60:63], v[72:75], v[92:95]
  v_mfma_f32_16x16x32_bf16 v[96:99], v[64:67], v[72:75], v[96:99]
  s_waitcnt vmcnt(3) lgkmcnt(0)
  v_mfma_f32_16x16x32_bf16 v[80:83], v[28:31], v[76:79], v[80:83]
  v_mfma_f32_16x16x32_bf16 v[84:87], v[32:35], v[76:79], v[84:87]
  v_mfma_f32_16x16x32_bf16 v[88:91], v[36:39], v[76:79], v[88:91]
  v_mfma_f32_16x16x32_bf16 v[92:95], v[40:43], v[76:79], v[92:95]
  v_mfma_f32_16x16x32_bf16 v[96:99], v[44:47], v[76:79], v[96:99]
  s_waitcnt vmcnt(0)
  s_cmp_eq_u32 s48, 1
  s_cbranch_scc1 OD_87
  v_mov_b32 v110, 0x3f80
  v_mov_b32 v111, 0
  s_branch DN_88
OD_87:
  v_mov_b32 v100, 0x3f80
  v_mov_b32 v101, 0
DN_88:
  ds_write_b128 v14, v[100:103] offset:0
  ds_write_b128 v14, v[104:107] offset:16
  ds_write_b128 v14, v[108:111] offset:32
  s_mov_b32 s34, 0x3fb8aa3b
  s_mov_b32 s35, 0x3fb8aa3b
  v_max3_f32 v16, v80, v81, v82
  v_min3_f32 v18, v80, v81, v82
  v_max3_f32 v16, v16, v83, v84
  v_min3_f32 v18, v18, v83, v84
  v_max3_f32 v16, v16, v85, v86
  v_min3_f32 v18, v18, v85, v86
  v_max3_f32 v16, v16, v87, v88
  v_min3_f32 v18, v18, v87, v88
  v_max3_f32 v16, v16, v89, v90
  v_min3_f32 v18, v18, v89, v90
  v_max3_f32 v16, v16, v91, v92
  v_min3_f32 v18, v18, v91, v92
  v_max3_f32 v16, v16, v93, v94
  v_min3_f32 v18, v18, v93, v94
  v_max3_f32 v16, v16, v95, v96
  v_min3_f32 v18, v18, v95, v96
  v_max3_f32 v16, v16, v97, v98
  v_min3_f32 v18, v18, v97, v98
  v_max_f32 v16, v16, v99
  v_min_f32 v18, v18, v99
  v_mul_f32 v16, s34, v16
  v_mul_f32 v18, s34, v18
  v_pk_fma_f32 v[28:29], v[80:81], s[34:35], v[16:17] op_sel_hi:[1,1,0] neg_lo:[0,0,1] neg_hi:[0,0,1]
  v_pk_fma_f32 v[48:49], v[80:81], s[34:35], v[18:19] op_sel_hi:[1,1,0] neg_lo:[1,0,0] neg_hi:[1,0,0]
  v_pk_fma_f32 v[30:31], v[82:83], s[34:35], v[16:17] op_sel_hi:[1,1,0] neg_lo:[0,0,1] neg_hi:[0,0,1]
  v_pk_fma_f32 v[50:51], v[82:83], s[34:35], v[18:19] op_sel_hi:[1,1,0] neg_lo:[1,0,0] neg_hi:[1,0,0]
  v_pk_fma_f32 v[32:33], v[84:85], s[34:35], v[16:17] op_sel_hi:[1,1,0] neg_lo:[0,0,1] neg_hi:[0,0,1]
  v_pk_fma_f32 v[52:53], v[84:85], s[34:35], v[18:19] op_sel_hi:[1,1,0] neg_lo:[1,0,0] neg_hi:[1,0,0]
  v_pk_fma_f32 v[34:35], v[86:87], s[34:35], v[16:17] op_sel_hi:[1,1,0] neg_lo:[0,0,1] neg_hi:[0,0,1]
  v_pk_fma_f32 v[54:55], v[86:87], s[34:35], v[18:19] op_sel_hi:[1,1,0] neg_lo:[1,0,0] neg_hi:[1,0,0]
  v_pk_fma_f32 v[36:37], v[88:89], s[34:35], v[16:17] op_sel_hi:[1,1,0] neg_lo:[0,0,1] neg_hi:[0,0,1]
  v_pk_fma_f32 v[56:57], v[88:89], s[34:35], v[18:19] op_sel_hi:[1,1,0] neg_lo:[1,0,0] neg_hi:[1,0,0]
  v_pk_fma_f32 v[38:39], v[90:91], s[34:35], v[16:17] op_sel_hi:[1,1,0] neg_lo:[0,0,1] neg_hi:[0,0,1]
  v_pk_fma_f32 v[58:59], v[90:91], s[34:35], v[18:19] op_sel_hi:[1,1,0] neg_lo:[1,0,0] neg_hi:[1,0,0]
  v_pk_fma_f32 v[40:41], v[92:93], s[34:35], v[16:17] op_sel_hi:[1,1,0] neg_lo:[0,0,1] neg_hi:[0,0,1]
  v_pk_fma_f32 v[60:61], v[92:93], s[34:35], v[18:19] op_sel_hi:[1,1,0] neg_lo:[1,0,0] neg_hi:[1,0,0]
  v_pk_fma_f32 v[42:43], v[94:95], s[34:35], v[16:17] op_sel_hi:[1,1,0] neg_lo:[0,0,1] neg_hi:[0,0,1]
  v_pk_fma_f32 v[62:63], v[94:95], s[34:35], v[18:19] op_sel_hi:[1,1,0] neg_lo:[1,0,0] neg_hi:[1,0,0]
  v_pk_fma_f32 v[44:45], v[96:97], s[34:35], v[16:17] op_sel_hi:[1,1,0] neg_lo:[0,0,1] neg_hi:[0,0,1]
  v_pk_fma_f32 v[64:65], v[96:97], s[34:35], v[18:19] op_sel_hi:[1,1,0] neg_lo:[1,0,0] neg_hi:[1,0,0]
  v_pk_fma_f32 v[46:47], v[98:99], s[34:35], v[16:17] op_sel_hi:[1,1,0] neg_lo:[0,0,1] neg_hi:[0,0,1]
  v_pk_fma_f32 v[66:67], v[98:99], s[34:35], v[18:19] op_sel_hi:[1,1,0] neg_lo:[1,0,0] neg_hi:[1,0,0]
  v_exp_f32 v28, v28
  v_exp_f32 v29, v29
  v_exp_f32 v30, v30
  v_exp_f32 v31, v31
  v_exp_f32 v32, v32
  v_exp_f32 v33, v33
  v_exp_f32 v34, v34
  v_exp_f32 v35, v35
  v_exp_f32 v36, v36
  v_exp_f32 v37, v37
  v_exp_f32 v38, v38
  v_exp_f32 v39, v39
  v_exp_f32 v40, v40
  v_exp_f32 v41, v41
  v_exp_f32 v42, v42
  v_exp_f32 v43, v43
  v_exp_f32 v44, v44
  v_exp_f32 v45, v45
  v_exp_f32 v46, v46
  v_exp_f32 v47, v47
  v_exp_f32 v48, v48
  v_exp_f32 v49, v49
  v_exp_f32 v50, v50
  v_exp_f32 v51, v51
  v_exp_f32 v52, v52
  v_exp_f32 v53, v53
  v_exp_f32 v54, v54
  v_exp_f32 v55, v55
  v_exp_f32 v56, v56
  v_exp_f32 v57, v57
  v_exp_f32 v58, v58
  v_exp_f32 v59, v59
  v_exp_f32 v60, v60
  v_exp_f32 v61, v61
  v_exp_f32 v62, v62
  v_exp_f32 v63, v63
  v_exp_f32 v64, v64
  v_exp_f32 v65, v65
  v_exp_f32 v66, v66
  v_exp_f32 v67, v67
  v_pk_add_f32 v[16:17], v[28:29], v[30:31]
  v_pk_add_f32 v[18:19], v[48:49], v[50:51]
  v_pk_add_f32 v[16:17], v[16:17], v[32:33]
  v_pk_add_f32 v[18:19], v[18:19], v[52:53]
  v_pk_add_f32 v[16:17], v[16:17], v[34:35]
  v_pk_add_f32 v[18:19], v[18:19], v[54:55]
  v_pk_add_f32 v[16:17], v[16:17], v[36:37]
  v_pk_add_f32 v[18:19], v[18:19], v[56:57]
  v_pk_add_f32 v[16:17], v[16:17], v[38:39]
  v_pk_add_f32 v[18:19], v[18:19], v[58:59]
  v_pk_add_f32 v[16:17], v[16:17], v[40:41]
  v_pk_add_f32 v[18:19], v[18:19], v[60:61]
  v_pk_add_f32 v[16:17], v[16:17], v[42:43]
  v_pk_add_f32 v[18:19], v[18:19], v[62:63]
  v_pk_add_f32 v[16:17], v[16:17], v[44:45]
  v_pk_add_f32 v[18:19], v[18:19], v[64:65]
  v_pk_add_f32 v[16:17], v[16:17], v[46:47]
  v_pk_add_f32 v[18:19], v[18:19], v[66:67]
  v_add_f32 v16, v16, v17
  v_add_f32 v18, v18, v19
  v_rcp_f32 v16, v16
  v_rcp_f32 v18, v18
  v_pk_mul_f32 v[28:29], v[28:29], v[16:17] op_sel_hi:[1,0]
  v_pk_mul_f32 v[30:31], v[30:31], v[16:17] op_sel_hi:[1,0]
  v_pk_mul_f32 v[32:33], v[32:33], v[16:17] op_sel_hi:[1,0]
  v_pk_mul_f32 v[34:35], v[34:35], v[16:17] op_sel_hi:[1,0]
  v_pk_mul_f32 v[36:37], v[36:37], v[16:17] op_sel_hi:[1,0]
  v_pk_mul_f32 v[38:39], v[38:39], v[16:17] op_sel_hi:[1,0]
  v_pk_mul_f32 v[40:41], v[40:41], v[16:17] op_sel_hi:[1,0]
  v_pk_mul_f32 v[42:43], v[42:43], v[16:17] op_sel_hi:[1,0]
  v_pk_mul_f32 v[44:45], v[44:45], v[16:17] op_sel_hi:[1,0]
  v_pk_mul_f32 v[46:47], v[46:47], v[16:17] op_sel_hi:[1,0]
  v_pk_mul_f32 v[48:49], v[48:49], v[18:19] op_sel_hi:[1,0]
  v_pk_mul_f32 v[50:51], v[50:51], v[18:19] op_sel_hi:[1,0]
  v_pk_mul_f32 v[52:53], v[52:53], v[18:19] op_sel_hi:[1,0]
  v_pk_mul_f32 v[54:55], v[54:55], v[18:19] op_sel_hi:[1,0]
  v_pk_mul_f32 v[56:57], v[56:57], v[18:19] op_sel_hi:[1,0]
  v_pk_mul_f32 v[58:59], v[58:59], v[18:19] op_sel_hi:[1,0]
  v_pk_mul_f32 v[60:61], v[60:61], v[18:19] op_sel_hi:[1,0]
  v_pk_mul_f32 v[62:63], v[62:63], v[18:19] op_sel_hi:[1,0]
  v_pk_mul_f32 v[64:65], v[64:65], v[18:19] op_sel_hi:[1,0]
  v_pk_mul_f32 v[66:67], v[66:67], v[18:19] op_sel_hi:[1,0]
  v_cvt_pk_bf16_f32 v80, v28, v29
  v_cvt_pk_bf16_f32 v81, v30, v31
  v_cvt_pk_bf16_f32 v82, v32, v33
  v_cvt_pk_bf16_f32 v83, v34, v35
  v_cvt_pk_bf16_f32 v84, v36, v37
  v_cvt_pk_bf16_f32 v85, v38, v39
  v_cvt_pk_bf16_f32 v86, v40, v41
  v_cvt_pk_bf16_f32 v87, v42, v43
  v_cvt_pk_bf16_f32 v88, v44, v45
  v_cvt_pk_bf16_f32 v89, v46, v47
  v_cvt_pk_bf16_f32 v90, v48, v49
  v_cvt_pk_bf16_f32 v91, v50, v51
  v_cvt_pk_bf16_f32 v92, v52, v53
  v_cvt_pk_bf16_f32 v93, v54, v55
  v_cvt_pk_bf16_f32 v94, v56, v57
  v_cvt_pk_bf16_f32 v95, v58, v59
  v_cvt_pk_bf16_f32 v96, v60, v61
  v_cvt_pk_bf16_f32 v97, v62, v63
  v_cvt_pk_bf16_f32 v98, v64, v65
  v_cvt_pk_bf16_f32 v99, v66, v67
  ds_write_b128 v13, v[80:83] offset:0
  ds_write_b128 v13, v[84:87] offset:16
  ds_write_b128 v13, v[88:91] offset:32
  ds_write_b128 v13, v[92:95] offset:48
  ds_write_b128 v13, v[96:99] offset:64
  s_waitcnt lgkmcnt(0)
  v_mov_b32 v15, 0x23be4
  s_mov_b64 exec, 1
  ds_add_u32 v15, v4
  s_mov_b64 exec, -1
  s_cmp_eq_u32 s3, 3
  s_cbranch_scc1 KVS_89
  v_lshl_add_u32 v8, v2, 3, v6
  s_lshl_b32 s32, s3, 5
  s_add_u32 s32, s32, 102400
  v_mul_u32_u24 v9, 80, v8
  v_lshl_add_u32 v9, v7, 3, v9
  v_add_u32 v9, s32, v9
  s_lshl_b32 s32, s48, 3
  s_add_u32 s32, s32, 149504
  v_mul_u32_u24 v10, 48, v8
  v_add_u32 v10, s32, v10
  v_lshl_add_u32 v20, v7, 3, v10
  s_mul_i32 s33, s48, 48
  s_sub_u32 s33, 40, s33
  v_mov_b32 v12, s33
  v_mov_b32 v21, 32
  v_and_b32 v22, 1, v7
  v_cmp_eq_u32 vcc, 0, v22
  s_nop 1
  v_cndmask_b32 v12, v12, v21, vcc
  v_add_u32 v21, v12, v10
  s_mul_i32 s32, s3, 768
  s_add_u32 s32, s32, 146432
  v_mul_u32_u24 v14, 48, v3
  v_lshl_add_u32 v14, v2, 3, v14
  v_add_u32 v14, s32, v14
  v_mul_u32_u24 v22, 48, v3
  v_and_b32 v23, 1, v2
  v_lshl_add_u32 v22, v23, 3, v22
  v_lshrrev_b32 v23, 1, v2
  v_lshl_add_u32 v22, v23, 2, v22
  s_add_u32 s32, s32, 32
  v_add_u32 v22, s32, v22
  v_lshlrev_b32 v8, 4, v1
  s_mul_i32 s32, s5, 24576
  s_lshl_b32 s33, s3, 10
  s_add_u32 s32, s32, s33
  s_add_u32 s32, s32, 0x1400000
  s_mul_i32 s33, s4, 3072
  s_add_u32 s33, s33, s32
  v_mov_b32 v15, 0x23be4
  s_mov_b32 s7, 4000000
W_90:
  ds_read_b32 v16, v15
  s_waitcnt lgkmcnt(0)
  v_cmp_gt_u32 vcc, 4, v16
  s_nop 0
  s_cbranch_vccz WD_91
  s_sub_u32 s7, s7, 1
  s_cbranch_scc0 W_90
WD_91:
  ds_read_b64_tr_b16 v[64:65], v9 offset:0
  ds_read_b64_tr_b16 v[66:67], v9 offset:320
  ds_read_b64_tr_b16 v[68:69], v20 offset:0
  ds_read_b64_tr_b16 v[70:71], v20 offset:192
  ds_read_b64_tr_b16 v[72:73], v21 offset:0
  ds_read_b64_tr_b16 v[74:75], v21 offset:192
  ds_read_b64_tr_b16 v[76:77], v9 offset:2560
  ds_read_b64_tr_b16 v[78:79], v9 offset:2880
  ds_read_b64_tr_b16 v[80:81], v20 offset:1536
  ds_read_b64_tr_b16 v[82:83], v20 offset:1728
  ds_read_b64_tr_b16 v[84:85], v21 offset:1536
  ds_read_b64_tr_b16 v[86:87], v21 offset:1728
  s_waitcnt lgkmcnt(6)
  v_mfma_f32_16x16x32_bf16 v[160:163], v[68:71], v[64:67], 0
  v_mfma_f32_16x16x32_bf16 v[164:167], v[72:75], v[64:67], 0
  ds_read_b64_tr_b16 v[88:89], v9 offset:5120
  ds_read_b64_tr_b16 v[90:91], v9 offset:5440
  ds_read_b64_tr_b16 v[92:93], v20 offset:3072
  ds_read_b64_tr_b16 v[94:95], v20 offset:3264
  ds_read_b64_tr_b16 v[96:97], v21 offset:3072
  ds_read_b64_tr_b16 v[98:99], v21 offset:3264
  s_waitcnt lgkmcnt(6)
  v_mfma_f32_16x16x32_bf16 v[160:163], v[80:83], v[76:79], v[160:163]
  v_mfma_f32_16x16x32_bf16 v[164:167], v[84:87], v[76:79], v[164:167]
  ds_read_b64_tr_b16 v[100:101], v9 offset:7680
  ds_read_b64_tr_b16 v[102:103], v9 offset:8000
  ds_read_b64_tr_b16 v[104:105], v20 offset:4608
  ds_read_b64_tr_b16 v[106:107], v20 offset:4800
  ds_read_b64_tr_b16 v[108:109], v21 offset:4608
  ds_read_b64_tr_b16 v[110:111], v21 offset:4800
  s_waitcnt lgkmcnt(6)
  v_mfma_f32_16x16x32_bf16 v[160:163], v[92:95], v[88:91], v[160:163]
  v_mfma_f32_16x16x32_bf16 v[164:167], v[96:99], v[88:91], v[164:167]
  ds_read_b64_tr_b16 v[112:113], v9 offset:10240
  ds_read_b64_tr_b16 v[114:115], v9 offset:10560
  ds_read_b64_tr_b16 v[116:117], v20 offset:6144
  ds_read_b64_tr_b16 v[118:119], v20 offset:6336
  ds_read_b64_tr_b16 v[120:121], v21 offset:6144
  ds_read_b64_tr_b16 v[122:123], v21 offset:6336
  s_waitcnt lgkmcnt(6)
  v_mfma_f32_16x16x32_bf16 v[160:163], v[104:107], v[100:103], v[160:163]
  v_mfma_f32_16x16x32_bf16 v[164:167], v[108:111], v[100:103], v[164:167]
  ds_read_b64_tr_b16 v[124:125], v9 offset:12800
  ds_read_b64_tr_b16 v[126:127], v9 offset:13120
  ds_read_b64_tr_b16 v[128:129], v20 offset:7680
  ds_read_b64_tr_b16 v[130:131], v20 offset:7872
  ds_read_b64_tr_b16 v[132:133], v21 offset:7680
  ds_read_b64_tr_b16 v[134:135], v21 offset:7872
  s_waitcnt lgkmcnt(6)
  v_mfma_f32_16x16x32_bf16 v[160:163], v[116:119], v[112:115], v[160:163]
  v_mfma_f32_16x16x32_bf16 v[164:167], v[120:123], v[112:115], v[164:167]
  ds_read_b64_tr_b16 v[136:137], v9 offset:15360
  ds_read_b64_tr_b16 v[138:139], v9 offset:15680
  ds_read_b64_tr_b16 v[140:141], v20 offset:9216
  ds_read_b64_tr_b16 v[142:143], v20 offset:9408
  ds_read_b64_tr_b16 v[144:145], v21 offset:9216
  ds_read_b64_tr_b16 v[146:147], v21 offset:9408
  s_waitcnt lgkmcnt(6)
  v_mfma_f32_16x16x32_bf16 v[160:163], v[128:131], v[124:127], v[160:163]
  v_mfma_f32_16x16x32_bf16 v[164:167], v[132:135], v[124:127], v[164:167]
  ds_read_b64_tr_b16 v[148:149], v9 offset:17920
  ds_read_b64_tr_b16 v[150:151], v9 offset:18240
  ds_read_b64_tr_b16 v[152:153], v20 offset:10752
  ds_read_b64_tr_b16 v[154:155], v20 offset:10944
  ds_read_b64_tr_b16 v[156:157], v21 offset:10752
  ds_read_b64_tr_b16 v[158:159], v21 offset:10944
  s_waitcnt lgkmcnt(6)
  v_mfma_f32_16x16x32_bf16 v[160:163], v[140:143], v[136:139], v[160:163]
  v_mfma_f32_16x16x32_bf16 v[164:167], v[144:147], v[136:139], v[164:167]
  s_waitcnt lgkmcnt(0)
  v_mfma_f32_16x16x32_bf16 v[160:163], v[152:155], v[148:151], v[160:163]
  v_mfma_f32_16x16x32_bf16 v[164:167], v[156:159], v[148:151], v[164:167]
  v_cmp_le_u32 vcc, 32, v1
  s_nop 5
  v_cvt_pk_bf16_f32 v168, v160, v161
  v_cvt_pk_bf16_f32 v169, v162, v163
  v_cvt_pk_bf16_f32 v170, v164, v165
  v_cvt_pk_bf16_f32 v171, v166, v167
  v_cndmask_b32 v170, v170, v171, vcc
  v_mov_b32 v171, v252
  buffer_store_dwordx4 v[168:171], v8, s[16:19], s33 offen sc1
  v_mov_b32 v240, v8
  v_mov_b32 v241, v14
  v_mov_b32 v242, v22
  s_mov_b32 s92, s32
  v_mov_b32 v64, v168
  v_mov_b32 v65, v169
  v_mov_b32 v66, v170
  v_mov_b32 v67, v171
  s_and_b32 s49, s5, 3
  s_lshl_b32 s32, s4, 2
  s_add_u32 s49, s49, s32
  s_lshl_b32 s51, s49, 2
  s_add_u32 s51, s51, s3
  s_lshr_b32 s32, s50, 1
  s_mul_i32 s32, s32, 5
  s_and_b32 s48, s50, 1
  s_mul_i32 s52, s48, 3
  s_add_u32 s52, s52, s32
  s_lshl_b32 s53, s52, 10
  s_add_u32 s34, s32, 2
  s_lshl_b32 s54, s34, 10
  s_lshl_b32 s35, s48, 9
  s_add_u32 s54, s54, s35
  v_lshlrev_b32 v5, 4, v1
  v_and_b32 v208, 1, v2
  v_lshrrev_b32 v209, 1, v2
  v_lshl_add_u32 v208, v208, 1, v209
  v_lshlrev_b32 v210, 4, v3
  v_lshl_add_u32 v6, v208, 8, v210
  v_lshl_add_u32 v8, v209, 8, v210
  v_lshlrev_b32 v7, 6, v209
  v_lshl_add_u32 v7, v3, 2, v7
  s_lshl_b32 s33, s51, 4
  v_add_u32 v204, s33, v3
  v_mul_u32_u24 v205, 1280, v204
  s_lshl_b32 s35, s52, 6
  v_lshl_add_u32 v9, v208, 4, v205
  v_add_u32 v9, s35, v9
  s_lshl_b32 s34, s34, 6
  s_lshl_b32 s35, s48, 5
  s_add_u32 s34, s34, s35
  v_lshl_add_u32 v10, v2, 3, v205
  v_add_u32 v10, s34, v10
  v_mov_b32 v11, 0
  s_lshl_b32 s94, s3, 2
  s_add_u32 s94, s94, 146368
  v_mov_b32 v15, s94
  s_lshr_b32 s36, s51, 4
  v_add_u32 v206, -1, v204
  v_lshrrev_b32 v200, 4, v206
  v_lshrrev_b32 v207, 4, v200
  v_and_b32 v211, 1, v200
  v_lshl_add_u32 v211, v207, 1, v211
  v_add_u32 v211, 576, v211
  v_cmp_eq_u32 vcc, s36, v207
  s_nop 1
  v_cndmask_b32 v200, v211, v200, vcc
  v_mul_u32_u24 v200, 20480, v200
  v_and_b32 v207, 15, v206
  v_lshl_add_u32 v200, v207, 4, v200
  v_lshl_add_u32 v200, v2, 8, v200
  v_bfrev_b32 v207, 1
  v_cmp_gt_u32 vcc, 0x800, v206
  s_nop 1
  v_cndmask_b32 v200, v207, v200, vcc
  v_add_u32 v206, 1, v204
  v_lshrrev_b32 v201, 4, v206
  v_lshrrev_b32 v207, 4, v201
  v_and_b32 v211, 1, v201
  v_lshl_add_u32 v211, v207, 1, v211
  v_add_u32 v211, 576, v211
  v_cmp_eq_u32 vcc, s36, v207
  s_nop 1
  v_cndmask_b32 v201, v211, v201, vcc
  v_mul_u32_u24 v201, 20480, v201
  v_and_b32 v207, 15, v206
  v_lshl_add_u32 v201, v207, 4, v201
  v_lshl_add_u32 v201, v2, 8, v201
  v_bfrev_b32 v207, 1
  v_cmp_gt_u32 vcc, 0x800, v206
  s_nop 1
  v_cndmask_b32 v201, v207, v201, vcc
  v_add_u32 v206, -2, v204
  v_lshrrev_b32 v202, 4, v206
  v_lshrrev_b32 v207, 4, v202
  v_and_b32 v211, 1, v202
  v_lshl_add_u32 v211, v207, 1, v211
  v_add_u32 v211, 576, v211
  v_cmp_eq_u32 vcc, s36, v207
  s_nop 1
  v_cndmask_b32 v202, v211, v202, vcc
  v_mul_u32_u24 v202, 20480, v202
  v_and_b32 v207, 15, v206
  v_lshl_add_u32 v202, v207, 4, v202
  v_lshl_add_u32 v202, v2, 8, v202
  v_bfrev_b32 v207, 1
  v_cmp_gt_u32 vcc, 0x800, v206
  s_nop 1
  v_cndmask_b32 v202, v207, v202, vcc
  v_add_u32 v206, 2, v204
  v_lshrrev_b32 v203, 4, v206
  v_lshrrev_b32 v207, 4, v203
  v_and_b32 v211, 1, v203
  v_lshl_add_u32 v211, v207, 1, v211
  v_add_u32 v211, 576, v211
  v_cmp_eq_u32 vcc, s36, v207
  s_nop 1
  v_cndmask_b32 v203, v211, v203, vcc
  v_mul_u32_u24 v203, 20480, v203
  v_and_b32 v207, 15, v206
  v_lshl_add_u32 v203, v207, 4, v203
  v_lshl_add_u32 v203, v2, 8, v203
  v_bfrev_b32 v207, 1
  v_cmp_gt_u32 vcc, 0x800, v206
  s_nop 1
  v_cndmask_b32 v203, v207, v203, vcc
  s_and_b32 s37, s51, 15
  s_mov_b32 s59, 0
  s_cmp_eq_u32 s37, 0
  s_cselect_b32 s59, 1, s59
  s_cmp_eq_u32 s37, 15
  s_cselect_b32 s59, 2, s59
  s_cmp_eq_u32 s51, 0
  s_cselect_b32 s59, 0, s59
  s_cmp_eq_u32 s51, 127
  s_cselect_b32 s59, 0, s59
  v_min_u32 v206, 59, v1
  v_mul_u32_u24 v207, 205, v206
  v_lshrrev_b32 v207, 12, v207
  v_mul_u32_u24 v211, 20, v207
  v_sub_u32 v206, v206, v211
  v_min_u32 v211, 1, v207
  v_mul_u32_u24 v211, 40, v211
  v_add_u32 v206, v206, v211
  v_lshlrev_b32 v206, 8, v206
  v_lshrrev_b32 v207, 1, v207
  v_lshlrev_b32 v207, 4, v207
  s_cmp_eq_u32 s59, 1
  s_cselect_b32 s37, 240, 0
  v_xor_b32 v207, s37, v207
  v_add_u32 v17, v206, v207
  s_mul_i32 s37, s36, 40960
  s_add_u32 s37, s37, 0xb3b000
  s_cmp_eq_u32 s59, 2
  s_cselect_b32 s38, 66560, 0
  s_add_u32 s37, s37, s38
  s_cmp_eq_u32 s59, 0
  s_cselect_b32 s37, 0x80000000, s37
  v_add_u32 v17, s37, v17
  v_mov_b32 v12, v5
  v_add_u32 v13, 0x10000, v5
  v_add_u32 v14, 0x20000, v5
  s_mov_b32 s88, 0xbdd2d3e8
  s_mov_b32 s89, 0xbdd2d3e8
  v_mov_b32 v22, 0xc0135761
  s_mov_b32 s90, 0xffff0000
  buffer_load_dwordx4 v[220:223], v9, s[8:11], 0 offen
  buffer_load_dwordx4 v[224:227], v9, s[8:11], 0 offen offset:64
  buffer_load_dwordx2 v[228:229], v10, s[8:11], 0 offen
  v_lshlrev_b32 v206, 8, v2
  v_lshl_add_u32 v206, v3, 2, v206
  s_lshl_b32 s33, s49, 7
  s_add_u32 s33, s33, 0xb91000
  v_and_b32 v204, 31, v1
  v_lshlrev_b32 v204, 2, v204
  s_mul_i32 s55, s51, 20480
  s_add_u32 s55, s55, 0x0
  s_mul_i32 s40, s51, 20480
  s_add_u32 s40, s40, 0x0
  s_add_u32 s41, s40, s54
  s_add_u32 s40, s40, s53
  s_lshl_b32 s42, s51, 3
  s_add_u32 s42, s42, s50
  s_mul_i32 s43, s51, 20480
  s_lshl_b32 s94, s50, 7
  s_add_u32 s43, s43, s94
  s_add_u32 s43, s43, 0x280000
  s_lshl_b32 s42, s42, 2
  s_add_u32 s42, s42, 0xb92000
  s_mov_b32 s7, 400000
P_92:
  s_add_u32 s93, s4, 1
  s_and_b32 s93, s93, 7
  s_mul_i32 s93, s93, 3072
  s_add_u32 s93, s93, s92
  buffer_load_dwordx4 v[68:71], v240, s[16:19], s93 offen sc1
  s_add_u32 s93, s4, 2
  s_and_b32 s93, s93, 7
  s_mul_i32 s93, s93, 3072
  s_add_u32 s93, s93, s92
  buffer_load_dwordx4 v[72:75], v240, s[16:19], s93 offen sc1
  s_add_u32 s93, s4, 3
  s_and_b32 s93, s93, 7
  s_mul_i32 s93, s93, 3072
  s_add_u32 s93, s93, s92
  buffer_load_dwordx4 v[76:79], v240, s[16:19], s93 offen sc1
  s_add_u32 s93, s4, 4
  s_and_b32 s93, s93, 7
  s_mul_i32 s93, s93, 3072
  s_add_u32 s93, s93, s92
  buffer_load_dwordx4 v[80:83], v240, s[16:19], s93 offen sc1
  s_add_u32 s93, s4, 5
  s_and_b32 s93, s93, 7
  s_mul_i32 s93, s93, 3072
  s_add_u32 s93, s93, s92
  buffer_load_dwordx4 v[84:87], v240, s[16:19], s93 offen sc1
  s_add_u32 s93, s4, 6
  s_and_b32 s93, s93, 7
  s_mul_i32 s93, s93, 3072
  s_add_u32 s93, s93, s92
  buffer_load_dwordx4 v[88:91], v240, s[16:19], s93 offen sc1
  s_add_u32 s93, s4, 7
  s_and_b32 s93, s93, 7
  s_mul_i32 s93, s93, 3072
  s_add_u32 s93, s93, s92
  buffer_load_dwordx4 v[92:95], v240, s[16:19], s93 offen sc1
  s_waitcnt vmcnt(0)
PE_94:
  v_and_b32 v244, v67, v71
  v_or_b32 v246, v67, v71
  v_bitop3_b32 v244, v244, v75, v79 bitop3:0x80
  v_or3_b32 v246, v246, v75, v79
  v_bitop3_b32 v244, v244, v83, v87 bitop3:0x80
  v_or3_b32 v246, v246, v83, v87
  v_bitop3_b32 v244, v244, v91, v95 bitop3:0x80
  v_or3_b32 v246, v246, v91, v95
  v_xor_b32 v244, s99, v244
  v_xor_b32 v246, s99, v246
  v_or_b32 v244, v244, v246
  v_cmp_ne_u32 vcc, 0, v244
  s_nop 0
  s_cbranch_vccz PD_93
  s_sub_u32 s7, s7, 1
  s_cbranch_scc0 P_92
PD_93:
  v_lshlrev_b32 v100, 16, v64
  v_and_b32 v101, s90, v64
  v_lshlrev_b32 v102, 16, v65
  v_and_b32 v103, s90, v65
  v_lshlrev_b32 v104, 16, v66
  v_and_b32 v105, s90, v66
  v_lshlrev_b32 v106, 16, v68
  v_and_b32 v107, s90, v68
  v_lshlrev_b32 v108, 16, v69
  v_and_b32 v109, s90, v69
  v_lshlrev_b32 v110, 16, v70
  v_and_b32 v111, s90, v70
  v_pk_add_f32 v[100:101], v[100:101], v[106:107]
  v_pk_add_f32 v[102:103], v[102:103], v[108:109]
  v_pk_add_f32 v[104:105], v[104:105], v[110:111]
  v_lshlrev_b32 v106, 16, v72
  v_and_b32 v107, s90, v72
  v_lshlrev_b32 v108, 16, v73
  v_and_b32 v109, s90, v73
  v_lshlrev_b32 v110, 16, v74
  v_and_b32 v111, s90, v74
  v_pk_add_f32 v[100:101], v[100:101], v[106:107]
  v_pk_add_f32 v[102:103], v[102:103], v[108:109]
  v_pk_add_f32 v[104:105], v[104:105], v[110:111]
  v_lshlrev_b32 v106, 16, v76
  v_and_b32 v107, s90, v76
  v_lshlrev_b32 v108, 16, v77
  v_and_b32 v109, s90, v77
  v_lshlrev_b32 v110, 16, v78
  v_and_b32 v111, s90, v78
  v_pk_add_f32 v[100:101], v[100:101], v[106:107]
  v_pk_add_f32 v[102:103], v[102:103], v[108:109]
  v_pk_add_f32 v[104:105], v[104:105], v[110:111]
  v_lshlrev_b32 v106, 16, v80
  v_and_b32 v107, s90, v80
  v_lshlrev_b32 v108, 16, v81
  v_and_b32 v109, s90, v81
  v_lshlrev_b32 v110, 16, v82
  v_and_b32 v111, s90, v82
  v_pk_add_f32 v[100:101], v[100:101], v[106:107]
  v_pk_add_f32 v[102:103], v[102:103], v[108:109]
  v_pk_add_f32 v[104:105], v[104:105], v[110:111]
  v_lshlrev_b32 v106, 16, v84
  v_and_b32 v107, s90, v84
  v_lshlrev_b32 v108, 16, v85
  v_and_b32 v109, s90, v85
  v_lshlrev_b32 v110, 16, v86
  v_and_b32 v111, s90, v86
  v_pk_add_f32 v[100:101], v[100:101], v[106:107]
  v_pk_add_f32 v[102:103], v[102:103], v[108:109]
  v_pk_add_f32 v[104:105], v[104:105], v[110:111]
  v_lshlrev_b32 v106, 16, v88
  v_and_b32 v107, s90, v88
  v_lshlrev_b32 v108, 16, v89
  v_and_b32 v109, s90, v89
  v_lshlrev_b32 v110, 16, v90
  v_and_b32 v111, s90, v90
  v_pk_add_f32 v[100:101], v[100:101], v[106:107]
  v_pk_add_f32 v[102:103], v[102:103], v[108:109]
  v_pk_add_f32 v[104:105], v[104:105], v[110:111]
  v_lshlrev_b32 v106, 16, v92
  v_and_b32 v107, s90, v92
  v_lshlrev_b32 v108, 16, v93
  v_and_b32 v109, s90, v93
  v_lshlrev_b32 v110, 16, v94
  v_and_b32 v111, s90, v94
  v_pk_add_f32 v[100:101], v[100:101], v[106:107]
  v_pk_add_f32 v[102:103], v[102:103], v[108:109]
  v_pk_add_f32 v[104:105], v[104:105], v[110:111]
  v_cvt_pk_bf16_f32 v244, v100, v101
  v_cvt_pk_bf16_f32 v245, v102, v103
  v_cvt_pk_bf16_f32 v246, v104, v105
  ds_write_b64 v241, v[244:245]
  ds_write_b32 v242, v246
  s_branch CJ_95
KVS_89:
L_pc:
  s_mul_i32 s42, s50, 5
  s_lshr_b32 s42, s42, 2
  s_mul_i32 s43, s42, 80
  s_add_u32 s43, s43, 0xb99000
  v_min_u32 v30, 39, v1
  v_lshlrev_b32 v30, 2, v30
  s_mov_b32 s7, 400000
P_96:
  buffer_load_dword v32, v30, s[16:19], s43 offen offset:800 sc1
  buffer_load_dword v33, v30, s[16:19], s43 offen offset:1600 sc1
  s_waitcnt vmcnt(0)
PE_98:
  v_xor_b32 v32, s99, v32
  v_xor_b32 v33, s99, v33
  v_or_b32 v32, v32, v33
  v_cmp_ne_u32 vcc, 0, v32
  s_nop 0
  s_cbranch_vccz PD_97
  s_sleep 50
  s_sub_u32 s7, s7, 1
  s_cbranch_scc0 P_96
PD_97:
  v_min_u32 v30, 39, v1
  v_lshlrev_b32 v30, 3, v30
  s_mul_i32 s32, s50, 320
  s_add_u32 s32, s32, 0x1300000
  buffer_load_dwordx2 v[32:33], v30, s[16:19], s32 offen sc1
  s_add_u32 s32, s32, 2560
  buffer_load_dwordx2 v[34:35], v30, s[16:19], s32 offen sc1
  s_add_u32 s32, s32, 2560
  buffer_load_dwordx2 v[36:37], v30, s[16:19], s32 offen sc1
  s_add_u32 s32, s32, 2560
  buffer_load_dwordx2 v[38:39], v30, s[16:19], s32 offen sc1
  s_add_u32 s32, s32, 2560
  buffer_load_dwordx2 v[40:41], v30, s[16:19], s32 offen sc1
  s_add_u32 s32, s32, 2560
  buffer_load_dwordx2 v[42:43], v30, s[16:19], s32 offen sc1
  s_add_u32 s32, s32, 2560
  buffer_load_dwordx2 v[44:45], v30, s[16:19], s32 offen sc1
  s_add_u32 s32, s32, 2560
  buffer_load_dwordx2 v[46:47], v30, s[16:19], s32 offen sc1
  s_add_u32 s32, s32, 2560
  buffer_load_dwordx2 v[48:49], v30, s[16:19], s32 offen sc1
  s_add_u32 s32, s32, 2560
  buffer_load_dwordx2 v[50:51], v30, s[16:19], s32 offen sc1
  s_add_u32 s32, s32, 2560
  buffer_load_dwordx2 v[52:53], v30, s[16:19], s32 offen sc1
  s_add_u32 s32, s32, 2560
  buffer_load_dwordx2 v[54:55], v30, s[16:19], s32 offen sc1
  s_add_u32 s32, s32, 2560
  buffer_load_dwordx2 v[56:57], v30, s[16:19], s32 offen sc1
  s_add_u32 s32, s32, 2560
  buffer_load_dwordx2 v[58:59], v30, s[16:19], s32 offen sc1
  s_add_u32 s32, s32, 2560
  buffer_load_dwordx2 v[60:61], v30, s[16:19], s32 offen sc1
  s_add_u32 s32, s32, 2560
  buffer_load_dwordx2 v[62:63], v30, s[16:19], s32 offen sc1
  s_add_u32 s32, s32, 2560
  buffer_load_dwordx2 v[64:65], v30, s[16:19], s32 offen sc1
  s_add_u32 s32, s32, 2560
  buffer_load_dwordx2 v[66:67], v30, s[16:19], s32 offen sc1
  s_add_u32 s32, s32, 2560
  buffer_load_dwordx2 v[68:69], v30, s[16:19], s32 offen sc1
  s_add_u32 s32, s32, 2560
  buffer_load_dwordx2 v[70:71], v30, s[16:19], s32 offen sc1
  s_and_b32 s49, s5, 3
  s_lshl_b32 s32, s4, 2
  s_add_u32 s49, s49, s32
  s_lshl_b32 s51, s49, 2
  s_add_u32 s51, s51, s3
  s_lshr_b32 s32, s50, 1
  s_mul_i32 s32, s32, 5
  s_and_b32 s48, s50, 1
  s_mul_i32 s52, s48, 3
  s_add_u32 s52, s52, s32
  s_lshl_b32 s53, s52, 10
  s_add_u32 s34, s32, 2
  s_lshl_b32 s54, s34, 10
  s_lshl_b32 s35, s48, 9
  s_add_u32 s54, s54, s35
  v_lshlrev_b32 v5, 4, v1
  v_and_b32 v208, 1, v2
  v_lshrrev_b32 v209, 1, v2
  v_lshl_add_u32 v208, v208, 1, v209
  v_lshlrev_b32 v210, 4, v3
  v_lshl_add_u32 v6, v208, 8, v210
  v_lshl_add_u32 v8, v209, 8, v210
  v_lshlrev_b32 v7, 6, v209
  v_lshl_add_u32 v7, v3, 2, v7
  s_lshl_b32 s33, s51, 4
  v_add_u32 v204, s33, v3
  v_mul_u32_u24 v205, 1280, v204
  s_lshl_b32 s35, s52, 6
  v_lshl_add_u32 v9, v208, 4, v205
  v_add_u32 v9, s35, v9
  s_lshl_b32 s34, s34, 6
  s_lshl_b32 s35, s48, 5
  s_add_u32 s34, s34, s35
  v_lshl_add_u32 v10, v2, 3, v205
  v_add_u32 v10, s34, v10
  v_mov_b32 v11, 0
  s_lshl_b32 s94, s3, 2
  s_add_u32 s94, s94, 146368
  v_mov_b32 v15, s94
  s_lshr_b32 s36, s51, 4
  v_add_u32 v206, -1, v204
  v_lshrrev_b32 v200, 4, v206
  v_lshrrev_b32 v207, 4, v200
  v_and_b32 v211, 1, v200
  v_lshl_add_u32 v211, v207, 1, v211
  v_add_u32 v211, 576, v211
  v_cmp_eq_u32 vcc, s36, v207
  s_nop 1
  v_cndmask_b32 v200, v211, v200, vcc
  v_mul_u32_u24 v200, 20480, v200
  v_and_b32 v207, 15, v206
  v_lshl_add_u32 v200, v207, 4, v200
  v_lshl_add_u32 v200, v2, 8, v200
  v_bfrev_b32 v207, 1
  v_cmp_gt_u32 vcc, 0x800, v206
  s_nop 1
  v_cndmask_b32 v200, v207, v200, vcc
  v_add_u32 v206, 1, v204
  v_lshrrev_b32 v201, 4, v206
  v_lshrrev_b32 v207, 4, v201
  v_and_b32 v211, 1, v201
  v_lshl_add_u32 v211, v207, 1, v211
  v_add_u32 v211, 576, v211
  v_cmp_eq_u32 vcc, s36, v207
  s_nop 1
  v_cndmask_b32 v201, v211, v201, vcc
  v_mul_u32_u24 v201, 20480, v201
  v_and_b32 v207, 15, v206
  v_lshl_add_u32 v201, v207, 4, v201
  v_lshl_add_u32 v201, v2, 8, v201
  v_bfrev_b32 v207, 1
  v_cmp_gt_u32 vcc, 0x800, v206
  s_nop 1
  v_cndmask_b32 v201, v207, v201, vcc
  v_add_u32 v206, -2, v204
  v_lshrrev_b32 v202, 4, v206
  v_lshrrev_b32 v207, 4, v202
  v_and_b32 v211, 1, v202
  v_lshl_add_u32 v211, v207, 1, v211
  v_add_u32 v211, 576, v211
  v_cmp_eq_u32 vcc, s36, v207
  s_nop 1
  v_cndmask_b32 v202, v211, v202, vcc
  v_mul_u32_u24 v202, 20480, v202
  v_and_b32 v207, 15, v206
  v_lshl_add_u32 v202, v207, 4, v202
  v_lshl_add_u32 v202, v2, 8, v202
  v_bfrev_b32 v207, 1
  v_cmp_gt_u32 vcc, 0x800, v206
  s_nop 1
  v_cndmask_b32 v202, v207, v202, vcc
  v_add_u32 v206, 2, v204
  v_lshrrev_b32 v203, 4, v206
  v_lshrrev_b32 v207, 4, v203
  v_and_b32 v211, 1, v203
  v_lshl_add_u32 v211, v207, 1, v211
  v_add_u32 v211, 576, v211
  v_cmp_eq_u32 vcc, s36, v207
  s_nop 1
  v_cndmask_b32 v203, v211, v203, vcc
  v_mul_u32_u24 v203, 20480, v203
  v_and_b32 v207, 15, v206
  v_lshl_add_u32 v203, v207, 4, v203
  v_lshl_add_u32 v203, v2, 8, v203
  v_bfrev_b32 v207, 1
  v_cmp_gt_u32 vcc, 0x800, v206
  s_nop 1
  v_cndmask_b32 v203, v207, v203, vcc
  s_and_b32 s37, s51, 15
  s_mov_b32 s59, 0
  s_cmp_eq_u32 s37, 0
  s_cselect_b32 s59, 1, s59
  s_cmp_eq_u32 s37, 15
  s_cselect_b32 s59, 2, s59
  s_cmp_eq_u32 s51, 0
  s_cselect_b32 s59, 0, s59
  s_cmp_eq_u32 s51, 127
  s_cselect_b32 s59, 0, s59
  v_min_u32 v206, 59, v1
  v_mul_u32_u24 v207, 205, v206
  v_lshrrev_b32 v207, 12, v207
  v_mul_u32_u24 v211, 20, v207
  v_sub_u32 v206, v206, v211
  v_min_u32 v211, 1, v207
  v_mul_u32_u24 v211, 40, v211
  v_add_u32 v206, v206, v211
  v_lshlrev_b32 v206, 8, v206
  v_lshrrev_b32 v207, 1, v207
  v_lshlrev_b32 v207, 4, v207
  s_cmp_eq_u32 s59, 1
  s_cselect_b32 s37, 240, 0
  v_xor_b32 v207, s37, v207
  v_add_u32 v17, v206, v207
  s_mul_i32 s37, s36, 40960
  s_add_u32 s37, s37, 0xb3b000
  s_cmp_eq_u32 s59, 2
  s_cselect_b32 s38, 66560, 0
  s_add_u32 s37, s37, s38
  s_cmp_eq_u32 s59, 0
  s_cselect_b32 s37, 0x80000000, s37
  v_add_u32 v17, s37, v17
  v_mov_b32 v12, v5
  v_add_u32 v13, 0x10000, v5
  v_add_u32 v14, 0x20000, v5
  s_mov_b32 s88, 0xbdd2d3e8
  s_mov_b32 s89, 0xbdd2d3e8
  v_mov_b32 v22, 0xc0135761
  s_mov_b32 s90, 0xffff0000
  buffer_load_dwordx4 v[220:223], v9, s[8:11], 0 offen
  buffer_load_dwordx4 v[224:227], v9, s[8:11], 0 offen offset:64
  buffer_load_dwordx2 v[228:229], v10, s[8:11], 0 offen
  v_lshlrev_b32 v206, 8, v2
  v_lshl_add_u32 v206, v3, 2, v206
  s_lshl_b32 s33, s49, 7
  s_add_u32 s33, s33, 0xb91000
  v_and_b32 v204, 31, v1
  v_lshlrev_b32 v204, 2, v204
  s_mul_i32 s55, s51, 20480
  s_add_u32 s55, s55, 0x0
  s_mul_i32 s40, s51, 20480
  s_add_u32 s40, s40, 0x0
  s_add_u32 s41, s40, s54
  s_add_u32 s40, s40, s53
  s_lshl_b32 s42, s51, 3
  s_add_u32 s42, s42, s50
  s_mul_i32 s43, s51, 20480
  s_lshl_b32 s94, s50, 7
  s_add_u32 s43, s43, s94
  s_add_u32 s43, s43, 0x280000
  s_lshl_b32 s42, s42, 2
  s_add_u32 s42, s42, 0xb92000
  s_waitcnt vmcnt(3)
  v_pk_add_f32 v[32:33], v[32:33], v[34:35]
  v_pk_add_f32 v[32:33], v[32:33], v[36:37]
  v_pk_add_f32 v[32:33], v[32:33], v[38:39]
  v_pk_add_f32 v[32:33], v[32:33], v[40:41]
  v_pk_add_f32 v[32:33], v[32:33], v[42:43]
  v_pk_add_f32 v[32:33], v[32:33], v[44:45]
  v_pk_add_f32 v[32:33], v[32:33], v[46:47]
  v_pk_add_f32 v[32:33], v[32:33], v[48:49]
  v_pk_add_f32 v[32:33], v[32:33], v[50:51]
  v_pk_add_f32 v[32:33], v[32:33], v[52:53]
  v_pk_add_f32 v[32:33], v[32:33], v[54:55]
  v_pk_add_f32 v[32:33], v[32:33], v[56:57]
  v_pk_add_f32 v[32:33], v[32:33], v[58:59]
  v_pk_add_f32 v[32:33], v[32:33], v[60:61]
  v_pk_add_f32 v[32:33], v[32:33], v[62:63]
  v_pk_add_f32 v[32:33], v[32:33], v[64:65]
  v_pk_add_f32 v[32:33], v[32:33], v[66:67]
  v_pk_add_f32 v[32:33], v[32:33], v[68:69]
  v_pk_add_f32 v[32:33], v[32:33], v[70:71]
  v_add_u32 v30, 0x27800, v30
  ds_write_b64 v30, v[32:33]
CJ_95:
  s_waitcnt lgkmcnt(0)
  s_barrier
  s_setprio 0
  s_mul_i32 s60, s50, 798720
  s_add_u32 s60, s60, 0xc00000
  s_mul_i32 s56, s57, 5120
  s_lshr_b32 s94, s4, 1
  s_add_u32 s95, s94, 0
  s_cmp_ge_u32 s95, 5
  s_cselect_b32 s96, 5, 0
  s_sub_u32 s95, s95, s96
  s_lshl_b32 s24, s95, 10
  s_add_u32 s95, s94, 1
  s_cmp_ge_u32 s95, 5
  s_cselect_b32 s96, 5, 0
  s_sub_u32 s95, s95, s96
  s_lshl_b32 s25, s95, 10
  s_add_u32 s95, s94, 2
  s_cmp_ge_u32 s95, 5
  s_cselect_b32 s96, 5, 0
  s_sub_u32 s95, s95, s96
  s_lshl_b32 s26, s95, 10
  s_add_u32 s95, s94, 3
  s_cmp_ge_u32 s95, 5
  s_cselect_b32 s96, 5, 0
  s_sub_u32 s95, s95, s96
  s_lshl_b32 s27, s95, 10
  s_add_u32 s95, s94, 4
  s_cmp_ge_u32 s95, 5
  s_cselect_b32 s96, 5, 0
  s_sub_u32 s95, s95, s96
  s_lshl_b32 s84, s95, 10
  s_and_b32 s85, s4, 1
  s_mul_i32 s72, s4, 11
  s_lshr_b32 s72, s72, 5
  s_mul_i32 s72, s72, 3
  s_sub_u32 s72, s4, s72
  v_lshlrev_b32 v243, 4, v1
  v_add_u32 v243, s56, v243
  s_mov_b32 s94, 102400
  s_mov_b32 s95, 102400
  s_add_u32 s94, s94, s60
  s_add_u32 s95, s95, s56
  s_add_u32 m0, s95, s24
  s_add_u32 s96, s94, s24
  buffer_load_dwordx4 v243, s[16:19], s96 offen sc1 lds
  s_add_u32 m0, s95, s25
  s_add_u32 s96, s94, s25
  buffer_load_dwordx4 v243, s[16:19], s96 offen sc1 lds
  s_add_u32 m0, s95, s26
  s_add_u32 s96, s94, s26
  buffer_load_dwordx4 v243, s[16:19], s96 offen sc1 lds
  s_add_u32 m0, s95, s27
  s_add_u32 s96, s94, s27
  buffer_load_dwordx4 v243, s[16:19], s96 offen sc1 lds
  s_add_u32 m0, s95, s84
  s_add_u32 s96, s94, s84
  buffer_load_dwordx4 v243, s[16:19], s96 offen sc1 lds
  s_waitcnt vmcnt(5)
  v_permlane16_swap_b32 v220, v222
  v_permlane16_swap_b32 v221, v223
  v_permlane16_swap_b32 v224, v226
  v_permlane16_swap_b32 v225, v227
  v_lshlrev_b32 v24, 16, v220
  v_and_b32 v25, s90, v220
  v_lshlrev_b32 v26, 16, v221
  v_and_b32 v27, s90, v221
  v_lshlrev_b32 v28, 16, v222
  v_and_b32 v29, s90, v222
  v_lshlrev_b32 v30, 16, v223
  v_and_b32 v31, s90, v223
  v_lshlrev_b32 v32, 16, v224
  v_and_b32 v33, s90, v224
  v_lshlrev_b32 v34, 16, v225
  v_and_b32 v35, s90, v225
  v_lshlrev_b32 v36, 16, v226
  v_and_b32 v37, s90, v226
  v_lshlrev_b32 v38, 16, v227
  v_and_b32 v39, s90, v227
  v_lshlrev_b32 v40, 16, v228
  v_and_b32 v41, s90, v228
  v_lshlrev_b32 v42, 16, v229
  v_and_b32 v43, s90, v229
  ds_read_b128 v[44:47], v12 offset:0
  ds_read_b128 v[48:51], v12 offset:1024
  ds_read_b128 v[52:55], v12 offset:2048
  ds_read_b128 v[56:59], v12 offset:3072
  ds_read_b128 v[60:63], v12 offset:4096
  ds_read_b128 v[64:67], v12 offset:5120
  ds_read_b128 v[68:71], v12 offset:6144
  ds_read_b128 v[72:75], v12 offset:7168
  ds_read_b128 v[76:79], v12 offset:8192
  ds_read_b128 v[80:83], v12 offset:9216
  ds_read_b128 v[84:87], v12 offset:10240
  ds_read_b128 v[88:91], v12 offset:11264
  ds_read_b128 v[92:95], v12 offset:12288
  s_mov_b32 s7, 400000
P_99:
  buffer_load_dword v205, v204, s[16:19], s33 offen sc1
  s_waitcnt vmcnt(0)
PE_101:
  v_cmp_ne_u32 vcc, s99, v205
  s_nop 0
  s_cbranch_vccz PD_100
  s_sub_u32 s7, s7, 1
  s_cbranch_scc0 P_99
PD_100:
  buffer_load_dwordx4 v[120:123], v5, s[16:19], s55 offen offset:0 sc1
  buffer_load_dwordx4 v[124:127], v5, s[16:19], s55 offen offset:1024 sc1
  buffer_load_dwordx4 v[128:131], v5, s[16:19], s55 offen offset:2048 sc1
  buffer_load_dwordx4 v[132:135], v5, s[16:19], s55 offen offset:3072 sc1
  s_add_u32 s55, s55, 4096
  buffer_load_dwordx4 v[136:139], v5, s[16:19], s55 offen offset:0 sc1
  buffer_load_dwordx4 v[140:143], v5, s[16:19], s55 offen offset:1024 sc1
  buffer_load_dwordx4 v[144:147], v5, s[16:19], s55 offen offset:2048 sc1
  buffer_load_dwordx4 v[148:151], v5, s[16:19], s55 offen offset:3072 sc1
  s_add_u32 s55, s55, 4096
  buffer_load_dwordx4 v[152:155], v5, s[16:19], s55 offen offset:0 sc1
  buffer_load_dwordx4 v[156:159], v5, s[16:19], s55 offen offset:1024 sc1
  buffer_load_dwordx4 v[160:163], v5, s[16:19], s55 offen offset:2048 sc1
  buffer_load_dwordx4 v[164:167], v5, s[16:19], s55 offen offset:3072 sc1
  s_add_u32 s55, s55, 4096
  buffer_load_dwordx4 v[168:171], v5, s[16:19], s55 offen offset:0 sc1
  buffer_load_dwordx4 v[172:175], v5, s[16:19], s55 offen offset:1024 sc1
  s_waitcnt vmcnt(13) lgkmcnt(8)
  v_mfma_f32_16x16x32_bf16 v[24:27], v[44:47], v[120:123], v[24:27]
  ds_read_b128 v[96:99], v12 offset:13312
  v_mfma_f32_16x16x32_bf16 v[28:31], v[48:51], v[120:123], v[28:31]
  ds_read_b128 v[44:47], v12 offset:14336
  v_mfma_f32_16x16x32_bf16 v[32:35], v[52:55], v[120:123], v[32:35]
  ds_read_b128 v[48:51], v12 offset:15360
  v_mfma_f32_16x16x32_bf16 v[36:39], v[56:59], v[120:123], v[36:39]
  ds_read_b128 v[52:55], v12 offset:16384
  v_mfma_f32_16x16x32_bf16 v[40:43], v[60:63], v[120:123], v[40:43]
  ds_read_b128 v[56:59], v12 offset:17408
  buffer_load_dwordx4 v[176:179], v5, s[16:19], s55 offen offset:2048 sc1
  s_waitcnt vmcnt(13) lgkmcnt(8)
  v_mfma_f32_16x16x32_bf16 v[24:27], v[64:67], v[124:127], v[24:27]
  ds_read_b128 v[60:63], v12 offset:18432
  v_mfma_f32_16x16x32_bf16 v[28:31], v[68:71], v[124:127], v[28:31]
  ds_read_b128 v[64:67], v12 offset:19456
  v_mfma_f32_16x16x32_bf16 v[32:35], v[72:75], v[124:127], v[32:35]
  ds_read_b128 v[68:71], v12 offset:20480
  v_mfma_f32_16x16x32_bf16 v[36:39], v[76:79], v[124:127], v[36:39]
  ds_read_b128 v[72:75], v12 offset:21504
  v_mfma_f32_16x16x32_bf16 v[40:43], v[80:83], v[124:127], v[40:43]
  ds_read_b128 v[76:79], v12 offset:22528
  buffer_load_dwordx4 v[180:183], v5, s[16:19], s55 offen offset:3072 sc1
  s_add_u32 s55, s55, 4096
  s_waitcnt vmcnt(13) lgkmcnt(8)
  v_mfma_f32_16x16x32_bf16 v[24:27], v[84:87], v[128:131], v[24:27]
  ds_read_b128 v[80:83], v12 offset:23552
  v_mfma_f32_16x16x32_bf16 v[28:31], v[88:91], v[128:131], v[28:31]
  ds_read_b128 v[84:87], v12 offset:24576
  v_mfma_f32_16x16x32_bf16 v[32:35], v[92:95], v[128:131], v[32:35]
  ds_read_b128 v[88:91], v12 offset:25600
  v_mfma_f32_16x16x32_bf16 v[36:39], v[96:99], v[128:131], v[36:39]
  ds_read_b128 v[92:95], v12 offset:26624
  v_mfma_f32_16x16x32_bf16 v[40:43], v[44:47], v[128:131], v[40:43]
  ds_read_b128 v[96:99], v12 offset:27648
  buffer_load_dwordx4 v[184:187], v5, s[16:19], s55 offen offset:0 sc1
  s_waitcnt vmcnt(13) lgkmcnt(8)
  v_mfma_f32_16x16x32_bf16 v[24:27], v[48:51], v[132:135], v[24:27]
  ds_read_b128 v[44:47], v12 offset:28672
  v_mfma_f32_16x16x32_bf16 v[28:31], v[52:55], v[132:135], v[28:31]
  ds_read_b128 v[48:51], v12 offset:29696
  v_mfma_f32_16x16x32_bf16 v[32:35], v[56:59], v[132:135], v[32:35]
  ds_read_b128 v[52:55], v12 offset:30720
  v_mfma_f32_16x16x32_bf16 v[36:39], v[60:63], v[132:135], v[36:39]
  ds_read_b128 v[56:59], v12 offset:31744
  v_mfma_f32_16x16x32_bf16 v[40:43], v[64:67], v[132:135], v[40:43]
  ds_read_b128 v[60:63], v12 offset:32768
  buffer_load_dwordx4 v[188:191], v5, s[16:19], s55 offen offset:1024 sc1
  v_mov_b32 v16, 1
  ds_write_b32 v15, v16
  s_waitcnt vmcnt(13) lgkmcnt(8)
  v_mfma_f32_16x16x32_bf16 v[24:27], v[68:71], v[136:139], v[24:27]
  ds_read_b128 v[64:67], v12 offset:33792
  v_mfma_f32_16x16x32_bf16 v[28:31], v[72:75], v[136:139], v[28:31]
  ds_read_b128 v[68:71], v12 offset:34816
  v_mfma_f32_16x16x32_bf16 v[32:35], v[76:79], v[136:139], v[32:35]
  ds_read_b128 v[72:75], v12 offset:35840
  v_mfma_f32_16x16x32_bf16 v[36:39], v[80:83], v[136:139], v[36:39]
  ds_read_b128 v[76:79], v12 offset:36864
  v_mfma_f32_16x16x32_bf16 v[40:43], v[84:87], v[136:139], v[40:43]
  ds_read_b128 v[80:83], v12 offset:37888
  buffer_load_dwordx4 v[192:195], v5, s[16:19], s55 offen offset:2048 sc1
  s_waitcnt vmcnt(13) lgkmcnt(8)
  v_mfma_f32_16x16x32_bf16 v[24:27], v[88:91], v[140:143], v[24:27]
  ds_read_b128 v[84:87], v12 offset:38912
  v_mfma_f32_16x16x32_bf16 v[28:31], v[92:95], v[140:143], v[28:31]
  ds_read_b128 v[88:91], v12 offset:39936
  v_mfma_f32_16x16x32_bf16 v[32:35], v[96:99], v[140:143], v[32:35]
  ds_read_b128 v[92:95], v12 offset:40960
  v_mfma_f32_16x16x32_bf16 v[36:39], v[44:47], v[140:143], v[36:39]
  ds_read_b128 v[96:99], v12 offset:41984
  v_mfma_f32_16x16x32_bf16 v[40:43], v[48:51], v[140:143], v[40:43]
  ds_read_b128 v[44:47], v12 offset:43008
  buffer_load_dwordx4 v[196:199], v5, s[16:19], s55 offen offset:3072 sc1
  s_add_u32 s55, s55, 4096
  s_waitcnt vmcnt(13) lgkmcnt(8)
  v_mfma_f32_16x16x32_bf16 v[24:27], v[52:55], v[144:147], v[24:27]
  ds_read_b128 v[48:51], v12 offset:44032
  v_mfma_f32_16x16x32_bf16 v[28:31], v[56:59], v[144:147], v[28:31]
  ds_read_b128 v[52:55], v12 offset:45056
  v_mfma_f32_16x16x32_bf16 v[32:35], v[60:63], v[144:147], v[32:35]
  ds_read_b128 v[56:59], v12 offset:46080
  v_mfma_f32_16x16x32_bf16 v[36:39], v[64:67], v[144:147], v[36:39]
  ds_read_b128 v[60:63], v12 offset:47104
  v_mfma_f32_16x16x32_bf16 v[40:43], v[68:71], v[144:147], v[40:43]
  ds_read_b128 v[64:67], v12 offset:48128
  s_waitcnt vmcnt(12) lgkmcnt(8)
  v_mfma_f32_16x16x32_bf16 v[24:27], v[72:75], v[148:151], v[24:27]
  ds_read_b128 v[68:71], v12 offset:49152
  v_mfma_f32_16x16x32_bf16 v[28:31], v[76:79], v[148:151], v[28:31]
  ds_read_b128 v[72:75], v12 offset:50176
  v_mfma_f32_16x16x32_bf16 v[32:35], v[80:83], v[148:151], v[32:35]
  ds_read_b128 v[76:79], v12 offset:51200
  v_mfma_f32_16x16x32_bf16 v[36:39], v[84:87], v[148:151], v[36:39]
  ds_read_b128 v[80:83], v12 offset:52224
  v_mfma_f32_16x16x32_bf16 v[40:43], v[88:91], v[148:151], v[40:43]
  ds_read_b128 v[84:87], v12 offset:53248
  s_waitcnt vmcnt(11) lgkmcnt(8)
  v_mfma_f32_16x16x32_bf16 v[24:27], v[92:95], v[152:155], v[24:27]
  ds_read_b128 v[88:91], v12 offset:54272
  v_mfma_f32_16x16x32_bf16 v[28:31], v[96:99], v[152:155], v[28:31]
  ds_read_b128 v[92:95], v12 offset:55296
  v_mfma_f32_16x16x32_bf16 v[32:35], v[44:47], v[152:155], v[32:35]
  ds_read_b128 v[96:99], v12 offset:56320
  v_mfma_f32_16x16x32_bf16 v[36:39], v[48:51], v[152:155], v[36:39]
  ds_read_b128 v[44:47], v12 offset:57344
  v_mfma_f32_16x16x32_bf16 v[40:43], v[52:55], v[152:155], v[40:43]
  ds_read_b128 v[48:51], v12 offset:58368
  s_waitcnt vmcnt(10) lgkmcnt(8)
  v_mfma_f32_16x16x32_bf16 v[24:27], v[56:59], v[156:159], v[24:27]
  ds_read_b128 v[52:55], v12 offset:59392
  v_mfma_f32_16x16x32_bf16 v[28:31], v[60:63], v[156:159], v[28:31]
  ds_read_b128 v[56:59], v12 offset:60416
  v_mfma_f32_16x16x32_bf16 v[32:35], v[64:67], v[156:159], v[32:35]
  ds_read_b128 v[60:63], v12 offset:61440
  v_mfma_f32_16x16x32_bf16 v[36:39], v[68:71], v[156:159], v[36:39]
  ds_read_b128 v[64:67], v12 offset:62464
  v_mfma_f32_16x16x32_bf16 v[40:43], v[72:75], v[156:159], v[40:43]
  ds_read_b128 v[68:71], v12 offset:63488
  s_waitcnt vmcnt(9) lgkmcnt(8)
  v_mfma_f32_16x16x32_bf16 v[24:27], v[76:79], v[160:163], v[24:27]
  ds_read_b128 v[72:75], v12 offset:64512
  v_mfma_f32_16x16x32_bf16 v[28:31], v[80:83], v[160:163], v[28:31]
  ds_read_b128 v[76:79], v13 offset:0
  v_mfma_f32_16x16x32_bf16 v[32:35], v[84:87], v[160:163], v[32:35]
  ds_read_b128 v[80:83], v13 offset:1024
  v_mfma_f32_16x16x32_bf16 v[36:39], v[88:91], v[160:163], v[36:39]
  ds_read_b128 v[84:87], v13 offset:2048
  v_mfma_f32_16x16x32_bf16 v[40:43], v[92:95], v[160:163], v[40:43]
  ds_read_b128 v[88:91], v13 offset:3072
  s_waitcnt vmcnt(8) lgkmcnt(8)
  v_mfma_f32_16x16x32_bf16 v[24:27], v[96:99], v[164:167], v[24:27]
  ds_read_b128 v[92:95], v13 offset:4096
  v_mfma_f32_16x16x32_bf16 v[28:31], v[44:47], v[164:167], v[28:31]
  ds_read_b128 v[96:99], v13 offset:5120
  v_mfma_f32_16x16x32_bf16 v[32:35], v[48:51], v[164:167], v[32:35]
  ds_read_b128 v[44:47], v13 offset:6144
  v_mfma_f32_16x16x32_bf16 v[36:39], v[52:55], v[164:167], v[36:39]
  ds_read_b128 v[48:51], v13 offset:7168
  v_mfma_f32_16x16x32_bf16 v[40:43], v[56:59], v[164:167], v[40:43]
  ds_read_b128 v[52:55], v13 offset:8192
  v_mov_b32 v16, 2
  ds_write_b32 v15, v16
  s_waitcnt vmcnt(7) lgkmcnt(8)
  v_mfma_f32_16x16x32_bf16 v[24:27], v[60:63], v[168:171], v[24:27]
  ds_read_b128 v[56:59], v13 offset:9216
  v_mfma_f32_16x16x32_bf16 v[28:31], v[64:67], v[168:171], v[28:31]
  ds_read_b128 v[60:63], v13 offset:10240
  v_mfma_f32_16x16x32_bf16 v[32:35], v[68:71], v[168:171], v[32:35]
  ds_read_b128 v[64:67], v13 offset:11264
  v_mfma_f32_16x16x32_bf16 v[36:39], v[72:75], v[168:171], v[36:39]
  ds_read_b128 v[68:71], v13 offset:12288
  v_mfma_f32_16x16x32_bf16 v[40:43], v[76:79], v[168:171], v[40:43]
  ds_read_b128 v[72:75], v13 offset:13312
  s_waitcnt vmcnt(6) lgkmcnt(8)
  v_mfma_f32_16x16x32_bf16 v[24:27], v[80:83], v[172:175], v[24:27]
  ds_read_b128 v[76:79], v13 offset:14336
  v_mfma_f32_16x16x32_bf16 v[28:31], v[84:87], v[172:175], v[28:31]
  ds_read_b128 v[80:83], v13 offset:15360
  v_mfma_f32_16x16x32_bf16 v[32:35], v[88:91], v[172:175], v[32:35]
  ds_read_b128 v[84:87], v13 offset:16384
  v_mfma_f32_16x16x32_bf16 v[36:39], v[92:95], v[172:175], v[36:39]
  ds_read_b128 v[88:91], v13 offset:17408
  v_mfma_f32_16x16x32_bf16 v[40:43], v[96:99], v[172:175], v[40:43]
  ds_read_b128 v[92:95], v13 offset:18432
  s_waitcnt vmcnt(5) lgkmcnt(8)
  v_mfma_f32_16x16x32_bf16 v[24:27], v[44:47], v[176:179], v[24:27]
  ds_read_b128 v[96:99], v13 offset:19456
  v_mfma_f32_16x16x32_bf16 v[28:31], v[48:51], v[176:179], v[28:31]
  ds_read_b128 v[44:47], v13 offset:20480
  v_mfma_f32_16x16x32_bf16 v[32:35], v[52:55], v[176:179], v[32:35]
  ds_read_b128 v[48:51], v13 offset:21504
  v_mfma_f32_16x16x32_bf16 v[36:39], v[56:59], v[176:179], v[36:39]
  ds_read_b128 v[52:55], v13 offset:22528
  v_mfma_f32_16x16x32_bf16 v[40:43], v[60:63], v[176:179], v[40:43]
  ds_read_b128 v[56:59], v13 offset:23552
  s_waitcnt vmcnt(4) lgkmcnt(8)
  v_mfma_f32_16x16x32_bf16 v[24:27], v[64:67], v[180:183], v[24:27]
  ds_read_b128 v[60:63], v13 offset:24576
  v_mfma_f32_16x16x32_bf16 v[28:31], v[68:71], v[180:183], v[28:31]
  ds_read_b128 v[64:67], v13 offset:25600
  v_mfma_f32_16x16x32_bf16 v[32:35], v[72:75], v[180:183], v[32:35]
  ds_read_b128 v[68:71], v13 offset:26624
  v_mfma_f32_16x16x32_bf16 v[36:39], v[76:79], v[180:183], v[36:39]
  ds_read_b128 v[72:75], v13 offset:27648
  v_mfma_f32_16x16x32_bf16 v[40:43], v[80:83], v[180:183], v[40:43]
  ds_read_b128 v[76:79], v13 offset:28672
  s_waitcnt vmcnt(3) lgkmcnt(8)
  v_mfma_f32_16x16x32_bf16 v[24:27], v[84:87], v[184:187], v[24:27]
  ds_read_b128 v[80:83], v13 offset:29696
  v_mfma_f32_16x16x32_bf16 v[28:31], v[88:91], v[184:187], v[28:31]
  ds_read_b128 v[84:87], v13 offset:30720
  v_mfma_f32_16x16x32_bf16 v[32:35], v[92:95], v[184:187], v[32:35]
  ds_read_b128 v[88:91], v13 offset:31744
  v_mfma_f32_16x16x32_bf16 v[36:39], v[96:99], v[184:187], v[36:39]
  ds_read_b128 v[92:95], v13 offset:32768
  v_mfma_f32_16x16x32_bf16 v[40:43], v[44:47], v[184:187], v[40:43]
  ds_read_b128 v[96:99], v13 offset:33792
  s_waitcnt vmcnt(2) lgkmcnt(8)
  v_mfma_f32_16x16x32_bf16 v[24:27], v[48:51], v[188:191], v[24:27]
  ds_read_b128 v[44:47], v13 offset:34816
  v_mfma_f32_16x16x32_bf16 v[28:31], v[52:55], v[188:191], v[28:31]
  ds_read_b128 v[48:51], v13 offset:35840
  v_mfma_f32_16x16x32_bf16 v[32:35], v[56:59], v[188:191], v[32:35]
  v_mfma_f32_16x16x32_bf16 v[36:39], v[60:63], v[188:191], v[36:39]
  v_mfma_f32_16x16x32_bf16 v[40:43], v[64:67], v[188:191], v[40:43]
  s_waitcnt vmcnt(1) lgkmcnt(5)
  v_mfma_f32_16x16x32_bf16 v[24:27], v[68:71], v[192:195], v[24:27]
  v_mfma_f32_16x16x32_bf16 v[28:31], v[72:75], v[192:195], v[28:31]
  v_mfma_f32_16x16x32_bf16 v[32:35], v[76:79], v[192:195], v[32:35]
  v_mfma_f32_16x16x32_bf16 v[36:39], v[80:83], v[192:195], v[36:39]
  v_mfma_f32_16x16x32_bf16 v[40:43], v[84:87], v[192:195], v[40:43]
  s_waitcnt vmcnt(0) lgkmcnt(0)
  v_mfma_f32_16x16x32_bf16 v[24:27], v[88:91], v[196:199], v[24:27]
  v_mfma_f32_16x16x32_bf16 v[28:31], v[92:95], v[196:199], v[28:31]
  v_mfma_f32_16x16x32_bf16 v[32:35], v[96:99], v[196:199], v[32:35]
  v_mfma_f32_16x16x32_bf16 v[36:39], v[44:47], v[196:199], v[36:39]
  v_mfma_f32_16x16x32_bf16 v[40:43], v[48:51], v[196:199], v[40:43]
  s_nop 7
  v_cvt_pk_bf16_f32 v228, v40, v41
  v_cvt_pk_bf16_f32 v230, v40, v41
  v_cvt_pk_bf16_f32 v229, v42, v43
  v_cvt_pk_bf16_f32 v231, v42, v43
  v_cvt_pk_bf16_f32 v220, v24, v25
  v_cvt_pk_bf16_f32 v221, v26, v27
  v_cvt_pk_bf16_f32 v222, v28, v29
  v_cvt_pk_bf16_f32 v223, v30, v31
  v_cvt_pk_bf16_f32 v224, v32, v33
  v_cvt_pk_bf16_f32 v225, v34, v35
  v_cvt_pk_bf16_f32 v226, v36, v37
  v_cvt_pk_bf16_f32 v227, v38, v39
  v_permlane16_swap_b32 v228, v230
  v_permlane16_swap_b32 v229, v231
  v_permlane16_swap_b32 v220, v222
  v_permlane16_swap_b32 v221, v223
  v_permlane16_swap_b32 v224, v226
  v_permlane16_swap_b32 v225, v227
  s_cmp_eq_u32 s6, 0
  s_cbranch_scc1 SL_102
  buffer_store_dwordx4 v[220:223], v6, s[20:23], s40 offen
  buffer_store_dwordx4 v[224:227], v6, s[20:23], s40 offen offset:1024
  s_mov_b32 exec_lo, 0xffff
  s_mov_b32 exec_hi, 0xffff
  buffer_store_dwordx4 v[228:231], v8, s[20:23], s41 offen
  s_mov_b64 exec, -1
  v_pk_add_f32 v[216:217], v[24:25], v[26:27]
  v_pk_mul_f32 v[218:219], v[24:25], v[24:25]
  v_pk_fma_f32 v[218:219], v[26:27], v[26:27], v[218:219]
  v_pk_add_f32 v[216:217], v[216:217], v[28:29]
  v_pk_fma_f32 v[218:219], v[28:29], v[28:29], v[218:219]
  v_pk_add_f32 v[216:217], v[216:217], v[30:31]
  v_pk_fma_f32 v[218:219], v[30:31], v[30:31], v[218:219]
  v_pk_add_f32 v[216:217], v[216:217], v[32:33]
  v_pk_fma_f32 v[218:219], v[32:33], v[32:33], v[218:219]
  v_pk_add_f32 v[216:217], v[216:217], v[34:35]
  v_pk_fma_f32 v[218:219], v[34:35], v[34:35], v[218:219]
  v_pk_add_f32 v[216:217], v[216:217], v[36:37]
  v_pk_fma_f32 v[218:219], v[36:37], v[36:37], v[218:219]
  v_pk_add_f32 v[216:217], v[216:217], v[38:39]
  v_pk_fma_f32 v[218:219], v[38:39], v[38:39], v[218:219]
  v_pk_add_f32 v[216:217], v[216:217], v[40:41]
  v_pk_fma_f32 v[218:219], v[40:41], v[40:41], v[218:219]
  v_pk_add_f32 v[216:217], v[216:217], v[42:43]
  v_pk_fma_f32 v[218:219], v[42:43], v[42:43], v[218:219]
  v_add_f32 v216, v216, v217
  v_add_f32 v218, v218, v219
  s_nop 1
  v_permlane32_swap_b32 v216, v218
  v_add_f32 v216, v216, v218
  v_mov_b32 v218, v216
  s_nop 1
  v_permlane16_swap_b32 v216, v218
  v_add_f32 v216, v216, v218
  buffer_store_dword v216, v7, s[16:19], s43 offen
  s_waitcnt vmcnt(0)
  s_mov_b64 exec, 1
  buffer_store_dword v252, v11, s[16:19], s42 offen
  s_mov_b64 exec, -1
  s_branch SE_103
SL_102:
  s_nop 1
  buffer_store_dwordx4 v[220:223], v6, s[20:23], s40 offen sc1
  buffer_store_dwordx4 v[224:227], v6, s[20:23], s40 offen offset:1024 sc1
  s_mov_b32 exec_lo, 0xffff
  s_mov_b32 exec_hi, 0xffff
  buffer_store_dwordx4 v[228:231], v8, s[20:23], s41 offen sc1
  s_mov_b64 exec, -1
  v_pk_add_f32 v[216:217], v[24:25], v[26:27]
  v_pk_mul_f32 v[218:219], v[24:25], v[24:25]
  v_pk_fma_f32 v[218:219], v[26:27], v[26:27], v[218:219]
  v_pk_add_f32 v[216:217], v[216:217], v[28:29]
  v_pk_fma_f32 v[218:219], v[28:29], v[28:29], v[218:219]
  v_pk_add_f32 v[216:217], v[216:217], v[30:31]
  v_pk_fma_f32 v[218:219], v[30:31], v[30:31], v[218:219]
  v_pk_add_f32 v[216:217], v[216:217], v[32:33]
  v_pk_fma_f32 v[218:219], v[32:33], v[32:33], v[218:219]
  v_pk_add_f32 v[216:217], v[216:217], v[34:35]
  v_pk_fma_f32 v[218:219], v[34:35], v[34:35], v[218:219]
  v_pk_add_f32 v[216:217], v[216:217], v[36:37]
  v_pk_fma_f32 v[218:219], v[36:37], v[36:37], v[218:219]
  v_pk_add_f32 v[216:217], v[216:217], v[38:39]
  v_pk_fma_f32 v[218:219], v[38:39], v[38:39], v[218:219]
  v_pk_add_f32 v[216:217], v[216:217], v[40:41]
  v_pk_fma_f32 v[218:219], v[40:41], v[40:41], v[218:219]
  v_pk_add_f32 v[216:217], v[216:217], v[42:43]
  v_pk_fma_f32 v[218:219], v[42:43], v[42:43], v[218:219]
  v_add_f32 v216, v216, v217
  v_add_f32 v218, v218, v219
  s_nop 1
  v_permlane32_swap_b32 v216, v218
  v_add_f32 v216, v216, v218
  v_mov_b32 v218, v216
  s_nop 1
  v_permlane16_swap_b32 v216, v218
  v_add_f32 v216, v216, v218
  buffer_store_dword v216, v7, s[16:19], s43 offen sc1
  s_waitcnt vmcnt(0)
  s_mov_b64 exec, 1
  buffer_store_dword v252, v11, s[16:19], s42 offen sc1
  s_mov_b64 exec, -1
SE_103:
  v_mov_b32 v100, v24
  v_mov_b32 v101, v25
  v_mov_b32 v102, v26
  v_mov_b32 v103, v27
  v_mov_b32 v104, v28
  v_mov_b32 v105, v29
  v_mov_b32 v106, v30
  v_mov_b32 v107, v31
  v_mov_b32 v108, v32
  v_mov_b32 v109, v33
  v_mov_b32 v110, v34
  v_mov_b32 v111, v35
  v_mov_b32 v112, v36
  v_mov_b32 v113, v37
  v_mov_b32 v114, v38
  v_mov_b32 v115, v39
  v_mov_b32 v116, v40
  v_mov_b32 v117, v41
  v_mov_b32 v118, v42
  v_mov_b32 v119, v43
  v_lshlrev_b32 v207, 4, v2
  v_add_u32 v207, 0x27800, v207
  s_mul_i32 s55, s51, 20480
  s_add_u32 s55, s55, 0x0
  s_mul_i32 s40, s51, 20480
  s_add_u32 s40, s40, 0x0
  s_add_u32 s41, s40, s54
  s_add_u32 s40, s40, s53
  s_lshl_b32 s42, s51, 3
  s_add_u32 s42, s42, s50
  s_lshl_b32 s42, s42, 2
  s_add_u32 s42, s42, 0xb93000
  s_lshr_b32 s44, s51, 4
  s_lshl_b32 s44, s44, 1
  s_add_u32 s44, s44, s59
  s_mul_i32 s44, s44, 20480
  s_add_u32 s44, s44, 0xb3b000
  s_add_u32 s45, s44, s54
  s_add_u32 s44, s44, s53
  s_cmp_eq_u32 s59, 1
  s_mov_b32 s46, 0xc000c000
  s_cmov_b32 s46, 0x00030003
  s_and_b32 s47, s46, 0xffff
  v_mov_b32 v52, 0x23bd0
  s_mov_b32 s7, 2000000
W_104:
  ds_read_b128 v[44:47], v52
  s_waitcnt lgkmcnt(0)
  v_min3_u32 v44, v44, v45, v46
  v_min_u32 v44, v44, v47
  v_cmp_gt_u32 vcc, 10, v44
  s_nop 0
  s_cbranch_vccz WD_105
  s_sub_u32 s7, s7, 1
  s_cbranch_scc0 W_104
WD_105:
  ds_read_b128 v[44:47], v13 offset:36864
  ds_read_b128 v[48:51], v13 offset:37888
  ds_read_b128 v[52:55], v13 offset:38912
  ds_read_b128 v[56:59], v13 offset:39936
  ds_read_b128 v[60:63], v13 offset:40960
  ds_read_b128 v[64:67], v13 offset:41984
  ds_read_b128 v[68:71], v13 offset:43008
  ds_read_b128 v[72:75], v13 offset:44032
  ds_read_b128 v[76:79], v13 offset:45056
  ds_read_b128 v[80:83], v13 offset:46080
  ds_read_b128 v[84:87], v13 offset:47104
  ds_read_b128 v[88:91], v13 offset:48128
  ds_read_b128 v[92:95], v13 offset:49152
  s_lshl_b32 s33, s51, 5
  s_add_u32 s33, s33, 0xb92000
  v_and_b32 v204, 7, v1
  v_lshlrev_b32 v204, 2, v204
  s_mov_b32 s7, 400000
P_106:
  buffer_load_dword v205, v204, s[16:19], s33 offen sc1
  s_waitcnt vmcnt(0)
PE_108:
  v_cmp_ne_u32 vcc, s99, v205
  s_nop 0
  s_cbranch_vccz PD_107
  s_sub_u32 s7, s7, 1
  s_cbranch_scc0 P_106
PD_107:
  s_mul_i32 s33, s51, 20480
  s_add_u32 s33, s33, 0x280000
  buffer_load_dword v208, v206, s[16:19], s33 offen offset:0 sc1
  buffer_load_dword v209, v206, s[16:19], s33 offen offset:64 sc1
  buffer_load_dword v210, v206, s[16:19], s33 offen offset:128 sc1
  buffer_load_dword v211, v206, s[16:19], s33 offen offset:192 sc1
  buffer_load_dwordx4 v[120:123], v5, s[20:23], s55 offen offset:0 sc1
  buffer_load_dwordx4 v[124:127], v5, s[20:23], s55 offen offset:1024 sc1
  buffer_load_dwordx4 v[128:131], v5, s[20:23], s55 offen offset:2048 sc1
  buffer_load_dwordx4 v[132:135], v5, s[20:23], s55 offen offset:3072 sc1
  s_add_u32 s55, s55, 4096
  buffer_load_dwordx4 v[136:139], v5, s[20:23], s55 offen offset:0 sc1
  buffer_load_dwordx4 v[140:143], v5, s[20:23], s55 offen offset:1024 sc1
  buffer_load_dwordx4 v[144:147], v5, s[20:23], s55 offen offset:2048 sc1
  buffer_load_dwordx4 v[148:151], v5, s[20:23], s55 offen offset:3072 sc1
  s_add_u32 s55, s55, 4096
  buffer_load_dwordx4 v[152:155], v5, s[20:23], s55 offen offset:0 sc1
  buffer_load_dwordx4 v[156:159], v5, s[20:23], s55 offen offset:1024 sc1
  buffer_load_dwordx4 v[160:163], v5, s[20:23], s55 offen offset:2048 sc1
  buffer_load_dwordx4 v[164:167], v5, s[20:23], s55 offen offset:3072 sc1
  s_add_u32 s55, s55, 4096
  buffer_load_dwordx4 v[168:171], v5, s[20:23], s55 offen offset:0 sc1
  buffer_load_dwordx4 v[172:175], v5, s[20:23], s55 offen offset:1024 sc1
  s_waitcnt vmcnt(13) lgkmcnt(8)
  v_mfma_f32_16x16x32_bf16 v[24:27], v[44:47], v[120:123], 0
  ds_read_b128 v[96:99], v13 offset:50176
  v_mfma_f32_16x16x32_bf16 v[28:31], v[48:51], v[120:123], 0
  ds_read_b128 v[44:47], v13 offset:51200
  v_mfma_f32_16x16x32_bf16 v[32:35], v[52:55], v[120:123], 0
  ds_read_b128 v[48:51], v13 offset:52224
  v_mfma_f32_16x16x32_bf16 v[36:39], v[56:59], v[120:123], 0
  ds_read_b128 v[52:55], v13 offset:53248
  v_mfma_f32_16x16x32_bf16 v[40:43], v[60:63], v[120:123], 0
  ds_read_b128 v[56:59], v13 offset:54272
  buffer_load_dwordx4 v[176:179], v5, s[20:23], s55 offen offset:2048 sc1
  s_waitcnt vmcnt(13) lgkmcnt(8)
  v_mfma_f32_16x16x32_bf16 v[24:27], v[64:67], v[124:127], v[24:27]
  ds_read_b128 v[60:63], v13 offset:55296
  v_add_f32 v208, v208, v210
  v_add_f32 v209, v209, v211
  v_mfma_f32_16x16x32_bf16 v[28:31], v[68:71], v[124:127], v[28:31]
  ds_read_b128 v[64:67], v13 offset:56320
  v_permlane32_swap_b32 v208, v209
  v_add_f32 v208, v208, v209
  v_mfma_f32_16x16x32_bf16 v[32:35], v[72:75], v[124:127], v[32:35]
  ds_read_b128 v[68:71], v13 offset:57344
  v_mov_b32 v209, v208
  s_nop 1
  v_permlane16_swap_b32 v208, v209
  v_mfma_f32_16x16x32_bf16 v[36:39], v[76:79], v[124:127], v[36:39]
  ds_read_b128 v[72:75], v13 offset:58368
  v_add_f32 v208, v208, v209
  v_mov_b32 v209, v208
  v_mfma_f32_16x16x32_bf16 v[40:43], v[80:83], v[124:127], v[40:43]
  ds_read_b128 v[76:79], v13 offset:59392
  buffer_load_dwordx4 v[180:183], v5, s[20:23], s55 offen offset:3072 sc1
  s_add_u32 s55, s55, 4096
  v_permlane32_swap_b32 v208, v209
  v_mul_f32 v208, 0x3acccccd, v208
  s_waitcnt vmcnt(13) lgkmcnt(8)
  v_mfma_f32_16x16x32_bf16 v[24:27], v[84:87], v[128:131], v[24:27]
  ds_read_b128 v[80:83], v13 offset:60416
  v_mul_f32 v209, 0x3acccccd, v209
  v_fma_f32 v209, -v208, v208, v209
  v_mfma_f32_16x16x32_bf16 v[28:31], v[88:91], v[128:131], v[28:31]
  ds_read_b128 v[84:87], v13 offset:61440
  v_max_f32 v209, 0, v209
  v_add_f32 v19, 0x3727c5ac, v209
  v_mfma_f32_16x16x32_bf16 v[32:35], v[92:95], v[128:131], v[32:35]
  ds_read_b128 v[88:91], v13 offset:62464
  v_rsq_f32 v19, v19
  v_mov_b32 v18, v208
  v_mfma_f32_16x16x32_bf16 v[36:39], v[96:99], v[128:131], v[36:39]
  ds_read_b128 v[92:95], v13 offset:63488
  v_mul_f32 v210, v19, v19
  v_mul_f32 v210, v210, v209
  v_mfma_f32_16x16x32_bf16 v[40:43], v[44:47], v[128:131], v[40:43]
  ds_read_b128 v[96:99], v13 offset:64512
  buffer_load_dwordx4 v[184:187], v5, s[20:23], s55 offen offset:0 sc1
  v_add_f32 v210, 0x3727c5ac, v210
  v_rsq_f32 v210, v210
  s_waitcnt vmcnt(13) lgkmcnt(8)
  v_mfma_f32_16x16x32_bf16 v[24:27], v[48:51], v[132:135], v[24:27]
  ds_read_b128 v[44:47], v14 offset:0
  v_mul_f32 v20, v210, v19
  v_mul_f32 v21, v20, v18
  v_mfma_f32_16x16x32_bf16 v[28:31], v[52:55], v[132:135], v[28:31]
  ds_read_b128 v[48:51], v14 offset:1024
  v_mfma_f32_16x16x32_bf16 v[32:35], v[56:59], v[132:135], v[32:35]
  ds_read_b128 v[52:55], v14 offset:2048
  v_mfma_f32_16x16x32_bf16 v[36:39], v[60:63], v[132:135], v[36:39]
  ds_read_b128 v[56:59], v14 offset:3072
  v_mfma_f32_16x16x32_bf16 v[40:43], v[64:67], v[132:135], v[40:43]
  ds_read_b128 v[60:63], v14 offset:4096
  buffer_load_dwordx4 v[188:191], v5, s[20:23], s55 offen offset:1024 sc1
  v_mov_b32 v16, 4
  ds_write_b32 v15, v16
  s_waitcnt vmcnt(13) lgkmcnt(8)
  v_mfma_f32_16x16x32_bf16 v[24:27], v[68:71], v[136:139], v[24:27]
  ds_read_b128 v[64:67], v14 offset:5120
  v_mfma_f32_16x16x32_bf16 v[28:31], v[72:75], v[136:139], v[28:31]
  ds_read_b128 v[68:71], v14 offset:6144
  v_mfma_f32_16x16x32_bf16 v[32:35], v[76:79], v[136:139], v[32:35]
  ds_read_b128 v[72:75], v14 offset:7168
  v_mfma_f32_16x16x32_bf16 v[36:39], v[80:83], v[136:139], v[36:39]
  ds_read_b128 v[76:79], v14 offset:8192
  v_mfma_f32_16x16x32_bf16 v[40:43], v[84:87], v[136:139], v[40:43]
  ds_read_b128 v[80:83], v14 offset:9216
  buffer_load_dwordx4 v[192:195], v5, s[20:23], s55 offen offset:2048 sc1
  s_waitcnt vmcnt(13) lgkmcnt(8)
  v_mfma_f32_16x16x32_bf16 v[24:27], v[88:91], v[140:143], v[24:27]
  ds_read_b128 v[84:87], v14 offset:10240
  v_mfma_f32_16x16x32_bf16 v[28:31], v[92:95], v[140:143], v[28:31]
  ds_read_b128 v[88:91], v14 offset:11264
  v_mfma_f32_16x16x32_bf16 v[32:35], v[96:99], v[140:143], v[32:35]
  ds_read_b128 v[92:95], v12 offset:0
  v_mfma_f32_16x16x32_bf16 v[36:39], v[44:47], v[140:143], v[36:39]
  ds_read_b128 v[96:99], v12 offset:1024
  v_mfma_f32_16x16x32_bf16 v[40:43], v[48:51], v[140:143], v[40:43]
  ds_read_b128 v[44:47], v12 offset:2048
  buffer_load_dwordx4 v[196:199], v5, s[20:23], s55 offen offset:3072 sc1
  s_add_u32 s55, s55, 4096
  s_waitcnt vmcnt(13) lgkmcnt(8)
  v_mfma_f32_16x16x32_bf16 v[24:27], v[52:55], v[144:147], v[24:27]
  ds_read_b128 v[48:51], v12 offset:3072
  v_mfma_f32_16x16x32_bf16 v[28:31], v[56:59], v[144:147], v[28:31]
  ds_read_b128 v[52:55], v12 offset:4096
  ds_read_b128 v[232:235], v207 offset:0
  v_mfma_f32_16x16x32_bf16 v[32:35], v[60:63], v[144:147], v[32:35]
  ds_read_b128 v[56:59], v12 offset:5120
  v_mfma_f32_16x16x32_bf16 v[36:39], v[64:67], v[144:147], v[36:39]
  ds_read_b128 v[60:63], v12 offset:6144
  v_mfma_f32_16x16x32_bf16 v[40:43], v[68:71], v[144:147], v[40:43]
  ds_read_b128 v[64:67], v12 offset:7168
  s_waitcnt vmcnt(12) lgkmcnt(8)
  v_mfma_f32_16x16x32_bf16 v[24:27], v[72:75], v[148:151], v[24:27]
  ds_read_b128 v[68:71], v12 offset:8192
  ds_read_b128 v[236:239], v207 offset:64
  v_mfma_f32_16x16x32_bf16 v[28:31], v[76:79], v[148:151], v[28:31]
  ds_read_b128 v[72:75], v12 offset:9216
  v_mfma_f32_16x16x32_bf16 v[32:35], v[80:83], v[148:151], v[32:35]
  ds_read_b128 v[76:79], v12 offset:10240
  v_mfma_f32_16x16x32_bf16 v[36:39], v[84:87], v[148:151], v[36:39]
  ds_read_b128 v[80:83], v12 offset:11264
  v_mfma_f32_16x16x32_bf16 v[40:43], v[88:91], v[148:151], v[40:43]
  ds_read_b128 v[84:87], v12 offset:12288
  ds_read_b128 v[240:243], v207 offset:128
  s_waitcnt vmcnt(11) lgkmcnt(8)
  v_mfma_f32_16x16x32_bf16 v[24:27], v[92:95], v[152:155], v[24:27]
  ds_read_b128 v[88:91], v12 offset:13312
  v_mfma_f32_16x16x32_bf16 v[28:31], v[96:99], v[152:155], v[28:31]
  ds_read_b128 v[92:95], v12 offset:14336
  v_mfma_f32_16x16x32_bf16 v[32:35], v[44:47], v[152:155], v[32:35]
  ds_read_b128 v[96:99], v12 offset:15360
  v_mfma_f32_16x16x32_bf16 v[36:39], v[48:51], v[152:155], v[36:39]
  ds_read_b128 v[44:47], v12 offset:16384
  ds_read_b128 v[244:247], v207 offset:192
  v_mfma_f32_16x16x32_bf16 v[40:43], v[52:55], v[152:155], v[40:43]
  ds_read_b128 v[48:51], v12 offset:17408
  s_waitcnt vmcnt(10) lgkmcnt(8)
  v_mfma_f32_16x16x32_bf16 v[24:27], v[56:59], v[156:159], v[24:27]
  ds_read_b128 v[52:55], v12 offset:18432
  v_mfma_f32_16x16x32_bf16 v[28:31], v[60:63], v[156:159], v[28:31]
  ds_read_b128 v[56:59], v12 offset:19456
  v_mfma_f32_16x16x32_bf16 v[32:35], v[64:67], v[156:159], v[32:35]
  ds_read_b128 v[60:63], v12 offset:20480
  ds_read_b128 v[248:251], v207 offset:256
  v_mfma_f32_16x16x32_bf16 v[36:39], v[68:71], v[156:159], v[36:39]
  ds_read_b128 v[64:67], v12 offset:21504
  v_mfma_f32_16x16x32_bf16 v[40:43], v[72:75], v[156:159], v[40:43]
  ds_read_b128 v[68:71], v12 offset:22528
  s_waitcnt vmcnt(9) lgkmcnt(8)
  v_mfma_f32_16x16x32_bf16 v[24:27], v[76:79], v[160:163], v[24:27]
  ds_read_b128 v[72:75], v12 offset:23552
  v_mfma_f32_16x16x32_bf16 v[28:31], v[80:83], v[160:163], v[28:31]
  ds_read_b128 v[76:79], v12 offset:24576
  v_mfma_f32_16x16x32_bf16 v[32:35], v[84:87], v[160:163], v[32:35]
  ds_read_b128 v[80:83], v12 offset:25600
  v_mfma_f32_16x16x32_bf16 v[36:39], v[88:91], v[160:163], v[36:39]
  ds_read_b128 v[84:87], v12 offset:26624
  v_mfma_f32_16x16x32_bf16 v[40:43], v[92:95], v[160:163], v[40:43]
  ds_read_b128 v[88:91], v12 offset:27648
  s_waitcnt vmcnt(8) lgkmcnt(8)
  v_mfma_f32_16x16x32_bf16 v[24:27], v[96:99], v[164:167], v[24:27]
  ds_read_b128 v[92:95], v12 offset:28672
  v_mfma_f32_16x16x32_bf16 v[28:31], v[44:47], v[164:167], v[28:31]
  ds_read_b128 v[96:99], v12 offset:29696
  v_mfma_f32_16x16x32_bf16 v[32:35], v[48:51], v[164:167], v[32:35]
  ds_read_b128 v[44:47], v12 offset:30720
  v_mfma_f32_16x16x32_bf16 v[36:39], v[52:55], v[164:167], v[36:39]
  ds_read_b128 v[48:51], v12 offset:31744
  v_mfma_f32_16x16x32_bf16 v[40:43], v[56:59], v[164:167], v[40:43]
  ds_read_b128 v[52:55], v12 offset:32768
  v_mov_b32 v16, 5
  ds_write_b32 v15, v16
  s_waitcnt vmcnt(7) lgkmcnt(8)
  v_mfma_f32_16x16x32_bf16 v[24:27], v[60:63], v[168:171], v[24:27]
  ds_read_b128 v[56:59], v12 offset:33792
  v_mfma_f32_16x16x32_bf16 v[28:31], v[64:67], v[168:171], v[28:31]
  ds_read_b128 v[60:63], v12 offset:34816
  v_mfma_f32_16x16x32_bf16 v[32:35], v[68:71], v[168:171], v[32:35]
  ds_read_b128 v[64:67], v12 offset:35840
  v_mfma_f32_16x16x32_bf16 v[36:39], v[72:75], v[168:171], v[36:39]
  ds_read_b128 v[68:71], v12 offset:36864
  v_mfma_f32_16x16x32_bf16 v[40:43], v[76:79], v[168:171], v[40:43]
  ds_read_b128 v[72:75], v12 offset:37888
  s_waitcnt vmcnt(6) lgkmcnt(8)
  v_mfma_f32_16x16x32_bf16 v[24:27], v[80:83], v[172:175], v[24:27]
  ds_read_b128 v[76:79], v12 offset:38912
  v_mfma_f32_16x16x32_bf16 v[28:31], v[84:87], v[172:175], v[28:31]
  ds_read_b128 v[80:83], v12 offset:39936
  v_mul_f32_e64 v232, -v21, v232
  v_mul_f32_e64 v233, -v21, v233
  v_mfma_f32_16x16x32_bf16 v[32:35], v[88:91], v[172:175], v[32:35]
  ds_read_b128 v[84:87], v12 offset:40960
  v_mul_f32_e64 v234, -v21, v234
  v_mul_f32_e64 v235, -v21, v235
  v_mfma_f32_16x16x32_bf16 v[36:39], v[92:95], v[172:175], v[36:39]
  ds_read_b128 v[88:91], v12 offset:41984
  v_mul_f32_e64 v236, -v21, v236
  v_mul_f32_e64 v237, -v21, v237
  v_mfma_f32_16x16x32_bf16 v[40:43], v[96:99], v[172:175], v[40:43]
  ds_read_b128 v[92:95], v12 offset:43008
  v_mul_f32_e64 v238, -v21, v238
  v_mul_f32_e64 v239, -v21, v239
  s_waitcnt vmcnt(5) lgkmcnt(8)
  v_mfma_f32_16x16x32_bf16 v[24:27], v[44:47], v[176:179], v[24:27]
  ds_read_b128 v[96:99], v12 offset:44032
  v_mul_f32_e64 v240, -v21, v240
  v_mul_f32_e64 v241, -v21, v241
  v_mfma_f32_16x16x32_bf16 v[28:31], v[48:51], v[176:179], v[28:31]
  ds_read_b128 v[44:47], v12 offset:45056
  v_mul_f32_e64 v242, -v21, v242
  v_mul_f32_e64 v243, -v21, v243
  v_mfma_f32_16x16x32_bf16 v[32:35], v[52:55], v[176:179], v[32:35]
  ds_read_b128 v[48:51], v12 offset:46080
  v_mul_f32_e64 v244, -v21, v244
  v_mul_f32_e64 v245, -v21, v245
  v_mfma_f32_16x16x32_bf16 v[36:39], v[56:59], v[176:179], v[36:39]
  ds_read_b128 v[52:55], v12 offset:47104
  v_mul_f32_e64 v246, -v21, v246
  v_mul_f32_e64 v247, -v21, v247
  v_mfma_f32_16x16x32_bf16 v[40:43], v[60:63], v[176:179], v[40:43]
  ds_read_b128 v[56:59], v12 offset:48128
  v_mul_f32_e64 v248, -v21, v248
  v_mul_f32_e64 v249, -v21, v249
  s_waitcnt vmcnt(4) lgkmcnt(8)
  v_mfma_f32_16x16x32_bf16 v[24:27], v[64:67], v[180:183], v[24:27]
  ds_read_b128 v[60:63], v12 offset:49152
  v_mul_f32_e64 v250, -v21, v250
  v_mul_f32_e64 v251, -v21, v251
  v_mfma_f32_16x16x32_bf16 v[28:31], v[68:71], v[180:183], v[28:31]
  ds_read_b128 v[64:67], v12 offset:50176
  v_mfma_f32_16x16x32_bf16 v[32:35], v[72:75], v[180:183], v[32:35]
  ds_read_b128 v[68:71], v12 offset:51200
  v_mfma_f32_16x16x32_bf16 v[36:39], v[76:79], v[180:183], v[36:39]
  ds_read_b128 v[72:75], v12 offset:52224
  v_mfma_f32_16x16x32_bf16 v[40:43], v[80:83], v[180:183], v[40:43]
  ds_read_b128 v[76:79], v12 offset:53248
  s_waitcnt vmcnt(3) lgkmcnt(8)
  v_mfma_f32_16x16x32_bf16 v[24:27], v[84:87], v[184:187], v[24:27]
  ds_read_b128 v[80:83], v12 offset:54272
  v_mfma_f32_16x16x32_bf16 v[28:31], v[88:91], v[184:187], v[28:31]
  ds_read_b128 v[84:87], v12 offset:55296
  v_mfma_f32_16x16x32_bf16 v[32:35], v[92:95], v[184:187], v[32:35]
  ds_read_b128 v[88:91], v12 offset:56320
  v_mfma_f32_16x16x32_bf16 v[36:39], v[96:99], v[184:187], v[36:39]
  ds_read_b128 v[92:95], v12 offset:57344
  v_mfma_f32_16x16x32_bf16 v[40:43], v[44:47], v[184:187], v[40:43]
  ds_read_b128 v[96:99], v12 offset:58368
  s_waitcnt vmcnt(2) lgkmcnt(8)
  v_mfma_f32_16x16x32_bf16 v[24:27], v[48:51], v[188:191], v[24:27]
  ds_read_b128 v[44:47], v12 offset:59392
  v_mfma_f32_16x16x32_bf16 v[28:31], v[52:55], v[188:191], v[28:31]
  ds_read_b128 v[48:51], v12 offset:60416
  v_mfma_f32_16x16x32_bf16 v[32:35], v[56:59], v[188:191], v[32:35]
  v_mfma_f32_16x16x32_bf16 v[36:39], v[60:63], v[188:191], v[36:39]
  v_mfma_f32_16x16x32_bf16 v[40:43], v[64:67], v[188:191], v[40:43]
  s_waitcnt vmcnt(1) lgkmcnt(5)
  v_mfma_f32_16x16x32_bf16 v[24:27], v[68:71], v[192:195], v[24:27]
  v_mfma_f32_16x16x32_bf16 v[28:31], v[72:75], v[192:195], v[28:31]
  v_mfma_f32_16x16x32_bf16 v[32:35], v[76:79], v[192:195], v[32:35]
  v_mfma_f32_16x16x32_bf16 v[36:39], v[80:83], v[192:195], v[36:39]
  v_mfma_f32_16x16x32_bf16 v[40:43], v[84:87], v[192:195], v[40:43]
  s_waitcnt vmcnt(0) lgkmcnt(0)
  v_mfma_f32_16x16x32_bf16 v[24:27], v[88:91], v[196:199], v[24:27]
  v_mfma_f32_16x16x32_bf16 v[28:31], v[92:95], v[196:199], v[28:31]
  v_mfma_f32_16x16x32_bf16 v[32:35], v[96:99], v[196:199], v[32:35]
  v_mfma_f32_16x16x32_bf16 v[36:39], v[44:47], v[196:199], v[36:39]
  v_mfma_f32_16x16x32_bf16 v[40:43], v[48:51], v[196:199], v[40:43]
  s_nop 3
  v_pk_fma_f32 v[24:25], v[24:25], v[20:21], v[232:233] op_sel_hi:[1,0,1]
  v_pk_fma_f32 v[26:27], v[26:27], v[20:21], v[234:235] op_sel_hi:[1,0,1]
  v_pk_fma_f32 v[28:29], v[28:29], v[20:21], v[236:237] op_sel_hi:[1,0,1]
  v_pk_fma_f32 v[30:31], v[30:31], v[20:21], v[238:239] op_sel_hi:[1,0,1]
  v_pk_fma_f32 v[32:33], v[32:33], v[20:21], v[240:241] op_sel_hi:[1,0,1]
  v_pk_fma_f32 v[34:35], v[34:35], v[20:21], v[242:243] op_sel_hi:[1,0,1]
  v_pk_fma_f32 v[36:37], v[36:37], v[20:21], v[244:245] op_sel_hi:[1,0,1]
  v_pk_fma_f32 v[38:39], v[38:39], v[20:21], v[246:247] op_sel_hi:[1,0,1]
  v_pk_fma_f32 v[40:41], v[40:41], v[20:21], v[248:249] op_sel_hi:[1,0,1]
  v_pk_fma_f32 v[42:43], v[42:43], v[20:21], v[250:251] op_sel_hi:[1,0,1]
  v_pk_mul_f32 v[44:45], v[24:25], v[24:25]
  v_pk_mul_f32 v[46:47], v[26:27], v[26:27]
  v_pk_mul_f32 v[48:49], v[28:29], v[28:29]
  v_pk_mul_f32 v[50:51], v[30:31], v[30:31]
  v_pk_mul_f32 v[52:53], v[32:33], v[32:33]
  v_pk_mul_f32 v[54:55], v[34:35], v[34:35]
  v_pk_mul_f32 v[56:57], v[36:37], v[36:37]
  v_pk_mul_f32 v[58:59], v[38:39], v[38:39]
  v_pk_mul_f32 v[60:61], v[40:41], v[40:41]
  v_pk_mul_f32 v[62:63], v[42:43], v[42:43]
  v_pk_fma_f32 v[44:45], v[44:45], s[88:89], v[22:23] op_sel_hi:[1,1,0]
  v_pk_fma_f32 v[46:47], v[46:47], s[88:89], v[22:23] op_sel_hi:[1,1,0]
  v_pk_fma_f32 v[48:49], v[48:49], s[88:89], v[22:23] op_sel_hi:[1,1,0]
  v_pk_fma_f32 v[50:51], v[50:51], s[88:89], v[22:23] op_sel_hi:[1,1,0]
  v_pk_fma_f32 v[52:53], v[52:53], s[88:89], v[22:23] op_sel_hi:[1,1,0]
  v_pk_fma_f32 v[54:55], v[54:55], s[88:89], v[22:23] op_sel_hi:[1,1,0]
  v_pk_fma_f32 v[56:57], v[56:57], s[88:89], v[22:23] op_sel_hi:[1,1,0]
  v_pk_fma_f32 v[58:59], v[58:59], s[88:89], v[22:23] op_sel_hi:[1,1,0]
  v_pk_fma_f32 v[60:61], v[60:61], s[88:89], v[22:23] op_sel_hi:[1,1,0]
  v_pk_fma_f32 v[62:63], v[62:63], s[88:89], v[22:23] op_sel_hi:[1,1,0]
  v_pk_mul_f32 v[44:45], v[44:45], v[24:25]
  v_pk_mul_f32 v[46:47], v[46:47], v[26:27]
  v_pk_mul_f32 v[48:49], v[48:49], v[28:29]
  v_pk_mul_f32 v[50:51], v[50:51], v[30:31]
  v_pk_mul_f32 v[52:53], v[52:53], v[32:33]
  v_pk_mul_f32 v[54:55], v[54:55], v[34:35]
  v_pk_mul_f32 v[56:57], v[56:57], v[36:37]
  v_pk_mul_f32 v[58:59], v[58:59], v[38:39]
  v_pk_mul_f32 v[60:61], v[60:61], v[40:41]
  v_pk_mul_f32 v[62:63], v[62:63], v[42:43]
  v_exp_f32 v44, v44
  v_exp_f32 v45, v45
  v_exp_f32 v46, v46
  v_exp_f32 v47, v47
  v_exp_f32 v48, v48
  v_exp_f32 v49, v49
  v_exp_f32 v50, v50
  v_exp_f32 v51, v51
  v_exp_f32 v52, v52
  v_exp_f32 v53, v53
  v_exp_f32 v54, v54
  v_exp_f32 v55, v55
  v_exp_f32 v56, v56
  v_exp_f32 v57, v57
  v_exp_f32 v58, v58
  v_exp_f32 v59, v59
  v_exp_f32 v60, v60
  v_exp_f32 v61, v61
  v_exp_f32 v62, v62
  v_exp_f32 v63, v63
  v_pk_add_f32 v[44:45], v[44:45], 1.0 op_sel_hi:[1,0]
  v_pk_add_f32 v[46:47], v[46:47], 1.0 op_sel_hi:[1,0]
  v_pk_add_f32 v[48:49], v[48:49], 1.0 op_sel_hi:[1,0]
  v_pk_add_f32 v[50:51], v[50:51], 1.0 op_sel_hi:[1,0]
  v_pk_add_f32 v[52:53], v[52:53], 1.0 op_sel_hi:[1,0]
  v_pk_add_f32 v[54:55], v[54:55], 1.0 op_sel_hi:[1,0]
  v_pk_add_f32 v[56:57], v[56:57], 1.0 op_sel_hi:[1,0]
  v_pk_add_f32 v[58:59], v[58:59], 1.0 op_sel_hi:[1,0]
  v_pk_add_f32 v[60:61], v[60:61], 1.0 op_sel_hi:[1,0]
  v_pk_add_f32 v[62:63], v[62:63], 1.0 op_sel_hi:[1,0]
  v_rcp_f32 v44, v44
  v_rcp_f32 v45, v45
  v_rcp_f32 v46, v46
  v_rcp_f32 v47, v47
  v_rcp_f32 v48, v48
  v_rcp_f32 v49, v49
  v_rcp_f32 v50, v50
  v_rcp_f32 v51, v51
  v_rcp_f32 v52, v52
  v_rcp_f32 v53, v53
  v_rcp_f32 v54, v54
  v_rcp_f32 v55, v55
  v_rcp_f32 v56, v56
  v_rcp_f32 v57, v57
  v_rcp_f32 v58, v58
  v_rcp_f32 v59, v59
  v_rcp_f32 v60, v60
  v_rcp_f32 v61, v61
  v_rcp_f32 v62, v62
  v_rcp_f32 v63, v63
  v_pk_mul_f32 v[24:25], v[24:25], v[44:45]
  v_pk_mul_f32 v[26:27], v[26:27], v[46:47]
  v_pk_mul_f32 v[28:29], v[28:29], v[48:49]
  v_pk_mul_f32 v[30:31], v[30:31], v[50:51]
  v_pk_mul_f32 v[32:33], v[32:33], v[52:53]
  v_pk_mul_f32 v[34:35], v[34:35], v[54:55]
  v_pk_mul_f32 v[36:37], v[36:37], v[56:57]
  v_pk_mul_f32 v[38:39], v[38:39], v[58:59]
  v_pk_mul_f32 v[40:41], v[40:41], v[60:61]
  v_pk_mul_f32 v[42:43], v[42:43], v[62:63]
  v_cvt_pk_bf16_f32 v228, v40, v41
  v_cvt_pk_bf16_f32 v230, v40, v41
  v_cvt_pk_bf16_f32 v229, v42, v43
  v_cvt_pk_bf16_f32 v231, v42, v43
  v_cvt_pk_bf16_f32 v220, v24, v25
  v_cvt_pk_bf16_f32 v221, v26, v27
  v_cvt_pk_bf16_f32 v222, v28, v29
  v_cvt_pk_bf16_f32 v223, v30, v31
  v_cvt_pk_bf16_f32 v224, v32, v33
  v_cvt_pk_bf16_f32 v225, v34, v35
  v_cvt_pk_bf16_f32 v226, v36, v37
  v_cvt_pk_bf16_f32 v227, v38, v39
  v_permlane16_swap_b32 v228, v230
  v_permlane16_swap_b32 v229, v231
  v_permlane16_swap_b32 v220, v222
  v_permlane16_swap_b32 v221, v223
  v_permlane16_swap_b32 v224, v226
  v_permlane16_swap_b32 v225, v227
  s_cmp_eq_u32 s6, 0
  s_cbranch_scc1 SL_109
  buffer_store_dwordx4 v[220:223], v6, s[16:19], s40 offen
  buffer_store_dwordx4 v[224:227], v6, s[16:19], s40 offen offset:1024
  s_mov_b32 exec_lo, 0xffff
  s_mov_b32 exec_hi, 0xffff
  buffer_store_dwordx4 v[228:231], v8, s[16:19], s41 offen
  s_mov_b64 exec, -1
  s_cmp_eq_u32 s59, 0
  s_cbranch_scc1 NE_111
  s_mov_b32 exec_lo, s46
  s_mov_b32 exec_hi, s46
  buffer_store_dwordx4 v[220:223], v6, s[16:19], s44 offen sc1
  buffer_store_dwordx4 v[224:227], v6, s[16:19], s44 offen offset:1024 sc1
  s_mov_b32 exec_lo, s47
  s_mov_b32 exec_hi, s47
  buffer_store_dwordx4 v[228:231], v8, s[16:19], s45 offen sc1
  s_mov_b64 exec, -1
  s_waitcnt vmcnt(3)
  s_branch DN_112
NE_111:
  s_waitcnt vmcnt(0)
DN_112:
  s_mov_b64 exec, 1
  buffer_store_dword v252, v11, s[16:19], s42 offen
  s_mov_b64 exec, -1
  s_branch SE_110
SL_109:
  s_nop 1
  buffer_store_dwordx4 v[220:223], v6, s[16:19], s40 offen sc1
  buffer_store_dwordx4 v[224:227], v6, s[16:19], s40 offen offset:1024 sc1
  s_mov_b32 exec_lo, 0xffff
  s_mov_b32 exec_hi, 0xffff
  buffer_store_dwordx4 v[228:231], v8, s[16:19], s41 offen sc1
  s_mov_b64 exec, -1
  s_cmp_eq_u32 s59, 0
  s_cbranch_scc1 NE_113
  s_mov_b32 exec_lo, s46
  s_mov_b32 exec_hi, s46
  buffer_store_dwordx4 v[220:223], v6, s[16:19], s44 offen sc1
  buffer_store_dwordx4 v[224:227], v6, s[16:19], s44 offen offset:1024 sc1
  s_mov_b32 exec_lo, s47
  s_mov_b32 exec_hi, s47
  buffer_store_dwordx4 v[228:231], v8, s[16:19], s45 offen sc1
  s_mov_b64 exec, -1
  s_waitcnt vmcnt(3)
  s_branch DN_114
NE_113:
  s_waitcnt vmcnt(0)
DN_114:
  s_mov_b64 exec, 1
  buffer_store_dword v252, v11, s[16:19], s42 offen sc1
  s_mov_b64 exec, -1
SE_110:
  v_mul_f32 v18, v18, v19
  v_pk_fma_f32 v[24:25], v[100:101], v[18:19], v[18:19] op_sel:[0,1,0] op_sel_hi:[1,1,0] neg_lo:[0,0,1] neg_hi:[0,0,1]
  v_pk_fma_f32 v[26:27], v[102:103], v[18:19], v[18:19] op_sel:[0,1,0] op_sel_hi:[1,1,0] neg_lo:[0,0,1] neg_hi:[0,0,1]
  v_pk_fma_f32 v[28:29], v[104:105], v[18:19], v[18:19] op_sel:[0,1,0] op_sel_hi:[1,1,0] neg_lo:[0,0,1] neg_hi:[0,0,1]
  v_pk_fma_f32 v[30:31], v[106:107], v[18:19], v[18:19] op_sel:[0,1,0] op_sel_hi:[1,1,0] neg_lo:[0,0,1] neg_hi:[0,0,1]
  v_pk_fma_f32 v[32:33], v[108:109], v[18:19], v[18:19] op_sel:[0,1,0] op_sel_hi:[1,1,0] neg_lo:[0,0,1] neg_hi:[0,0,1]
  v_pk_fma_f32 v[34:35], v[110:111], v[18:19], v[18:19] op_sel:[0,1,0] op_sel_hi:[1,1,0] neg_lo:[0,0,1] neg_hi:[0,0,1]
  v_pk_fma_f32 v[36:37], v[112:113], v[18:19], v[18:19] op_sel:[0,1,0] op_sel_hi:[1,1,0] neg_lo:[0,0,1] neg_hi:[0,0,1]
  v_pk_fma_f32 v[38:39], v[114:115], v[18:19], v[18:19] op_sel:[0,1,0] op_sel_hi:[1,1,0] neg_lo:[0,0,1] neg_hi:[0,0,1]
  v_pk_fma_f32 v[40:41], v[116:117], v[18:19], v[18:19] op_sel:[0,1,0] op_sel_hi:[1,1,0] neg_lo:[0,0,1] neg_hi:[0,0,1]
  v_pk_fma_f32 v[42:43], v[118:119], v[18:19], v[18:19] op_sel:[0,1,0] op_sel_hi:[1,1,0] neg_lo:[0,0,1] neg_hi:[0,0,1]
  s_lshl_b32 s34, s51, 3
  s_sub_u32 s33, s34, 8
  s_and_b32 s34, s34, 0x380
  s_add_u32 s35, s34, 127
  v_min_u32 v204, 23, v1
  v_add_u32 v204, s33, v204
  v_max_i32 v204, s34, v204
  v_min_i32 v204, s35, v204
  v_lshlrev_b32 v204, 2, v204
  s_mov_b32 s33, 0xb93000
  s_mov_b32 s55, 0x0
  s_mul_i32 s40, s51, 20480
  s_add_u32 s40, s40, 0x0
  s_add_u32 s41, s40, s54
  s_add_u32 s40, s40, s53
  s_lshl_b32 s42, s51, 3
  s_add_u32 s42, s42, s50
  s_mul_i32 s43, s51, 20480
  s_lshl_b32 s94, s50, 7
  s_add_u32 s43, s43, s94
  s_add_u32 s43, s43, 0x280000
  s_lshl_b32 s42, s42, 2
  s_add_u32 s42, s42, 0xb94000
  v_mov_b32 v52, 0x23bd0
  s_mov_b32 s7, 2000000
W_115:
  ds_read_b128 v[44:47], v52
  s_waitcnt lgkmcnt(0)
  v_min3_u32 v44, v44, v45, v46
  v_min_u32 v44, v44, v47
  v_cmp_gt_u32 vcc, 15, v44
  s_nop 0
  s_cbranch_vccz WD_116
  s_sub_u32 s7, s7, 1
  s_cbranch_scc0 W_115
WD_116:
  ds_read_b128 v[44:47], v12 offset:61440
  ds_read_b128 v[48:51], v12 offset:62464
  ds_read_b128 v[52:55], v12 offset:63488
  ds_read_b128 v[56:59], v12 offset:64512
  ds_read_b128 v[60:63], v13 offset:0
  ds_read_b128 v[64:67], v13 offset:1024
  ds_read_b128 v[68:71], v13 offset:2048
  ds_read_b128 v[72:75], v13 offset:3072
  ds_read_b128 v[76:79], v13 offset:4096
  ds_read_b128 v[80:83], v13 offset:5120
  ds_read_b128 v[84:87], v13 offset:6144
  ds_read_b128 v[88:91], v13 offset:7168
  ds_read_b128 v[92:95], v13 offset:8192
  s_mov_b32 s7, 400000
P_117:
  buffer_load_dword v205, v204, s[16:19], s33 offen sc1
  buffer_load_dword v208, v17, s[16:19], 0 offen sc1
  s_waitcnt vmcnt(0)
PE_119:
  v_cmp_eq_u32 s[96:97], -1, v208
  v_cmp_ne_u32 vcc, s99, v205
  s_nop 1
  s_or_b64 vcc, vcc, s[96:97]
  s_cbranch_vccz PD_118
  s_sub_u32 s7, s7, 1
  s_cbranch_scc0 P_117
PD_118:
  buffer_load_dwordx4 v[120:123], v200, s[16:19], s55 offen offset:0 sc1
  buffer_load_dwordx4 v[124:127], v200, s[16:19], s55 offen offset:1024 sc1
  buffer_load_dwordx4 v[128:131], v200, s[16:19], s55 offen offset:2048 sc1
  buffer_load_dwordx4 v[132:135], v200, s[16:19], s55 offen offset:3072 sc1
  s_add_u32 s55, s55, 4096
  buffer_load_dwordx4 v[136:139], v200, s[16:19], s55 offen offset:0 sc1
  buffer_load_dwordx4 v[140:143], v201, s[16:19], s55 offen offset:1024 sc1
  buffer_load_dwordx4 v[144:147], v201, s[16:19], s55 offen offset:2048 sc1
  buffer_load_dwordx4 v[148:151], v201, s[16:19], s55 offen offset:3072 sc1
  s_add_u32 s55, s55, 4096
  buffer_load_dwordx4 v[152:155], v201, s[16:19], s55 offen offset:0 sc1
  buffer_load_dwordx4 v[156:159], v201, s[16:19], s55 offen offset:1024 sc1
  buffer_load_dwordx4 v[160:163], v202, s[16:19], s55 offen offset:2048 sc1
  buffer_load_dwordx4 v[164:167], v202, s[16:19], s55 offen offset:3072 sc1
  s_add_u32 s55, s55, 4096
  buffer_load_dwordx4 v[168:171], v202, s[16:19], s55 offen offset:0 sc1
  buffer_load_dwordx4 v[172:175], v202, s[16:19], s55 offen offset:1024 sc1
  s_waitcnt vmcnt(13) lgkmcnt(8)
  v_mfma_f32_16x16x32_bf16 v[24:27], v[44:47], v[120:123], v[24:27]
  ds_read_b128 v[96:99], v13 offset:9216
  v_mfma_f32_16x16x32_bf16 v[28:31], v[48:51], v[120:123], v[28:31]
  ds_read_b128 v[44:47], v13 offset:10240
  v_mfma_f32_16x16x32_bf16 v[32:35], v[52:55], v[120:123], v[32:35]
  ds_read_b128 v[48:51], v13 offset:11264
  v_mfma_f32_16x16x32_bf16 v[36:39], v[56:59], v[120:123], v[36:39]
  ds_read_b128 v[52:55], v13 offset:12288
  v_mfma_f32_16x16x32_bf16 v[40:43], v[60:63], v[120:123], v[40:43]
  ds_read_b128 v[56:59], v13 offset:13312
  buffer_load_dwordx4 v[176:179], v202, s[16:19], s55 offen offset:2048 sc1
  s_waitcnt vmcnt(13) lgkmcnt(8)
  v_mfma_f32_16x16x32_bf16 v[24:27], v[64:67], v[124:127], v[24:27]
  ds_read_b128 v[60:63], v13 offset:14336
  v_mfma_f32_16x16x32_bf16 v[28:31], v[68:71], v[124:127], v[28:31]
  ds_read_b128 v[64:67], v13 offset:15360
  v_mfma_f32_16x16x32_bf16 v[32:35], v[72:75], v[124:127], v[32:35]
  ds_read_b128 v[68:71], v13 offset:16384
  v_mfma_f32_16x16x32_bf16 v[36:39], v[76:79], v[124:127], v[36:39]
  ds_read_b128 v[72:75], v13 offset:17408
  v_mfma_f32_16x16x32_bf16 v[40:43], v[80:83], v[124:127], v[40:43]
  ds_read_b128 v[76:79], v13 offset:18432
  buffer_load_dwordx4 v[180:183], v203, s[16:19], s55 offen offset:3072 sc1
  s_add_u32 s55, s55, 4096
  s_waitcnt vmcnt(13) lgkmcnt(8)
  v_mfma_f32_16x16x32_bf16 v[24:27], v[84:87], v[128:131], v[24:27]
  ds_read_b128 v[80:83], v13 offset:19456
  v_mfma_f32_16x16x32_bf16 v[28:31], v[88:91], v[128:131], v[28:31]
  ds_read_b128 v[84:87], v13 offset:20480
  v_mfma_f32_16x16x32_bf16 v[32:35], v[92:95], v[128:131], v[32:35]
  ds_read_b128 v[88:91], v13 offset:21504
  v_mfma_f32_16x16x32_bf16 v[36:39], v[96:99], v[128:131], v[36:39]
  ds_read_b128 v[92:95], v13 offset:22528
  v_mfma_f32_16x16x32_bf16 v[40:43], v[44:47], v[128:131], v[40:43]
  ds_read_b128 v[96:99], v13 offset:23552
  buffer_load_dwordx4 v[184:187], v203, s[16:19], s55 offen offset:0 sc1
  s_waitcnt vmcnt(13) lgkmcnt(8)
  v_mfma_f32_16x16x32_bf16 v[24:27], v[48:51], v[132:135], v[24:27]
  ds_read_b128 v[44:47], v13 offset:24576
  v_mfma_f32_16x16x32_bf16 v[28:31], v[52:55], v[132:135], v[28:31]
  ds_read_b128 v[48:51], v13 offset:25600
  v_mfma_f32_16x16x32_bf16 v[32:35], v[56:59], v[132:135], v[32:35]
  ds_read_b128 v[52:55], v13 offset:26624
  v_mfma_f32_16x16x32_bf16 v[36:39], v[60:63], v[132:135], v[36:39]
  ds_read_b128 v[56:59], v13 offset:27648
  v_mfma_f32_16x16x32_bf16 v[40:43], v[64:67], v[132:135], v[40:43]
  ds_read_b128 v[60:63], v13 offset:28672
  buffer_load_dwordx4 v[188:191], v203, s[16:19], s55 offen offset:1024 sc1
  v_mov_b32 v16, 7
  ds_write_b32 v15, v16
  s_waitcnt vmcnt(13) lgkmcnt(8)
  v_mfma_f32_16x16x32_bf16 v[24:27], v[68:71], v[136:139], v[24:27]
  ds_read_b128 v[64:67], v13 offset:29696
  v_mfma_f32_16x16x32_bf16 v[28:31], v[72:75], v[136:139], v[28:31]
  ds_read_b128 v[68:71], v13 offset:30720
  v_mfma_f32_16x16x32_bf16 v[32:35], v[76:79], v[136:139], v[32:35]
  ds_read_b128 v[72:75], v13 offset:31744
  v_mfma_f32_16x16x32_bf16 v[36:39], v[80:83], v[136:139], v[36:39]
  ds_read_b128 v[76:79], v13 offset:32768
  v_mfma_f32_16x16x32_bf16 v[40:43], v[84:87], v[136:139], v[40:43]
  ds_read_b128 v[80:83], v13 offset:33792
  buffer_load_dwordx4 v[192:195], v203, s[16:19], s55 offen offset:2048 sc1
  s_waitcnt vmcnt(13) lgkmcnt(8)
  v_mfma_f32_16x16x32_bf16 v[24:27], v[88:91], v[140:143], v[24:27]
  ds_read_b128 v[84:87], v13 offset:34816
  v_mfma_f32_16x16x32_bf16 v[28:31], v[92:95], v[140:143], v[28:31]
  ds_read_b128 v[88:91], v13 offset:35840
  v_mfma_f32_16x16x32_bf16 v[32:35], v[96:99], v[140:143], v[32:35]
  ds_read_b128 v[92:95], v13 offset:36864
  v_mfma_f32_16x16x32_bf16 v[36:39], v[44:47], v[140:143], v[36:39]
  ds_read_b128 v[96:99], v13 offset:37888
  v_mfma_f32_16x16x32_bf16 v[40:43], v[48:51], v[140:143], v[40:43]
  ds_read_b128 v[44:47], v13 offset:38912
  buffer_load_dwordx4 v[196:199], v203, s[16:19], s55 offen offset:3072 sc1
  s_add_u32 s55, s55, 4096
  s_waitcnt vmcnt(13) lgkmcnt(8)
  v_mfma_f32_16x16x32_bf16 v[24:27], v[52:55], v[144:147], v[24:27]
  ds_read_b128 v[48:51], v13 offset:39936
  v_mfma_f32_16x16x32_bf16 v[28:31], v[56:59], v[144:147], v[28:31]
  ds_read_b128 v[52:55], v13 offset:40960
  v_mfma_f32_16x16x32_bf16 v[32:35], v[60:63], v[144:147], v[32:35]
  ds_read_b128 v[56:59], v13 offset:41984
  v_mfma_f32_16x16x32_bf16 v[36:39], v[64:67], v[144:147], v[36:39]
  ds_read_b128 v[60:63], v13 offset:43008
  v_mfma_f32_16x16x32_bf16 v[40:43], v[68:71], v[144:147], v[40:43]
  ds_read_b128 v[64:67], v13 offset:44032
  s_waitcnt vmcnt(12) lgkmcnt(8)
  v_mfma_f32_16x16x32_bf16 v[24:27], v[72:75], v[148:151], v[24:27]
  ds_read_b128 v[68:71], v13 offset:45056
  v_mfma_f32_16x16x32_bf16 v[28:31], v[76:79], v[148:151], v[28:31]
  ds_read_b128 v[72:75], v13 offset:46080
  v_mfma_f32_16x16x32_bf16 v[32:35], v[80:83], v[148:151], v[32:35]
  ds_read_b128 v[76:79], v13 offset:47104
  v_mfma_f32_16x16x32_bf16 v[36:39], v[84:87], v[148:151], v[36:39]
  ds_read_b128 v[80:83], v13 offset:48128
  v_mfma_f32_16x16x32_bf16 v[40:43], v[88:91], v[148:151], v[40:43]
  ds_read_b128 v[84:87], v13 offset:49152
  s_waitcnt vmcnt(11) lgkmcnt(8)
  v_mfma_f32_16x16x32_bf16 v[24:27], v[92:95], v[152:155], v[24:27]
  ds_read_b128 v[88:91], v13 offset:50176
  v_mfma_f32_16x16x32_bf16 v[28:31], v[96:99], v[152:155], v[28:31]
  ds_read_b128 v[92:95], v13 offset:51200
  v_mfma_f32_16x16x32_bf16 v[32:35], v[44:47], v[152:155], v[32:35]
  ds_read_b128 v[96:99], v13 offset:52224
  v_mfma_f32_16x16x32_bf16 v[36:39], v[48:51], v[152:155], v[36:39]
  ds_read_b128 v[44:47], v13 offset:53248
  v_mfma_f32_16x16x32_bf16 v[40:43], v[52:55], v[152:155], v[40:43]
  ds_read_b128 v[48:51], v13 offset:54272
  s_waitcnt vmcnt(10) lgkmcnt(8)
  v_mfma_f32_16x16x32_bf16 v[24:27], v[56:59], v[156:159], v[24:27]
  ds_read_b128 v[52:55], v13 offset:55296
  v_mfma_f32_16x16x32_bf16 v[28:31], v[60:63], v[156:159], v[28:31]
  ds_read_b128 v[56:59], v13 offset:56320
  v_mfma_f32_16x16x32_bf16 v[32:35], v[64:67], v[156:159], v[32:35]
  ds_read_b128 v[60:63], v13 offset:57344
  v_mfma_f32_16x16x32_bf16 v[36:39], v[68:71], v[156:159], v[36:39]
  ds_read_b128 v[64:67], v13 offset:58368
  v_mfma_f32_16x16x32_bf16 v[40:43], v[72:75], v[156:159], v[40:43]
  ds_read_b128 v[68:71], v13 offset:59392
  s_waitcnt vmcnt(9) lgkmcnt(8)
  v_mfma_f32_16x16x32_bf16 v[24:27], v[76:79], v[160:163], v[24:27]
  ds_read_b128 v[72:75], v13 offset:60416
  v_mfma_f32_16x16x32_bf16 v[28:31], v[80:83], v[160:163], v[28:31]
  ds_read_b128 v[76:79], v13 offset:61440
  v_mfma_f32_16x16x32_bf16 v[32:35], v[84:87], v[160:163], v[32:35]
  ds_read_b128 v[80:83], v13 offset:62464
  v_mfma_f32_16x16x32_bf16 v[36:39], v[88:91], v[160:163], v[36:39]
  ds_read_b128 v[84:87], v13 offset:63488
  v_mfma_f32_16x16x32_bf16 v[40:43], v[92:95], v[160:163], v[40:43]
  ds_read_b128 v[88:91], v13 offset:64512
  s_waitcnt vmcnt(8) lgkmcnt(8)
  v_mfma_f32_16x16x32_bf16 v[24:27], v[96:99], v[164:167], v[24:27]
  ds_read_b128 v[92:95], v14 offset:0
  v_mfma_f32_16x16x32_bf16 v[28:31], v[44:47], v[164:167], v[28:31]
  ds_read_b128 v[96:99], v14 offset:1024
  v_mfma_f32_16x16x32_bf16 v[32:35], v[48:51], v[164:167], v[32:35]
  ds_read_b128 v[44:47], v14 offset:2048
  v_mfma_f32_16x16x32_bf16 v[36:39], v[52:55], v[164:167], v[36:39]
  ds_read_b128 v[48:51], v14 offset:3072
  v_mfma_f32_16x16x32_bf16 v[40:43], v[56:59], v[164:167], v[40:43]
  ds_read_b128 v[52:55], v14 offset:4096
  v_mov_b32 v16, 8
  ds_write_b32 v15, v16
  s_waitcnt vmcnt(7) lgkmcnt(8)
  v_mfma_f32_16x16x32_bf16 v[24:27], v[60:63], v[168:171], v[24:27]
  ds_read_b128 v[56:59], v14 offset:5120
  v_mfma_f32_16x16x32_bf16 v[28:31], v[64:67], v[168:171], v[28:31]
  ds_read_b128 v[60:63], v14 offset:6144
  v_mfma_f32_16x16x32_bf16 v[32:35], v[68:71], v[168:171], v[32:35]
  ds_read_b128 v[64:67], v14 offset:7168
  v_mfma_f32_16x16x32_bf16 v[36:39], v[72:75], v[168:171], v[36:39]
  ds_read_b128 v[68:71], v14 offset:8192
  v_mfma_f32_16x16x32_bf16 v[40:43], v[76:79], v[168:171], v[40:43]
  ds_read_b128 v[72:75], v14 offset:9216
  s_waitcnt vmcnt(6) lgkmcnt(8)
  v_mfma_f32_16x16x32_bf16 v[24:27], v[80:83], v[172:175], v[24:27]
  ds_read_b128 v[76:79], v14 offset:10240
  v_mfma_f32_16x16x32_bf16 v[28:31], v[84:87], v[172:175], v[28:31]
  ds_read_b128 v[80:83], v14 offset:11264
  v_mfma_f32_16x16x32_bf16 v[32:35], v[88:91], v[172:175], v[32:35]
  ds_read_b128 v[84:87], v12 offset:0
  v_mfma_f32_16x16x32_bf16 v[36:39], v[92:95], v[172:175], v[36:39]
  ds_read_b128 v[88:91], v12 offset:1024
  v_mfma_f32_16x16x32_bf16 v[40:43], v[96:99], v[172:175], v[40:43]
  ds_read_b128 v[92:95], v12 offset:2048
  s_waitcnt vmcnt(5) lgkmcnt(8)
  v_mfma_f32_16x16x32_bf16 v[24:27], v[44:47], v[176:179], v[24:27]
  ds_read_b128 v[96:99], v12 offset:3072
  v_mfma_f32_16x16x32_bf16 v[28:31], v[48:51], v[176:179], v[28:31]
  ds_read_b128 v[44:47], v12 offset:4096
  v_mfma_f32_16x16x32_bf16 v[32:35], v[52:55], v[176:179], v[32:35]
  ds_read_b128 v[48:51], v12 offset:5120
  v_mfma_f32_16x16x32_bf16 v[36:39], v[56:59], v[176:179], v[36:39]
  ds_read_b128 v[52:55], v12 offset:6144
  v_mfma_f32_16x16x32_bf16 v[40:43], v[60:63], v[176:179], v[40:43]
  ds_read_b128 v[56:59], v12 offset:7168
  s_waitcnt vmcnt(4) lgkmcnt(8)
  v_mfma_f32_16x16x32_bf16 v[24:27], v[64:67], v[180:183], v[24:27]
  ds_read_b128 v[60:63], v12 offset:8192
  v_mfma_f32_16x16x32_bf16 v[28:31], v[68:71], v[180:183], v[28:31]
  ds_read_b128 v[64:67], v12 offset:9216
  v_mfma_f32_16x16x32_bf16 v[32:35], v[72:75], v[180:183], v[32:35]
  ds_read_b128 v[68:71], v12 offset:10240
  v_mfma_f32_16x16x32_bf16 v[36:39], v[76:79], v[180:183], v[36:39]
  ds_read_b128 v[72:75], v12 offset:11264
  v_mfma_f32_16x16x32_bf16 v[40:43], v[80:83], v[180:183], v[40:43]
  ds_read_b128 v[76:79], v12 offset:12288
  s_waitcnt vmcnt(3) lgkmcnt(8)
  v_mfma_f32_16x16x32_bf16 v[24:27], v[84:87], v[184:187], v[24:27]
  ds_read_b128 v[80:83], v12 offset:13312
  v_mfma_f32_16x16x32_bf16 v[28:31], v[88:91], v[184:187], v[28:31]
  ds_read_b128 v[84:87], v12 offset:14336
  v_mfma_f32_16x16x32_bf16 v[32:35], v[92:95], v[184:187], v[32:35]
  ds_read_b128 v[88:91], v12 offset:15360
  v_mfma_f32_16x16x32_bf16 v[36:39], v[96:99], v[184:187], v[36:39]
  ds_read_b128 v[92:95], v12 offset:16384
  v_mfma_f32_16x16x32_bf16 v[40:43], v[44:47], v[184:187], v[40:43]
  ds_read_b128 v[96:99], v12 offset:17408
  s_waitcnt vmcnt(2) lgkmcnt(8)
  v_mfma_f32_16x16x32_bf16 v[24:27], v[48:51], v[188:191], v[24:27]
  ds_read_b128 v[44:47], v12 offset:18432
  v_mfma_f32_16x16x32_bf16 v[28:31], v[52:55], v[188:191], v[28:31]
  ds_read_b128 v[48:51], v12 offset:19456
  v_mfma_f32_16x16x32_bf16 v[32:35], v[56:59], v[188:191], v[32:35]
  v_mfma_f32_16x16x32_bf16 v[36:39], v[60:63], v[188:191], v[36:39]
  v_mfma_f32_16x16x32_bf16 v[40:43], v[64:67], v[188:191], v[40:43]
  s_waitcnt vmcnt(1) lgkmcnt(5)
  v_mfma_f32_16x16x32_bf16 v[24:27], v[68:71], v[192:195], v[24:27]
  v_mfma_f32_16x16x32_bf16 v[28:31], v[72:75], v[192:195], v[28:31]
  v_mfma_f32_16x16x32_bf16 v[32:35], v[76:79], v[192:195], v[32:35]
  v_mfma_f32_16x16x32_bf16 v[36:39], v[80:83], v[192:195], v[36:39]
  v_mfma_f32_16x16x32_bf16 v[40:43], v[84:87], v[192:195], v[40:43]
  s_waitcnt vmcnt(0) lgkmcnt(0)
  v_mfma_f32_16x16x32_bf16 v[24:27], v[88:91], v[196:199], v[24:27]
  v_mfma_f32_16x16x32_bf16 v[28:31], v[92:95], v[196:199], v[28:31]
  v_mfma_f32_16x16x32_bf16 v[32:35], v[96:99], v[196:199], v[32:35]
  v_mfma_f32_16x16x32_bf16 v[36:39], v[44:47], v[196:199], v[36:39]
  v_mfma_f32_16x16x32_bf16 v[40:43], v[48:51], v[196:199], v[40:43]
  s_nop 7
  v_cvt_pk_bf16_f32 v228, v40, v41
  v_cvt_pk_bf16_f32 v230, v40, v41
  v_cvt_pk_bf16_f32 v229, v42, v43
  v_cvt_pk_bf16_f32 v231, v42, v43
  v_cvt_pk_bf16_f32 v220, v24, v25
  v_cvt_pk_bf16_f32 v221, v26, v27
  v_cvt_pk_bf16_f32 v222, v28, v29
  v_cvt_pk_bf16_f32 v223, v30, v31
  v_cvt_pk_bf16_f32 v224, v32, v33
  v_cvt_pk_bf16_f32 v225, v34, v35
  v_cvt_pk_bf16_f32 v226, v36, v37
  v_cvt_pk_bf16_f32 v227, v38, v39
  v_permlane16_swap_b32 v228, v230
  v_permlane16_swap_b32 v229, v231
  v_permlane16_swap_b32 v220, v222
  v_permlane16_swap_b32 v221, v223
  v_permlane16_swap_b32 v224, v226
  v_permlane16_swap_b32 v225, v227
  s_cmp_eq_u32 s6, 0
  s_cbranch_scc1 SL_120
  buffer_store_dwordx4 v[220:223], v6, s[20:23], s40 offen
  buffer_store_dwordx4 v[224:227], v6, s[20:23], s40 offen offset:1024
  s_mov_b32 exec_lo, 0xffff
  s_mov_b32 exec_hi, 0xffff
  buffer_store_dwordx4 v[228:231], v8, s[20:23], s41 offen
  s_mov_b64 exec, -1
  v_pk_add_f32 v[216:217], v[24:25], v[26:27]
  v_pk_mul_f32 v[218:219], v[24:25], v[24:25]
  v_pk_fma_f32 v[218:219], v[26:27], v[26:27], v[218:219]
  v_pk_add_f32 v[216:217], v[216:217], v[28:29]
  v_pk_fma_f32 v[218:219], v[28:29], v[28:29], v[218:219]
  v_pk_add_f32 v[216:217], v[216:217], v[30:31]
  v_pk_fma_f32 v[218:219], v[30:31], v[30:31], v[218:219]
  v_pk_add_f32 v[216:217], v[216:217], v[32:33]
  v_pk_fma_f32 v[218:219], v[32:33], v[32:33], v[218:219]
  v_pk_add_f32 v[216:217], v[216:217], v[34:35]
  v_pk_fma_f32 v[218:219], v[34:35], v[34:35], v[218:219]
  v_pk_add_f32 v[216:217], v[216:217], v[36:37]
  v_pk_fma_f32 v[218:219], v[36:37], v[36:37], v[218:219]
  v_pk_add_f32 v[216:217], v[216:217], v[38:39]
  v_pk_fma_f32 v[218:219], v[38:39], v[38:39], v[218:219]
  v_pk_add_f32 v[216:217], v[216:217], v[40:41]
  v_pk_fma_f32 v[218:219], v[40:41], v[40:41], v[218:219]
  v_pk_add_f32 v[216:217], v[216:217], v[42:43]
  v_pk_fma_f32 v[218:219], v[42:43], v[42:43], v[218:219]
  v_add_f32 v216, v216, v217
  v_add_f32 v218, v218, v219
  s_nop 1
  v_permlane32_swap_b32 v216, v218
  v_add_f32 v216, v216, v218
  v_mov_b32 v218, v216
  s_nop 1
  v_permlane16_swap_b32 v216, v218
  v_add_f32 v216, v216, v218
  buffer_store_dword v216, v7, s[16:19], s43 offen
  s_waitcnt vmcnt(0)
  s_mov_b64 exec, 1
  buffer_store_dword v252, v11, s[16:19], s42 offen
  s_mov_b64 exec, -1
  s_branch SE_121
SL_120:
  s_nop 1
  buffer_store_dwordx4 v[220:223], v6, s[20:23], s40 offen sc1
  buffer_store_dwordx4 v[224:227], v6, s[20:23], s40 offen offset:1024 sc1
  s_mov_b32 exec_lo, 0xffff
  s_mov_b32 exec_hi, 0xffff
  buffer_store_dwordx4 v[228:231], v8, s[20:23], s41 offen sc1
  s_mov_b64 exec, -1
  v_pk_add_f32 v[216:217], v[24:25], v[26:27]
  v_pk_mul_f32 v[218:219], v[24:25], v[24:25]
  v_pk_fma_f32 v[218:219], v[26:27], v[26:27], v[218:219]
  v_pk_add_f32 v[216:217], v[216:217], v[28:29]
  v_pk_fma_f32 v[218:219], v[28:29], v[28:29], v[218:219]
  v_pk_add_f32 v[216:217], v[216:217], v[30:31]
  v_pk_fma_f32 v[218:219], v[30:31], v[30:31], v[218:219]
  v_pk_add_f32 v[216:217], v[216:217], v[32:33]
  v_pk_fma_f32 v[218:219], v[32:33], v[32:33], v[218:219]
  v_pk_add_f32 v[216:217], v[216:217], v[34:35]
  v_pk_fma_f32 v[218:219], v[34:35], v[34:35], v[218:219]
  v_pk_add_f32 v[216:217], v[216:217], v[36:37]
  v_pk_fma_f32 v[218:219], v[36:37], v[36:37], v[218:219]
  v_pk_add_f32 v[216:217], v[216:217], v[38:39]
  v_pk_fma_f32 v[218:219], v[38:39], v[38:39], v[218:219]
  v_pk_add_f32 v[216:217], v[216:217], v[40:41]
  v_pk_fma_f32 v[218:219], v[40:41], v[40:41], v[218:219]
  v_pk_add_f32 v[216:217], v[216:217], v[42:43]
  v_pk_fma_f32 v[218:219], v[42:43], v[42:43], v[218:219]
  v_add_f32 v216, v216, v217
  v_add_f32 v218, v218, v219
  s_nop 1
  v_permlane32_swap_b32 v216, v218
  v_add_f32 v216, v216, v218
  v_mov_b32 v218, v216
  s_nop 1
  v_permlane16_swap_b32 v216, v218
  v_add_f32 v216, v216, v218
  buffer_store_dword v216, v7, s[16:19], s43 offen sc1
  s_waitcnt vmcnt(0)
  s_mov_b64 exec, 1
  buffer_store_dword v252, v11, s[16:19], s42 offen sc1
  s_mov_b64 exec, -1
SE_121:
  v_pk_add_f32 v[100:101], v[100:101], v[24:25]
  v_pk_add_f32 v[102:103], v[102:103], v[26:27]
  v_pk_add_f32 v[104:105], v[104:105], v[28:29]
  v_pk_add_f32 v[106:107], v[106:107], v[30:31]
  v_pk_add_f32 v[108:109], v[108:109], v[32:33]
  v_pk_add_f32 v[110:111], v[110:111], v[34:35]
  v_pk_add_f32 v[112:113], v[112:113], v[36:37]
  v_pk_add_f32 v[114:115], v[114:115], v[38:39]
  v_pk_add_f32 v[116:117], v[116:117], v[40:41]
  v_pk_add_f32 v[118:119], v[118:119], v[42:43]
  v_lshlrev_b32 v207, 4, v2
  v_add_u32 v207, 0x27a00, v207
  s_mul_i32 s55, s51, 20480
  s_add_u32 s55, s55, 0x0
  s_mul_i32 s40, s51, 49152
  s_mul_i32 s41, s50, 6144
  s_add_u32 s40, s40, s41
  s_add_u32 s40, s40, 0x500000
  s_add_u32 s41, s40, 4096
  s_lshl_b32 s42, s51, 3
  s_add_u32 s42, s42, s50
  s_lshl_b32 s42, s42, 2
  s_add_u32 s42, s42, 0xb95000
  s_add_u32 s43, s42, 4096
  s_add_u32 s44, s43, 4096
  s_mul_i32 s95, s51, 49152
  s_add_u32 s95, s95, 0x500000
  s_add_u32 s94, s50, 1
  s_and_b32 s94, s94, 7
  s_mul_i32 s94, s94, 6144
  s_add_u32 s65, s94, s95
  s_add_u32 s94, s50, 2
  s_and_b32 s94, s94, 7
  s_mul_i32 s94, s94, 6144
  s_add_u32 s66, s94, s95
  s_add_u32 s94, s50, 3
  s_and_b32 s94, s94, 7
  s_mul_i32 s94, s94, 6144
  s_add_u32 s67, s94, s95
  s_add_u32 s94, s50, 4
  s_and_b32 s94, s94, 7
  s_mul_i32 s94, s94, 6144
  s_add_u32 s68, s94, s95
  s_add_u32 s94, s50, 5
  s_and_b32 s94, s94, 7
  s_mul_i32 s94, s94, 6144
  s_add_u32 s69, s94, s95
  s_add_u32 s94, s50, 6
  s_and_b32 s94, s94, 7
  s_mul_i32 s94, s94, 6144
  s_add_u32 s70, s94, s95
  s_add_u32 s94, s50, 7
  s_and_b32 s94, s94, 7
  s_mul_i32 s94, s94, 6144
  s_add_u32 s71, s94, s95
  s_mul_i32 s45, s51, 49152
  s_add_u32 s45, s45, 0x500000
  s_lshl_b32 s46, s51, 5
  s_add_u32 s46, s46, 0xb95000
  v_mov_b32 v52, 0x23bd0
  s_mov_b32 s7, 2000000
W_122:
  ds_read_b128 v[44:47], v52
  s_waitcnt lgkmcnt(0)
  v_min3_u32 v44, v44, v45, v46
  v_min_u32 v44, v44, v47
  v_cmp_gt_u32 vcc, 17, v44
  s_nop 0
  s_cbranch_vccz WD_123
  s_sub_u32 s7, s7, 1
  s_cbranch_scc0 W_122
WD_123:
  ds_read_b128 v[44:47], v12 offset:20480
  ds_read_b128 v[48:51], v12 offset:21504
  ds_read_b128 v[52:55], v12 offset:22528
  ds_read_b128 v[56:59], v12 offset:23552
  ds_read_b128 v[60:63], v12 offset:24576
  ds_read_b128 v[64:67], v12 offset:25600
  ds_read_b128 v[68:71], v12 offset:26624
  ds_read_b128 v[72:75], v12 offset:27648
  ds_read_b128 v[76:79], v12 offset:28672
  s_lshl_b32 s33, s51, 5
  s_add_u32 s33, s33, 0xb94000
  v_and_b32 v204, 7, v1
  v_lshlrev_b32 v204, 2, v204
  s_mov_b32 s7, 400000
P_124:
  buffer_load_dword v205, v204, s[16:19], s33 offen sc1
  s_waitcnt vmcnt(0)
PE_126:
  v_cmp_ne_u32 vcc, s99, v205
  s_nop 0
  s_cbranch_vccz PD_125
  s_sub_u32 s7, s7, 1
  s_cbranch_scc0 P_124
PD_125:
  s_mul_i32 s33, s51, 20480
  s_add_u32 s33, s33, 0x280000
  buffer_load_dword v208, v206, s[16:19], s33 offen offset:0 sc1
  buffer_load_dword v209, v206, s[16:19], s33 offen offset:64 sc1
  buffer_load_dword v210, v206, s[16:19], s33 offen offset:128 sc1
  buffer_load_dword v211, v206, s[16:19], s33 offen offset:192 sc1
  s_mov_b32 s72, s99
  s_mov_b32 s73, s99
  buffer_load_dwordx4 v[120:123], v5, s[20:23], s55 offen offset:0 sc1
  buffer_load_dwordx4 v[124:127], v5, s[20:23], s55 offen offset:1024 sc1
  buffer_load_dwordx4 v[128:131], v5, s[20:23], s55 offen offset:2048 sc1
  buffer_load_dwordx4 v[132:135], v5, s[20:23], s55 offen offset:3072 sc1
  s_add_u32 s55, s55, 4096
  buffer_load_dwordx4 v[136:139], v5, s[20:23], s55 offen offset:0 sc1
  buffer_load_dwordx4 v[140:143], v5, s[20:23], s55 offen offset:1024 sc1
  buffer_load_dwordx4 v[144:147], v5, s[20:23], s55 offen offset:2048 sc1
  buffer_load_dwordx4 v[148:151], v5, s[20:23], s55 offen offset:3072 sc1
  s_add_u32 s55, s55, 4096
  buffer_load_dwordx4 v[152:155], v5, s[20:23], s55 offen offset:0 sc1
  buffer_load_dwordx4 v[156:159], v5, s[20:23], s55 offen offset:1024 sc1
  buffer_load_dwordx4 v[160:163], v5, s[20:23], s55 offen offset:2048 sc1
  buffer_load_dwordx4 v[164:167], v5, s[20:23], s55 offen offset:3072 sc1
  s_add_u32 s55, s55, 4096
  buffer_load_dwordx4 v[168:171], v5, s[20:23], s55 offen offset:0 sc1
  buffer_load_dwordx4 v[172:175], v5, s[20:23], s55 offen offset:1024 sc1
  buffer_load_dwordx4 v[176:179], v5, s[20:23], s55 offen offset:2048 sc1
  buffer_load_dwordx4 v[180:183], v5, s[20:23], s55 offen offset:3072 sc1
  s_add_u32 s55, s55, 4096
  buffer_load_dwordx4 v[184:187], v5, s[20:23], s55 offen offset:0 sc1
  buffer_load_dwordx4 v[188:191], v5, s[20:23], s55 offen offset:1024 sc1
  buffer_load_dwordx4 v[192:195], v5, s[20:23], s55 offen offset:2048 sc1
  buffer_load_dwordx4 v[196:199], v5, s[20:23], s55 offen offset:3072 sc1
  s_add_u32 s55, s55, 4096
  s_waitcnt vmcnt(18) lgkmcnt(5)
  v_mfma_f32_16x16x32_bf16 v[24:27], v[44:47], v[120:123], 0
  ds_read_b128 v[80:83], v12 offset:29696
  v_mfma_f32_16x16x32_bf16 v[28:31], v[48:51], v[120:123], 0
  ds_read_b128 v[84:87], v12 offset:30720
  v_mfma_f32_16x16x32_bf16 v[24:27], v[52:55], v[124:127], v[24:27]
  ds_read_b128 v[88:91], v12 offset:31744
  v_mfma_f32_16x16x32_bf16 v[28:31], v[56:59], v[124:127], v[28:31]
  ds_read_b128 v[92:95], v12 offset:32768
  s_waitcnt vmcnt(16) lgkmcnt(5)
  v_mfma_f32_16x16x32_bf16 v[24:27], v[60:63], v[128:131], v[24:27]
  ds_read_b128 v[96:99], v12 offset:33792
  v_mfma_f32_16x16x32_bf16 v[28:31], v[64:67], v[128:131], v[28:31]
  ds_read_b128 v[44:47], v12 offset:34816
  v_mfma_f32_16x16x32_bf16 v[24:27], v[68:71], v[132:135], v[24:27]
  ds_read_b128 v[48:51], v12 offset:35840
  v_mfma_f32_16x16x32_bf16 v[28:31], v[72:75], v[132:135], v[28:31]
  ds_read_b128 v[52:55], v12 offset:36864
  s_barrier
  s_waitcnt vmcnt(14) lgkmcnt(5)
  v_mfma_f32_16x16x32_bf16 v[24:27], v[76:79], v[136:139], v[24:27]
  ds_read_b128 v[56:59], v12 offset:37888
  v_add_f32 v208, v208, v210
  v_add_f32 v209, v209, v211
  v_mfma_f32_16x16x32_bf16 v[28:31], v[80:83], v[136:139], v[28:31]
  ds_read_b128 v[60:63], v12 offset:38912
  v_permlane32_swap_b32 v208, v209
  v_add_f32 v208, v208, v209
  v_mfma_f32_16x16x32_bf16 v[24:27], v[84:87], v[140:143], v[24:27]
  ds_read_b128 v[64:67], v12 offset:39936
  v_mov_b32 v209, v208
  s_nop 1
  v_permlane16_swap_b32 v208, v209
  v_mfma_f32_16x16x32_bf16 v[28:31], v[88:91], v[140:143], v[28:31]
  ds_read_b128 v[68:71], v12 offset:40960
  v_add_f32 v208, v208, v209
  v_mov_b32 v209, v208
  s_waitcnt vmcnt(12) lgkmcnt(5)
  v_mfma_f32_16x16x32_bf16 v[24:27], v[92:95], v[144:147], v[24:27]
  ds_read_b128 v[72:75], v12 offset:41984
  v_permlane32_swap_b32 v208, v209
  v_mul_f32 v208, 0x3acccccd, v208
  v_mfma_f32_16x16x32_bf16 v[28:31], v[96:99], v[144:147], v[28:31]
  ds_read_b128 v[76:79], v12 offset:43008
  v_mul_f32 v209, 0x3acccccd, v209
  v_fma_f32 v209, -v208, v208, v209
  v_mfma_f32_16x16x32_bf16 v[24:27], v[44:47], v[148:151], v[24:27]
  ds_read_b128 v[80:83], v12 offset:44032
  v_max_f32 v209, 0, v209
  v_add_f32 v19, 0x3727c5ac, v209
  v_mfma_f32_16x16x32_bf16 v[28:31], v[48:51], v[148:151], v[28:31]
  ds_read_b128 v[84:87], v12 offset:45056
  v_rsq_f32 v19, v19
  v_mov_b32 v18, v208
  s_waitcnt vmcnt(10) lgkmcnt(5)
  v_mfma_f32_16x16x32_bf16 v[24:27], v[52:55], v[152:155], v[24:27]
  ds_read_b128 v[88:91], v12 offset:46080
  v_mul_f32 v20, v19, v19
  v_rcp_f32 v21, v19
  v_mfma_f32_16x16x32_bf16 v[28:31], v[56:59], v[152:155], v[28:31]
  ds_read_b128 v[92:95], v12 offset:47104
  v_mul_f32 v20, v20, v19
  v_mul_f32 v20, s88, v20
  v_mfma_f32_16x16x32_bf16 v[24:27], v[60:63], v[156:159], v[24:27]
  ds_read_b128 v[96:99], v12 offset:48128
  v_mul_f32 v19, v22, v19
  v_mfma_f32_16x16x32_bf16 v[28:31], v[64:67], v[156:159], v[28:31]
  ds_read_b128 v[44:47], v12 offset:49152
  s_waitcnt vmcnt(8) lgkmcnt(5)
  v_mfma_f32_16x16x32_bf16 v[24:27], v[68:71], v[160:163], v[24:27]
  ds_read_b128 v[48:51], v12 offset:50176
  v_mfma_f32_16x16x32_bf16 v[28:31], v[72:75], v[160:163], v[28:31]
  ds_read_b128 v[52:55], v12 offset:51200
  ds_read_b128 v[212:215], v207 offset:0
  ds_read_b128 v[216:219], v207 offset:64
  v_mfma_f32_16x16x32_bf16 v[24:27], v[76:79], v[164:167], v[24:27]
  ds_read_b128 v[56:59], v12 offset:52224
  v_mfma_f32_16x16x32_bf16 v[28:31], v[80:83], v[164:167], v[28:31]
  ds_read_b128 v[60:63], v12 offset:53248
  s_waitcnt vmcnt(6) lgkmcnt(5)
  v_mfma_f32_16x16x32_bf16 v[24:27], v[84:87], v[168:171], v[24:27]
  ds_read_b128 v[64:67], v12 offset:54272
  v_mfma_f32_16x16x32_bf16 v[28:31], v[88:91], v[168:171], v[28:31]
  ds_read_b128 v[68:71], v12 offset:55296
  v_mfma_f32_16x16x32_bf16 v[24:27], v[92:95], v[172:175], v[24:27]
  ds_read_b128 v[72:75], v12 offset:56320
  v_mfma_f32_16x16x32_bf16 v[28:31], v[96:99], v[172:175], v[28:31]
  ds_read_b128 v[76:79], v12 offset:57344
  s_waitcnt vmcnt(4) lgkmcnt(5)
  v_mfma_f32_16x16x32_bf16 v[24:27], v[44:47], v[176:179], v[24:27]
  ds_read_b128 v[80:83], v12 offset:58368
  v_mfma_f32_16x16x32_bf16 v[28:31], v[48:51], v[176:179], v[28:31]
  ds_read_b128 v[84:87], v12 offset:59392
  v_mfma_f32_16x16x32_bf16 v[24:27], v[52:55], v[180:183], v[24:27]
  ds_read_b128 v[88:91], v12 offset:60416
  v_mfma_f32_16x16x32_bf16 v[28:31], v[56:59], v[180:183], v[28:31]
  ds_read_b128 v[92:95], v12 offset:61440
  s_waitcnt vmcnt(2) lgkmcnt(5)
  v_mfma_f32_16x16x32_bf16 v[24:27], v[60:63], v[184:187], v[24:27]
  ds_read_b128 v[96:99], v12 offset:62464
  v_mfma_f32_16x16x32_bf16 v[28:31], v[64:67], v[184:187], v[28:31]
  ds_read_b128 v[44:47], v12 offset:63488
  v_mfma_f32_16x16x32_bf16 v[24:27], v[68:71], v[188:191], v[24:27]
  ds_read_b128 v[48:51], v12 offset:64512
  v_mfma_f32_16x16x32_bf16 v[28:31], v[72:75], v[188:191], v[28:31]
  ds_read_b128 v[52:55], v13 offset:0
  s_waitcnt vmcnt(0) lgkmcnt(5)
  v_mfma_f32_16x16x32_bf16 v[24:27], v[76:79], v[192:195], v[24:27]
  ds_read_b128 v[56:59], v13 offset:1024
  v_mfma_f32_16x16x32_bf16 v[28:31], v[80:83], v[192:195], v[28:31]
  ds_read_b128 v[60:63], v13 offset:2048
  v_mfma_f32_16x16x32_bf16 v[24:27], v[84:87], v[196:199], v[24:27]
  ds_read_b128 v[64:67], v13 offset:3072
  v_mfma_f32_16x16x32_bf16 v[28:31], v[88:91], v[196:199], v[28:31]
  ds_read_b128 v[68:71], v13 offset:4096
  s_barrier
  s_waitcnt lgkmcnt(5)
  v_mfma_f32_16x16x32_bf16 v[32:35], v[92:95], v[120:123], 0
  ds_read_b128 v[72:75], v13 offset:5120
  v_mfma_f32_16x16x32_bf16 v[36:39], v[96:99], v[120:123], 0
  ds_read_b128 v[76:79], v13 offset:6144
  v_mfma_f32_16x16x32_bf16 v[32:35], v[44:47], v[124:127], v[32:35]
  ds_read_b128 v[80:83], v13 offset:7168
  v_fma_f32 v24, -v18, v212, v24
  v_fma_f32 v25, -v18, v213, v25
  v_mfma_f32_16x16x32_bf16 v[36:39], v[48:51], v[124:127], v[36:39]
  ds_read_b128 v[84:87], v13 offset:8192
  v_fma_f32 v26, -v18, v214, v26
  v_fma_f32 v27, -v18, v215, v27
  s_waitcnt lgkmcnt(5)
  v_mfma_f32_16x16x32_bf16 v[32:35], v[52:55], v[128:131], v[32:35]
  ds_read_b128 v[88:91], v13 offset:9216
  v_fma_f32 v28, -v18, v216, v28
  v_fma_f32 v29, -v18, v217, v29
  v_mfma_f32_16x16x32_bf16 v[36:39], v[56:59], v[128:131], v[36:39]
  ds_read_b128 v[92:95], v13 offset:10240
  v_fma_f32 v30, -v18, v218, v30
  v_fma_f32 v31, -v18, v219, v31
  v_mfma_f32_16x16x32_bf16 v[32:35], v[60:63], v[132:135], v[32:35]
  ds_read_b128 v[96:99], v13 offset:11264
  v_mul_f32 v220, v24, v24
  v_mul_f32 v221, v25, v25
  v_mfma_f32_16x16x32_bf16 v[36:39], v[64:67], v[132:135], v[36:39]
  ds_read_b128 v[44:47], v13 offset:12288
  v_mul_f32 v222, v26, v26
  v_mul_f32 v223, v27, v27
  s_waitcnt lgkmcnt(5)
  v_mfma_f32_16x16x32_bf16 v[32:35], v[68:71], v[136:139], v[32:35]
  ds_read_b128 v[48:51], v13 offset:13312
  v_mul_f32 v224, v28, v28
  v_mul_f32 v225, v29, v29
  v_mfma_f32_16x16x32_bf16 v[36:39], v[72:75], v[136:139], v[36:39]
  ds_read_b128 v[52:55], v13 offset:14336
  v_mul_f32 v226, v30, v30
  v_mul_f32 v227, v31, v31
  v_mfma_f32_16x16x32_bf16 v[32:35], v[76:79], v[140:143], v[32:35]
  ds_read_b128 v[56:59], v13 offset:15360
  v_fma_f32 v220, v220, v20, v19
  v_fma_f32 v221, v221, v20, v19
  v_mfma_f32_16x16x32_bf16 v[36:39], v[80:83], v[140:143], v[36:39]
  ds_read_b128 v[60:63], v13 offset:16384
  v_fma_f32 v222, v222, v20, v19
  v_fma_f32 v223, v223, v20, v19
  s_waitcnt lgkmcnt(5)
  v_mfma_f32_16x16x32_bf16 v[32:35], v[84:87], v[144:147], v[32:35]
  ds_read_b128 v[64:67], v13 offset:17408
  v_fma_f32 v224, v224, v20, v19
  v_fma_f32 v225, v225, v20, v19
  v_mfma_f32_16x16x32_bf16 v[36:39], v[88:91], v[144:147], v[36:39]
  ds_read_b128 v[68:71], v13 offset:18432
  v_fma_f32 v226, v226, v20, v19
  v_fma_f32 v227, v227, v20, v19
  v_mfma_f32_16x16x32_bf16 v[32:35], v[92:95], v[148:151], v[32:35]
  ds_read_b128 v[72:75], v13 offset:19456
  v_mul_f32 v220, v220, v24
  v_mul_f32 v221, v221, v25
  v_mfma_f32_16x16x32_bf16 v[36:39], v[96:99], v[148:151], v[36:39]
  ds_read_b128 v[76:79], v13 offset:20480
  v_mul_f32 v222, v222, v26
  v_mul_f32 v223, v223, v27
  s_waitcnt lgkmcnt(5)
  v_mfma_f32_16x16x32_bf16 v[32:35], v[44:47], v[152:155], v[32:35]
  ds_read_b128 v[80:83], v13 offset:21504
  v_mul_f32 v224, v224, v28
  v_mul_f32 v225, v225, v29
  v_mfma_f32_16x16x32_bf16 v[36:39], v[48:51], v[152:155], v[36:39]
  ds_read_b128 v[84:87], v13 offset:22528
  v_mul_f32 v226, v226, v30
  v_mul_f32 v227, v227, v31
  v_mfma_f32_16x16x32_bf16 v[32:35], v[52:55], v[156:159], v[32:35]
  ds_read_b128 v[88:91], v13 offset:23552
  v_exp_f32 v220, v220
  v_exp_f32 v221, v221
  v_mfma_f32_16x16x32_bf16 v[36:39], v[56:59], v[156:159], v[36:39]
  ds_read_b128 v[92:95], v13 offset:24576
  v_exp_f32 v222, v222
  v_exp_f32 v223, v223
  s_waitcnt lgkmcnt(5)
  v_mfma_f32_16x16x32_bf16 v[32:35], v[60:63], v[160:163], v[32:35]
  ds_read_b128 v[96:99], v13 offset:25600
  v_exp_f32 v224, v224
  v_exp_f32 v225, v225
  v_mfma_f32_16x16x32_bf16 v[36:39], v[64:67], v[160:163], v[36:39]
  ds_read_b128 v[44:47], v13 offset:26624
  v_exp_f32 v226, v226
  v_exp_f32 v227, v227
  ds_read_b128 v[240:243], v207 offset:128
  ds_read_b128 v[244:247], v207 offset:192
  v_mfma_f32_16x16x32_bf16 v[32:35], v[68:71], v[164:167], v[32:35]
  ds_read_b128 v[48:51], v13 offset:27648
  v_fma_f32 v220, v220, v21, v21
  v_fma_f32 v221, v221, v21, v21
  v_mfma_f32_16x16x32_bf16 v[36:39], v[72:75], v[164:167], v[36:39]
  ds_read_b128 v[52:55], v13 offset:28672
  v_fma_f32 v222, v222, v21, v21
  v_fma_f32 v223, v223, v21, v21
  s_waitcnt lgkmcnt(5)
  v_mfma_f32_16x16x32_bf16 v[32:35], v[76:79], v[168:171], v[32:35]
  ds_read_b128 v[56:59], v13 offset:29696
  v_fma_f32 v224, v224, v21, v21
  v_fma_f32 v225, v225, v21, v21
  v_mfma_f32_16x16x32_bf16 v[36:39], v[80:83], v[168:171], v[36:39]
  ds_read_b128 v[60:63], v13 offset:30720
  v_fma_f32 v226, v226, v21, v21
  v_fma_f32 v227, v227, v21, v21
  v_mfma_f32_16x16x32_bf16 v[32:35], v[84:87], v[172:175], v[32:35]
  ds_read_b128 v[64:67], v13 offset:31744
  v_rcp_f32 v220, v220
  v_rcp_f32 v221, v221
  v_mfma_f32_16x16x32_bf16 v[36:39], v[88:91], v[172:175], v[36:39]
  ds_read_b128 v[68:71], v13 offset:32768
  v_rcp_f32 v222, v222
  v_rcp_f32 v223, v223
  s_waitcnt lgkmcnt(5)
  v_mfma_f32_16x16x32_bf16 v[32:35], v[92:95], v[176:179], v[32:35]
  ds_read_b128 v[72:75], v13 offset:33792
  v_rcp_f32 v224, v224
  v_rcp_f32 v225, v225
  v_mfma_f32_16x16x32_bf16 v[36:39], v[96:99], v[176:179], v[36:39]
  ds_read_b128 v[76:79], v13 offset:34816
  v_rcp_f32 v226, v226
  v_rcp_f32 v227, v227
  v_mfma_f32_16x16x32_bf16 v[32:35], v[44:47], v[180:183], v[32:35]
  ds_read_b128 v[80:83], v13 offset:35840
  v_mul_f32 v24, v24, v220
  v_mul_f32 v25, v25, v221
  v_mfma_f32_16x16x32_bf16 v[36:39], v[48:51], v[180:183], v[36:39]
  ds_read_b128 v[84:87], v13 offset:36864
  v_mul_f32 v26, v26, v222
  v_mul_f32 v27, v27, v223
  s_waitcnt lgkmcnt(5)
  v_mfma_f32_16x16x32_bf16 v[32:35], v[52:55], v[184:187], v[32:35]
  ds_read_b128 v[88:91], v13 offset:37888
  v_mul_f32 v28, v28, v224
  v_mul_f32 v29, v29, v225
  v_mfma_f32_16x16x32_bf16 v[36:39], v[56:59], v[184:187], v[36:39]
  ds_read_b128 v[92:95], v13 offset:38912
  v_mul_f32 v30, v30, v226
  v_mul_f32 v31, v31, v227
  v_mfma_f32_16x16x32_bf16 v[32:35], v[60:63], v[188:191], v[32:35]
  ds_read_b128 v[96:99], v13 offset:39936
  v_cvt_pk_bf16_f32 v228, v24, v25
  v_cvt_pk_bf16_f32 v229, v26, v27
  v_mfma_f32_16x16x32_bf16 v[36:39], v[64:67], v[188:191], v[36:39]
  ds_read_b128 v[44:47], v13 offset:40960
  v_cvt_pk_bf16_f32 v230, v28, v29
  v_cvt_pk_bf16_f32 v231, v30, v31
  s_waitcnt lgkmcnt(5)
  v_mfma_f32_16x16x32_bf16 v[32:35], v[68:71], v[192:195], v[32:35]
  ds_read_b128 v[48:51], v13 offset:41984
  buffer_store_dwordx4 v[228:231], v5, s[16:19], s40 offen offset:0 sc1
  v_mfma_f32_16x16x32_bf16 v[36:39], v[72:75], v[192:195], v[36:39]
  ds_read_b128 v[52:55], v13 offset:43008
  v_mfma_f32_16x16x32_bf16 v[32:35], v[76:79], v[196:199], v[32:35]
  ds_read_b128 v[56:59], v13 offset:44032
  v_mfma_f32_16x16x32_bf16 v[36:39], v[80:83], v[196:199], v[36:39]
  ds_read_b128 v[60:63], v13 offset:45056
  s_barrier
  s_waitcnt lgkmcnt(5)
  v_mfma_f32_16x16x32_bf16 v[24:27], v[84:87], v[120:123], 0
  ds_read_b128 v[64:67], v13 offset:46080
  v_mfma_f32_16x16x32_bf16 v[28:31], v[88:91], v[120:123], 0
  ds_read_b128 v[68:71], v13 offset:47104
  v_mfma_f32_16x16x32_bf16 v[24:27], v[92:95], v[124:127], v[24:27]
  ds_read_b128 v[72:75], v13 offset:48128
  v_fma_f32 v32, -v18, v240, v32
  v_fma_f32 v33, -v18, v241, v33
  v_mfma_f32_16x16x32_bf16 v[28:31], v[96:99], v[124:127], v[28:31]
  ds_read_b128 v[76:79], v13 offset:49152
  v_fma_f32 v34, -v18, v242, v34
  v_fma_f32 v35, -v18, v243, v35
  s_waitcnt lgkmcnt(5)
  v_mfma_f32_16x16x32_bf16 v[24:27], v[44:47], v[128:131], v[24:27]
  ds_read_b128 v[80:83], v13 offset:50176
  v_fma_f32 v36, -v18, v244, v36
  v_fma_f32 v37, -v18, v245, v37
  v_mfma_f32_16x16x32_bf16 v[28:31], v[48:51], v[128:131], v[28:31]
  ds_read_b128 v[84:87], v13 offset:51200
  v_fma_f32 v38, -v18, v246, v38
  v_fma_f32 v39, -v18, v247, v39
  v_mfma_f32_16x16x32_bf16 v[24:27], v[52:55], v[132:135], v[24:27]
  ds_read_b128 v[88:91], v13 offset:52224
  v_mul_f32 v220, v32, v32
  v_mul_f32 v221, v33, v33
  v_mfma_f32_16x16x32_bf16 v[28:31], v[56:59], v[132:135], v[28:31]
  ds_read_b128 v[92:95], v13 offset:53248
  v_mul_f32 v222, v34, v34
  v_mul_f32 v223, v35, v35
  s_waitcnt lgkmcnt(5)
  v_mfma_f32_16x16x32_bf16 v[24:27], v[60:63], v[136:139], v[24:27]
  ds_read_b128 v[96:99], v13 offset:54272
  v_mul_f32 v224, v36, v36
  v_mul_f32 v225, v37, v37
  v_mfma_f32_16x16x32_bf16 v[28:31], v[64:67], v[136:139], v[28:31]
  ds_read_b128 v[44:47], v13 offset:55296
  v_mul_f32 v226, v38, v38
  v_mul_f32 v227, v39, v39
  v_mfma_f32_16x16x32_bf16 v[24:27], v[68:71], v[140:143], v[24:27]
  ds_read_b128 v[48:51], v13 offset:56320
  v_fma_f32 v220, v220, v20, v19
  v_fma_f32 v221, v221, v20, v19
  v_mfma_f32_16x16x32_bf16 v[28:31], v[72:75], v[140:143], v[28:31]
  ds_read_b128 v[52:55], v13 offset:57344
  v_fma_f32 v222, v222, v20, v19
  v_fma_f32 v223, v223, v20, v19
  s_waitcnt lgkmcnt(5)
  v_mfma_f32_16x16x32_bf16 v[24:27], v[76:79], v[144:147], v[24:27]
  ds_read_b128 v[56:59], v13 offset:58368
  v_fma_f32 v224, v224, v20, v19
  v_fma_f32 v225, v225, v20, v19
  v_mfma_f32_16x16x32_bf16 v[28:31], v[80:83], v[144:147], v[28:31]
  ds_read_b128 v[60:63], v13 offset:59392
  v_fma_f32 v226, v226, v20, v19
  v_fma_f32 v227, v227, v20, v19
  v_mfma_f32_16x16x32_bf16 v[24:27], v[84:87], v[148:151], v[24:27]
  ds_read_b128 v[64:67], v13 offset:60416
  v_mul_f32 v220, v220, v32
  v_mul_f32 v221, v221, v33
  v_mfma_f32_16x16x32_bf16 v[28:31], v[88:91], v[148:151], v[28:31]
  ds_read_b128 v[68:71], v13 offset:61440
  v_mul_f32 v222, v222, v34
  v_mul_f32 v223, v223, v35
  s_waitcnt lgkmcnt(5)
  v_mfma_f32_16x16x32_bf16 v[24:27], v[92:95], v[152:155], v[24:27]
  ds_read_b128 v[72:75], v13 offset:62464
  v_mul_f32 v224, v224, v36
  v_mul_f32 v225, v225, v37
  v_mfma_f32_16x16x32_bf16 v[28:31], v[96:99], v[152:155], v[28:31]
  ds_read_b128 v[76:79], v13 offset:63488
  v_mul_f32 v226, v226, v38
  v_mul_f32 v227, v227, v39
  v_mfma_f32_16x16x32_bf16 v[24:27], v[44:47], v[156:159], v[24:27]
  ds_read_b128 v[80:83], v13 offset:64512
  v_exp_f32 v220, v220
  v_exp_f32 v221, v221
  v_mfma_f32_16x16x32_bf16 v[28:31], v[48:51], v[156:159], v[28:31]
  ds_read_b128 v[84:87], v14 offset:0
  v_exp_f32 v222, v222
  v_exp_f32 v223, v223
  s_waitcnt lgkmcnt(5)
  v_mfma_f32_16x16x32_bf16 v[24:27], v[52:55], v[160:163], v[24:27]
  ds_read_b128 v[88:91], v14 offset:1024
  v_exp_f32 v224, v224
  v_exp_f32 v225, v225
  v_mfma_f32_16x16x32_bf16 v[28:31], v[56:59], v[160:163], v[28:31]
  ds_read_b128 v[92:95], v14 offset:2048
  v_exp_f32 v226, v226
  v_exp_f32 v227, v227
  ds_read_b128 v[212:215], v207 offset:256
  ds_read_b128 v[216:219], v207 offset:320
  v_mfma_f32_16x16x32_bf16 v[24:27], v[60:63], v[164:167], v[24:27]
  ds_read_b128 v[96:99], v14 offset:3072
  v_fma_f32 v220, v220, v21, v21
  v_fma_f32 v221, v221, v21, v21
  v_mfma_f32_16x16x32_bf16 v[28:31], v[64:67], v[164:167], v[28:31]
  ds_read_b128 v[44:47], v14 offset:4096
  v_fma_f32 v222, v222, v21, v21
  v_fma_f32 v223, v223, v21, v21
  s_waitcnt lgkmcnt(5)
  v_mfma_f32_16x16x32_bf16 v[24:27], v[68:71], v[168:171], v[24:27]
  ds_read_b128 v[48:51], v14 offset:5120
  v_fma_f32 v224, v224, v21, v21
  v_fma_f32 v225, v225, v21, v21
  v_mfma_f32_16x16x32_bf16 v[28:31], v[72:75], v[168:171], v[28:31]
  ds_read_b128 v[52:55], v14 offset:6144
  v_fma_f32 v226, v226, v21, v21
  v_fma_f32 v227, v227, v21, v21
  v_mfma_f32_16x16x32_bf16 v[24:27], v[76:79], v[172:175], v[24:27]
  ds_read_b128 v[56:59], v14 offset:7168
  v_rcp_f32 v220, v220
  v_rcp_f32 v221, v221
  v_mfma_f32_16x16x32_bf16 v[28:31], v[80:83], v[172:175], v[28:31]
  ds_read_b128 v[60:63], v14 offset:8192
  v_rcp_f32 v222, v222
  v_rcp_f32 v223, v223
  s_waitcnt lgkmcnt(5)
  v_mfma_f32_16x16x32_bf16 v[24:27], v[84:87], v[176:179], v[24:27]
  ds_read_b128 v[64:67], v14 offset:9216
  v_rcp_f32 v224, v224
  v_rcp_f32 v225, v225
  v_mfma_f32_16x16x32_bf16 v[28:31], v[88:91], v[176:179], v[28:31]
  ds_read_b128 v[68:71], v14 offset:10240
  v_rcp_f32 v226, v226
  v_rcp_f32 v227, v227
  v_mfma_f32_16x16x32_bf16 v[24:27], v[92:95], v[180:183], v[24:27]
  ds_read_b128 v[72:75], v14 offset:11264
  v_mul_f32 v32, v32, v220
  v_mul_f32 v33, v33, v221
  v_mfma_f32_16x16x32_bf16 v[28:31], v[96:99], v[180:183], v[28:31]
  ds_read_b128 v[76:79], v12 offset:0
  v_mul_f32 v34, v34, v222
  v_mul_f32 v35, v35, v223
  s_waitcnt lgkmcnt(5)
  v_mfma_f32_16x16x32_bf16 v[24:27], v[44:47], v[184:187], v[24:27]
  ds_read_b128 v[80:83], v12 offset:1024
  v_mul_f32 v36, v36, v224
  v_mul_f32 v37, v37, v225
  v_mfma_f32_16x16x32_bf16 v[28:31], v[48:51], v[184:187], v[28:31]
  ds_read_b128 v[84:87], v12 offset:2048
  v_mul_f32 v38, v38, v226
  v_mul_f32 v39, v39, v227
  v_mfma_f32_16x16x32_bf16 v[24:27], v[52:55], v[188:191], v[24:27]
  ds_read_b128 v[88:91], v12 offset:3072
  v_cvt_pk_bf16_f32 v232, v32, v33
  v_cvt_pk_bf16_f32 v233, v34, v35
  v_mfma_f32_16x16x32_bf16 v[28:31], v[56:59], v[188:191], v[28:31]
  ds_read_b128 v[92:95], v12 offset:4096
  v_cvt_pk_bf16_f32 v234, v36, v37
  v_cvt_pk_bf16_f32 v235, v38, v39
  s_waitcnt lgkmcnt(5)
  v_mfma_f32_16x16x32_bf16 v[24:27], v[60:63], v[192:195], v[24:27]
  ds_read_b128 v[96:99], v12 offset:5120
  buffer_store_dwordx4 v[232:235], v5, s[16:19], s40 offen offset:1024 sc1
  v_mfma_f32_16x16x32_bf16 v[28:31], v[64:67], v[192:195], v[28:31]
  ds_read_b128 v[44:47], v12 offset:6144
  v_mfma_f32_16x16x32_bf16 v[24:27], v[68:71], v[196:199], v[24:27]
  ds_read_b128 v[48:51], v12 offset:7168
  v_mfma_f32_16x16x32_bf16 v[28:31], v[72:75], v[196:199], v[28:31]
  ds_read_b128 v[52:55], v12 offset:8192
  s_barrier
  s_waitcnt lgkmcnt(5)
  v_mfma_f32_16x16x32_bf16 v[32:35], v[76:79], v[120:123], 0
  ds_read_b128 v[56:59], v12 offset:9216
  v_mfma_f32_16x16x32_bf16 v[36:39], v[80:83], v[120:123], 0
  ds_read_b128 v[60:63], v12 offset:10240
  v_mfma_f32_16x16x32_bf16 v[32:35], v[84:87], v[124:127], v[32:35]
  ds_read_b128 v[64:67], v12 offset:11264
  v_fma_f32 v24, -v18, v212, v24
  v_fma_f32 v25, -v18, v213, v25
  v_mfma_f32_16x16x32_bf16 v[36:39], v[88:91], v[124:127], v[36:39]
  ds_read_b128 v[68:71], v12 offset:12288
  v_fma_f32 v26, -v18, v214, v26
  v_fma_f32 v27, -v18, v215, v27
  s_waitcnt lgkmcnt(5)
  v_mfma_f32_16x16x32_bf16 v[32:35], v[92:95], v[128:131], v[32:35]
  ds_read_b128 v[72:75], v12 offset:13312
  v_fma_f32 v28, -v18, v216, v28
  v_fma_f32 v29, -v18, v217, v29
  v_mfma_f32_16x16x32_bf16 v[36:39], v[96:99], v[128:131], v[36:39]
  ds_read_b128 v[76:79], v12 offset:14336
  v_fma_f32 v30, -v18, v218, v30
  v_fma_f32 v31, -v18, v219, v31
  v_mfma_f32_16x16x32_bf16 v[32:35], v[44:47], v[132:135], v[32:35]
  ds_read_b128 v[80:83], v12 offset:15360
  v_mul_f32 v220, v24, v24
  v_mul_f32 v221, v25, v25
  v_mfma_f32_16x16x32_bf16 v[36:39], v[48:51], v[132:135], v[36:39]
  ds_read_b128 v[84:87], v12 offset:16384
  v_mul_f32 v222, v26, v26
  v_mul_f32 v223, v27, v27
  s_waitcnt lgkmcnt(5)
  v_mfma_f32_16x16x32_bf16 v[32:35], v[52:55], v[136:139], v[32:35]
  ds_read_b128 v[88:91], v12 offset:17408
  v_mul_f32 v224, v28, v28
  v_mul_f32 v225, v29, v29
  v_mfma_f32_16x16x32_bf16 v[36:39], v[56:59], v[136:139], v[36:39]
  ds_read_b128 v[92:95], v12 offset:18432
  v_mul_f32 v226, v30, v30
  v_mul_f32 v227, v31, v31
  v_mfma_f32_16x16x32_bf16 v[32:35], v[60:63], v[140:143], v[32:35]
  ds_read_b128 v[96:99], v12 offset:19456
  v_fma_f32 v220, v220, v20, v19
  v_fma_f32 v221, v221, v20, v19
  v_mfma_f32_16x16x32_bf16 v[36:39], v[64:67], v[140:143], v[36:39]
  ds_read_b128 v[44:47], v12 offset:20480
  v_fma_f32 v222, v222, v20, v19
  v_fma_f32 v223, v223, v20, v19
  s_waitcnt lgkmcnt(5)
  v_mfma_f32_16x16x32_bf16 v[32:35], v[68:71], v[144:147], v[32:35]
  ds_read_b128 v[48:51], v12 offset:21504
  v_fma_f32 v224, v224, v20, v19
  v_fma_f32 v225, v225, v20, v19
  v_mfma_f32_16x16x32_bf16 v[36:39], v[72:75], v[144:147], v[36:39]
  ds_read_b128 v[52:55], v12 offset:22528
  v_fma_f32 v226, v226, v20, v19
  v_fma_f32 v227, v227, v20, v19
  v_mfma_f32_16x16x32_bf16 v[32:35], v[76:79], v[148:151], v[32:35]
  ds_read_b128 v[56:59], v12 offset:23552
  v_mul_f32 v220, v220, v24
  v_mul_f32 v221, v221, v25
  v_mfma_f32_16x16x32_bf16 v[36:39], v[80:83], v[148:151], v[36:39]
  ds_read_b128 v[60:63], v12 offset:24576
  v_mul_f32 v222, v222, v26
  v_mul_f32 v223, v223, v27
  s_waitcnt lgkmcnt(5)
  v_mfma_f32_16x16x32_bf16 v[32:35], v[84:87], v[152:155], v[32:35]
  ds_read_b128 v[64:67], v12 offset:25600
  v_mul_f32 v224, v224, v28
  v_mul_f32 v225, v225, v29
  v_mfma_f32_16x16x32_bf16 v[36:39], v[88:91], v[152:155], v[36:39]
  ds_read_b128 v[68:71], v12 offset:26624
  v_mul_f32 v226, v226, v30
  v_mul_f32 v227, v227, v31
  v_mfma_f32_16x16x32_bf16 v[32:35], v[92:95], v[156:159], v[32:35]
  ds_read_b128 v[72:75], v12 offset:27648
  v_exp_f32 v220, v220
  v_exp_f32 v221, v221
  v_mfma_f32_16x16x32_bf16 v[36:39], v[96:99], v[156:159], v[36:39]
  ds_read_b128 v[76:79], v12 offset:28672
  v_exp_f32 v222, v222
  v_exp_f32 v223, v223
  s_waitcnt lgkmcnt(5)
  v_mfma_f32_16x16x32_bf16 v[32:35], v[44:47], v[160:163], v[32:35]
  ds_read_b128 v[80:83], v12 offset:29696
  v_exp_f32 v224, v224
  v_exp_f32 v225, v225
  v_mfma_f32_16x16x32_bf16 v[36:39], v[48:51], v[160:163], v[36:39]
  ds_read_b128 v[84:87], v12 offset:30720
  v_exp_f32 v226, v226
  v_exp_f32 v227, v227
  ds_read_b128 v[240:243], v207 offset:384
  ds_read_b128 v[244:247], v207 offset:448
  v_mfma_f32_16x16x32_bf16 v[32:35], v[52:55], v[164:167], v[32:35]
  ds_read_b128 v[88:91], v12 offset:31744
  v_fma_f32 v220, v220, v21, v21
  v_fma_f32 v221, v221, v21, v21
  v_mfma_f32_16x16x32_bf16 v[36:39], v[56:59], v[164:167], v[36:39]
  ds_read_b128 v[92:95], v12 offset:32768
  v_fma_f32 v222, v222, v21, v21
  v_fma_f32 v223, v223, v21, v21
  s_waitcnt lgkmcnt(5)
  v_mfma_f32_16x16x32_bf16 v[32:35], v[60:63], v[168:171], v[32:35]
  ds_read_b128 v[96:99], v12 offset:33792
  v_fma_f32 v224, v224, v21, v21
  v_fma_f32 v225, v225, v21, v21
  v_mfma_f32_16x16x32_bf16 v[36:39], v[64:67], v[168:171], v[36:39]
  ds_read_b128 v[44:47], v12 offset:34816
  v_fma_f32 v226, v226, v21, v21
  v_fma_f32 v227, v227, v21, v21
  v_mfma_f32_16x16x32_bf16 v[32:35], v[68:71], v[172:175], v[32:35]
  ds_read_b128 v[48:51], v12 offset:35840
  v_rcp_f32 v220, v220
  v_rcp_f32 v221, v221
  v_mfma_f32_16x16x32_bf16 v[36:39], v[72:75], v[172:175], v[36:39]
  ds_read_b128 v[52:55], v12 offset:36864
  v_rcp_f32 v222, v222
  v_rcp_f32 v223, v223
  s_waitcnt lgkmcnt(5)
  v_mfma_f32_16x16x32_bf16 v[32:35], v[76:79], v[176:179], v[32:35]
  ds_read_b128 v[56:59], v12 offset:37888
  v_rcp_f32 v224, v224
  v_rcp_f32 v225, v225
  v_mfma_f32_16x16x32_bf16 v[36:39], v[80:83], v[176:179], v[36:39]
  ds_read_b128 v[60:63], v12 offset:38912
  v_rcp_f32 v226, v226
  v_rcp_f32 v227, v227
  v_mfma_f32_16x16x32_bf16 v[32:35], v[84:87], v[180:183], v[32:35]
  ds_read_b128 v[64:67], v12 offset:39936
  v_mul_f32 v24, v24, v220
  v_mul_f32 v25, v25, v221
  v_mfma_f32_16x16x32_bf16 v[36:39], v[88:91], v[180:183], v[36:39]
  ds_read_b128 v[68:71], v12 offset:40960
  v_mul_f32 v26, v26, v222
  v_mul_f32 v27, v27, v223
  s_waitcnt lgkmcnt(5)
  v_mfma_f32_16x16x32_bf16 v[32:35], v[92:95], v[184:187], v[32:35]
  ds_read_b128 v[72:75], v12 offset:41984
  v_mul_f32 v28, v28, v224
  v_mul_f32 v29, v29, v225
  v_mfma_f32_16x16x32_bf16 v[36:39], v[96:99], v[184:187], v[36:39]
  ds_read_b128 v[76:79], v12 offset:43008
  v_mul_f32 v30, v30, v226
  v_mul_f32 v31, v31, v227
  v_mfma_f32_16x16x32_bf16 v[32:35], v[44:47], v[188:191], v[32:35]
  ds_read_b128 v[80:83], v12 offset:44032
  v_cvt_pk_bf16_f32 v40, v24, v25
  v_cvt_pk_bf16_f32 v41, v26, v27
  v_mfma_f32_16x16x32_bf16 v[36:39], v[48:51], v[188:191], v[36:39]
  ds_read_b128 v[84:87], v12 offset:45056
  v_cvt_pk_bf16_f32 v42, v28, v29
  v_cvt_pk_bf16_f32 v43, v30, v31
  s_waitcnt lgkmcnt(5)
  v_mfma_f32_16x16x32_bf16 v[32:35], v[52:55], v[192:195], v[32:35]
  ds_read_b128 v[88:91], v12 offset:46080
  s_waitcnt vmcnt(0)
  s_cmp_eq_u32 s6, 0
  s_cbranch_scc1 SL_127
  s_mov_b64 exec, 1
  buffer_store_dword v252, v11, s[16:19], s42 offen
  s_mov_b64 exec, -1
  s_branch SE_128
SL_127:
  s_nop 1
  s_mov_b64 exec, 1
  buffer_store_dword v252, v11, s[16:19], s42 offen sc1
  s_mov_b64 exec, -1
SE_128:
  buffer_store_dwordx4 v[40:43], v5, s[16:19], s40 offen offset:2048 sc1
  v_mfma_f32_16x16x32_bf16 v[36:39], v[56:59], v[192:195], v[36:39]
  ds_read_b128 v[92:95], v12 offset:47104
  v_mfma_f32_16x16x32_bf16 v[32:35], v[60:63], v[196:199], v[32:35]
  ds_read_b128 v[96:99], v12 offset:48128
  v_mfma_f32_16x16x32_bf16 v[36:39], v[64:67], v[196:199], v[36:39]
  ds_read_b128 v[44:47], v12 offset:49152
  s_barrier
  s_waitcnt lgkmcnt(5)
  v_mfma_f32_16x16x32_bf16 v[24:27], v[68:71], v[120:123], 0
  ds_read_b128 v[48:51], v12 offset:50176
  v_mfma_f32_16x16x32_bf16 v[28:31], v[72:75], v[120:123], 0
  ds_read_b128 v[52:55], v12 offset:51200
  v_mfma_f32_16x16x32_bf16 v[24:27], v[76:79], v[124:127], v[24:27]
  ds_read_b128 v[56:59], v12 offset:52224
  v_fma_f32 v32, -v18, v240, v32
  v_fma_f32 v33, -v18, v241, v33
  v_mfma_f32_16x16x32_bf16 v[28:31], v[80:83], v[124:127], v[28:31]
  ds_read_b128 v[60:63], v12 offset:53248
  v_fma_f32 v34, -v18, v242, v34
  v_fma_f32 v35, -v18, v243, v35
  s_waitcnt lgkmcnt(5)
  v_mfma_f32_16x16x32_bf16 v[24:27], v[84:87], v[128:131], v[24:27]
  ds_read_b128 v[64:67], v12 offset:54272
  v_fma_f32 v36, -v18, v244, v36
  v_fma_f32 v37, -v18, v245, v37
  v_mfma_f32_16x16x32_bf16 v[28:31], v[88:91], v[128:131], v[28:31]
  ds_read_b128 v[68:71], v12 offset:55296
  v_fma_f32 v38, -v18, v246, v38
  v_fma_f32 v39, -v18, v247, v39
  v_mfma_f32_16x16x32_bf16 v[24:27], v[92:95], v[132:135], v[24:27]
  ds_read_b128 v[72:75], v12 offset:56320
  v_mul_f32 v220, v32, v32
  v_mul_f32 v221, v33, v33
  v_mfma_f32_16x16x32_bf16 v[28:31], v[96:99], v[132:135], v[28:31]
  ds_read_b128 v[76:79], v12 offset:57344
  v_mul_f32 v222, v34, v34
  v_mul_f32 v223, v35, v35
  s_waitcnt lgkmcnt(5)
  v_mfma_f32_16x16x32_bf16 v[24:27], v[44:47], v[136:139], v[24:27]
  ds_read_b128 v[80:83], v12 offset:58368
  v_mul_f32 v224, v36, v36
  v_mul_f32 v225, v37, v37
  v_mfma_f32_16x16x32_bf16 v[28:31], v[48:51], v[136:139], v[28:31]
  ds_read_b128 v[84:87], v12 offset:59392
  v_mul_f32 v226, v38, v38
  v_mul_f32 v227, v39, v39
  v_mfma_f32_16x16x32_bf16 v[24:27], v[52:55], v[140:143], v[24:27]
  ds_read_b128 v[88:91], v12 offset:60416
  v_fma_f32 v220, v220, v20, v19
  v_fma_f32 v221, v221, v20, v19
  v_mfma_f32_16x16x32_bf16 v[28:31], v[56:59], v[140:143], v[28:31]
  ds_read_b128 v[92:95], v12 offset:61440
  v_fma_f32 v222, v222, v20, v19
  v_fma_f32 v223, v223, v20, v19
  s_waitcnt lgkmcnt(5)
  v_mfma_f32_16x16x32_bf16 v[24:27], v[60:63], v[144:147], v[24:27]
  ds_read_b128 v[96:99], v12 offset:62464
  v_fma_f32 v224, v224, v20, v19
  v_fma_f32 v225, v225, v20, v19
  v_mfma_f32_16x16x32_bf16 v[28:31], v[64:67], v[144:147], v[28:31]
  ds_read_b128 v[44:47], v12 offset:63488
  v_fma_f32 v226, v226, v20, v19
  v_fma_f32 v227, v227, v20, v19
  v_mfma_f32_16x16x32_bf16 v[24:27], v[68:71], v[148:151], v[24:27]
  ds_read_b128 v[48:51], v12 offset:64512
  v_mul_f32 v220, v220, v32
  v_mul_f32 v221, v221, v33
  v_mfma_f32_16x16x32_bf16 v[28:31], v[72:75], v[148:151], v[28:31]
  ds_read_b128 v[52:55], v13 offset:0
  v_mul_f32 v222, v222, v34
  v_mul_f32 v223, v223, v35
  s_waitcnt lgkmcnt(5)
  v_mfma_f32_16x16x32_bf16 v[24:27], v[76:79], v[152:155], v[24:27]
  ds_read_b128 v[56:59], v13 offset:1024
  v_mul_f32 v224, v224, v36
  v_mul_f32 v225, v225, v37
  v_mfma_f32_16x16x32_bf16 v[28:31], v[80:83], v[152:155], v[28:31]
  ds_read_b128 v[60:63], v13 offset:2048
  v_mul_f32 v226, v226, v38
  v_mul_f32 v227, v227, v39
  buffer_load_dword v205, v204, s[16:19], s46 offen sc1
  v_mfma_f32_16x16x32_bf16 v[24:27], v[84:87], v[156:159], v[24:27]
  ds_read_b128 v[64:67], v13 offset:3072
  v_exp_f32 v220, v220
  v_exp_f32 v221, v221
  v_mfma_f32_16x16x32_bf16 v[28:31], v[88:91], v[156:159], v[28:31]
  ds_read_b128 v[68:71], v13 offset:4096
  v_exp_f32 v222, v222
  v_exp_f32 v223, v223
  s_waitcnt lgkmcnt(5)
  v_mfma_f32_16x16x32_bf16 v[24:27], v[92:95], v[160:163], v[24:27]
  ds_read_b128 v[72:75], v13 offset:5120
  v_exp_f32 v224, v224
  v_exp_f32 v225, v225
  v_mfma_f32_16x16x32_bf16 v[28:31], v[96:99], v[160:163], v[28:31]
  ds_read_b128 v[76:79], v13 offset:6144
  v_exp_f32 v226, v226
  v_exp_f32 v227, v227
  ds_read_b128 v[212:215], v207 offset:512
  ds_read_b128 v[216:219], v207 offset:576
  v_mfma_f32_16x16x32_bf16 v[24:27], v[44:47], v[164:167], v[24:27]
  ds_read_b128 v[80:83], v13 offset:7168
  v_fma_f32 v220, v220, v21, v21
  v_fma_f32 v221, v221, v21, v21
  v_mfma_f32_16x16x32_bf16 v[28:31], v[48:51], v[164:167], v[28:31]
  ds_read_b128 v[84:87], v13 offset:8192
  v_fma_f32 v222, v222, v21, v21
  v_fma_f32 v223, v223, v21, v21
  s_waitcnt lgkmcnt(5)
  v_mfma_f32_16x16x32_bf16 v[24:27], v[52:55], v[168:171], v[24:27]
  ds_read_b128 v[88:91], v13 offset:9216
  v_fma_f32 v224, v224, v21, v21
  v_fma_f32 v225, v225, v21, v21
  v_mfma_f32_16x16x32_bf16 v[28:31], v[56:59], v[168:171], v[28:31]
  ds_read_b128 v[92:95], v13 offset:10240
  v_fma_f32 v226, v226, v21, v21
  v_fma_f32 v227, v227, v21, v21
  v_mfma_f32_16x16x32_bf16 v[24:27], v[60:63], v[172:175], v[24:27]
  ds_read_b128 v[96:99], v13 offset:11264
  v_rcp_f32 v220, v220
  v_rcp_f32 v221, v221
  v_mfma_f32_16x16x32_bf16 v[28:31], v[64:67], v[172:175], v[28:31]
  ds_read_b128 v[44:47], v13 offset:12288
  v_rcp_f32 v222, v222
  v_rcp_f32 v223, v223
  s_waitcnt lgkmcnt(5)
  v_mfma_f32_16x16x32_bf16 v[24:27], v[68:71], v[176:179], v[24:27]
  ds_read_b128 v[48:51], v13 offset:13312
  v_rcp_f32 v224, v224
  v_rcp_f32 v225, v225
  v_mfma_f32_16x16x32_bf16 v[28:31], v[72:75], v[176:179], v[28:31]
  ds_read_b128 v[52:55], v13 offset:14336
  v_rcp_f32 v226, v226
  v_rcp_f32 v227, v227
  v_mfma_f32_16x16x32_bf16 v[24:27], v[76:79], v[180:183], v[24:27]
  ds_read_b128 v[56:59], v13 offset:15360
  v_mul_f32 v32, v32, v220
  v_mul_f32 v33, v33, v221
  v_mfma_f32_16x16x32_bf16 v[28:31], v[80:83], v[180:183], v[28:31]
  ds_read_b128 v[60:63], v13 offset:16384
  v_mul_f32 v34, v34, v222
  v_mul_f32 v35, v35, v223
  s_waitcnt lgkmcnt(5)
  v_mfma_f32_16x16x32_bf16 v[24:27], v[84:87], v[184:187], v[24:27]
  ds_read_b128 v[64:67], v13 offset:17408
  v_mul_f32 v36, v36, v224
  v_mul_f32 v37, v37, v225
  v_mfma_f32_16x16x32_bf16 v[28:31], v[88:91], v[184:187], v[28:31]
  ds_read_b128 v[68:71], v13 offset:18432
  v_mul_f32 v38, v38, v226
  v_mul_f32 v39, v39, v227
  v_mfma_f32_16x16x32_bf16 v[24:27], v[92:95], v[188:191], v[24:27]
  ds_read_b128 v[72:75], v13 offset:19456
  v_cvt_pk_bf16_f32 v200, v32, v33
  v_cvt_pk_bf16_f32 v201, v34, v35
  v_mfma_f32_16x16x32_bf16 v[28:31], v[96:99], v[188:191], v[28:31]
  ds_read_b128 v[76:79], v13 offset:20480
  v_cvt_pk_bf16_f32 v202, v36, v37
  v_cvt_pk_bf16_f32 v203, v38, v39
  s_waitcnt lgkmcnt(5)
  v_mfma_f32_16x16x32_bf16 v[24:27], v[44:47], v[192:195], v[24:27]
  ds_read_b128 v[80:83], v13 offset:21504
  buffer_store_dwordx4 v[200:203], v5, s[16:19], s40 offen offset:3072 sc1
  v_mfma_f32_16x16x32_bf16 v[28:31], v[48:51], v[192:195], v[28:31]
  ds_read_b128 v[84:87], v13 offset:22528
  v_mfma_f32_16x16x32_bf16 v[24:27], v[52:55], v[196:199], v[24:27]
  ds_read_b128 v[88:91], v13 offset:23552
  v_mfma_f32_16x16x32_bf16 v[28:31], v[56:59], v[196:199], v[28:31]
  ds_read_b128 v[92:95], v13 offset:24576
  s_barrier
  s_waitcnt lgkmcnt(5)
  v_mfma_f32_16x16x32_bf16 v[32:35], v[60:63], v[120:123], 0
  ds_read_b128 v[96:99], v13 offset:25600
  v_mfma_f32_16x16x32_bf16 v[36:39], v[64:67], v[120:123], 0
  ds_read_b128 v[44:47], v13 offset:26624
  v_mfma_f32_16x16x32_bf16 v[32:35], v[68:71], v[124:127], v[32:35]
  ds_read_b128 v[48:51], v13 offset:27648
  v_fma_f32 v24, -v18, v212, v24
  v_fma_f32 v25, -v18, v213, v25
  v_mfma_f32_16x16x32_bf16 v[36:39], v[72:75], v[124:127], v[36:39]
  ds_read_b128 v[52:55], v13 offset:28672
  v_fma_f32 v26, -v18, v214, v26
  v_fma_f32 v27, -v18, v215, v27
  s_waitcnt lgkmcnt(5)
  v_mfma_f32_16x16x32_bf16 v[32:35], v[76:79], v[128:131], v[32:35]
  ds_read_b128 v[56:59], v13 offset:29696
  v_fma_f32 v28, -v18, v216, v28
  v_fma_f32 v29, -v18, v217, v29
  v_mfma_f32_16x16x32_bf16 v[36:39], v[80:83], v[128:131], v[36:39]
  ds_read_b128 v[60:63], v13 offset:30720
  v_fma_f32 v30, -v18, v218, v30
  v_fma_f32 v31, -v18, v219, v31
  v_mfma_f32_16x16x32_bf16 v[32:35], v[84:87], v[132:135], v[32:35]
  ds_read_b128 v[64:67], v13 offset:31744
  v_mul_f32 v220, v24, v24
  v_mul_f32 v221, v25, v25
  v_mfma_f32_16x16x32_bf16 v[36:39], v[88:91], v[132:135], v[36:39]
  ds_read_b128 v[68:71], v13 offset:32768
  v_mul_f32 v222, v26, v26
  v_mul_f32 v223, v27, v27
  s_waitcnt lgkmcnt(5)
  v_mfma_f32_16x16x32_bf16 v[32:35], v[92:95], v[136:139], v[32:35]
  ds_read_b128 v[72:75], v13 offset:33792
  v_mul_f32 v224, v28, v28
  v_mul_f32 v225, v29, v29
  v_mfma_f32_16x16x32_bf16 v[36:39], v[96:99], v[136:139], v[36:39]
  ds_read_b128 v[76:79], v13 offset:34816
  v_mul_f32 v226, v30, v30
  v_mul_f32 v227, v31, v31
  s_mov_b32 s7, 400000
  s_waitcnt vmcnt(1)
  s_branch PE_131
P_129:
  buffer_load_dword v205, v204, s[16:19], s46 offen sc1
  s_waitcnt vmcnt(0)
PE_131:
  v_cmp_ne_u32 vcc, s99, v205
  s_nop 0
  s_cbranch_vccz PD_130
  s_sub_u32 s7, s7, 1
  s_cbranch_scc0 P_129
PD_130:
  s_add_u32 s46, s46, 4096
  v_mfma_f32_16x16x32_bf16 v[32:35], v[44:47], v[140:143], v[32:35]
  ds_read_b128 v[80:83], v13 offset:35840
  v_fma_f32 v220, v220, v20, v19
  v_fma_f32 v221, v221, v20, v19
  v_mfma_f32_16x16x32_bf16 v[36:39], v[48:51], v[140:143], v[36:39]
  ds_read_b128 v[84:87], v13 offset:36864
  buffer_load_dwordx4 v[120:123], v5, s[16:19], s65 offen offset:0 sc1
  buffer_load_dwordx4 v[124:127], v5, s[16:19], s65 offen offset:1024 sc1
  v_fma_f32 v222, v222, v20, v19
  v_fma_f32 v223, v223, v20, v19
  s_waitcnt lgkmcnt(5)
  v_mfma_f32_16x16x32_bf16 v[32:35], v[52:55], v[144:147], v[32:35]
  ds_read_b128 v[88:91], v13 offset:37888
  v_fma_f32 v224, v224, v20, v19
  v_fma_f32 v225, v225, v20, v19
  v_mfma_f32_16x16x32_bf16 v[36:39], v[56:59], v[144:147], v[36:39]
  ds_read_b128 v[92:95], v13 offset:38912
  buffer_load_dwordx4 v[128:131], v5, s[16:19], s66 offen offset:0 sc1
  buffer_load_dwordx4 v[132:135], v5, s[16:19], s66 offen offset:1024 sc1
  v_fma_f32 v226, v226, v20, v19
  v_fma_f32 v227, v227, v20, v19
  v_mfma_f32_16x16x32_bf16 v[32:35], v[60:63], v[148:151], v[32:35]
  ds_read_b128 v[96:99], v13 offset:39936
  v_mul_f32 v220, v220, v24
  v_mul_f32 v221, v221, v25
  v_mfma_f32_16x16x32_bf16 v[36:39], v[64:67], v[148:151], v[36:39]
  ds_read_b128 v[44:47], v13 offset:40960
  buffer_load_dwordx4 v[136:139], v5, s[16:19], s67 offen offset:0 sc1
  buffer_load_dwordx4 v[140:143], v5, s[16:19], s67 offen offset:1024 sc1
  v_mul_f32 v222, v222, v26
  v_mul_f32 v223, v223, v27
  s_waitcnt lgkmcnt(5)
  v_mfma_f32_16x16x32_bf16 v[32:35], v[68:71], v[152:155], v[32:35]
  ds_read_b128 v[48:51], v13 offset:41984
  v_mul_f32 v224, v224, v28
  v_mul_f32 v225, v225, v29
  v_mfma_f32_16x16x32_bf16 v[36:39], v[72:75], v[152:155], v[36:39]
  ds_read_b128 v[52:55], v13 offset:43008
  buffer_load_dwordx4 v[144:147], v5, s[16:19], s68 offen offset:0 sc1
  buffer_load_dwordx4 v[148:151], v5, s[16:19], s68 offen offset:1024 sc1
  v_mul_f32 v226, v226, v30
  v_mul_f32 v227, v227, v31
  v_mfma_f32_16x16x32_bf16 v[32:35], v[76:79], v[156:159], v[32:35]
  ds_read_b128 v[56:59], v13 offset:44032
  v_exp_f32 v220, v220
  v_exp_f32 v221, v221
  v_mfma_f32_16x16x32_bf16 v[36:39], v[80:83], v[156:159], v[36:39]
  ds_read_b128 v[60:63], v13 offset:45056
  buffer_load_dwordx4 v[152:155], v5, s[16:19], s69 offen offset:0 sc1
  buffer_load_dwordx4 v[156:159], v5, s[16:19], s69 offen offset:1024 sc1
  v_exp_f32 v222, v222
  v_exp_f32 v223, v223
  s_waitcnt lgkmcnt(5)
  v_mfma_f32_16x16x32_bf16 v[32:35], v[84:87], v[160:163], v[32:35]
  ds_read_b128 v[64:67], v13 offset:46080
  v_exp_f32 v224, v224
  v_exp_f32 v225, v225
  v_mfma_f32_16x16x32_bf16 v[36:39], v[88:91], v[160:163], v[36:39]
  ds_read_b128 v[68:71], v13 offset:47104
  buffer_load_dwordx4 v[160:163], v5, s[16:19], s70 offen offset:0 sc1
  v_exp_f32 v226, v226
  v_exp_f32 v227, v227
  ds_read_b128 v[240:243], v207 offset:640
  ds_read_b128 v[244:247], v207 offset:704
  v_mfma_f32_16x16x32_bf16 v[32:35], v[92:95], v[164:167], v[32:35]
  ds_read_b128 v[72:75], v13 offset:48128
  v_fma_f32 v220, v220, v21, v21
  v_fma_f32 v221, v221, v21, v21
  v_mfma_f32_16x16x32_bf16 v[36:39], v[96:99], v[164:167], v[36:39]
  ds_read_b128 v[76:79], v13 offset:49152
  buffer_load_dwordx4 v[164:167], v5, s[16:19], s70 offen offset:1024 sc1
  v_fma_f32 v222, v222, v21, v21
  v_fma_f32 v223, v223, v21, v21
  s_waitcnt lgkmcnt(5)
  v_mfma_f32_16x16x32_bf16 v[32:35], v[44:47], v[168:171], v[32:35]
  ds_read_b128 v[80:83], v13 offset:50176
  v_fma_f32 v224, v224, v21, v21
  v_fma_f32 v225, v225, v21, v21
  v_mfma_f32_16x16x32_bf16 v[36:39], v[48:51], v[168:171], v[36:39]
  ds_read_b128 v[84:87], v13 offset:51200
  buffer_load_dwordx4 v[168:171], v5, s[16:19], s71 offen offset:0 sc1
  v_fma_f32 v226, v226, v21, v21
  v_fma_f32 v227, v227, v21, v21
  v_mfma_f32_16x16x32_bf16 v[32:35], v[52:55], v[172:175], v[32:35]
  ds_read_b128 v[88:91], v13 offset:52224
  v_rcp_f32 v220, v220
  v_rcp_f32 v221, v221
  v_mfma_f32_16x16x32_bf16 v[36:39], v[56:59], v[172:175], v[36:39]
  ds_read_b128 v[92:95], v13 offset:53248
  buffer_load_dwordx4 v[172:175], v5, s[16:19], s71 offen offset:1024 sc1
  v_rcp_f32 v222, v222
  v_rcp_f32 v223, v223
  s_waitcnt lgkmcnt(5)
  v_mfma_f32_16x16x32_bf16 v[32:35], v[60:63], v[176:179], v[32:35]
  ds_read_b128 v[96:99], v13 offset:54272
  v_rcp_f32 v224, v224
  v_rcp_f32 v225, v225
  v_mfma_f32_16x16x32_bf16 v[36:39], v[64:67], v[176:179], v[36:39]
  ds_read_b128 v[44:47], v13 offset:55296
  v_rcp_f32 v226, v226
  v_rcp_f32 v227, v227
  v_mfma_f32_16x16x32_bf16 v[32:35], v[68:71], v[180:183], v[32:35]
  ds_read_b128 v[48:51], v13 offset:56320
  v_mul_f32 v24, v24, v220
  v_mul_f32 v25, v25, v221
  v_mfma_f32_16x16x32_bf16 v[36:39], v[72:75], v[180:183], v[36:39]
  ds_read_b128 v[52:55], v13 offset:57344
  v_mul_f32 v26, v26, v222
  v_mul_f32 v27, v27, v223
  s_waitcnt lgkmcnt(5)
  v_mfma_f32_16x16x32_bf16 v[32:35], v[76:79], v[184:187], v[32:35]
  ds_read_b128 v[56:59], v13 offset:58368
  v_mul_f32 v28, v28, v224
  v_mul_f32 v29, v29, v225
  v_mfma_f32_16x16x32_bf16 v[36:39], v[80:83], v[184:187], v[36:39]
  ds_read_b128 v[60:63], v13 offset:59392
  v_mul_f32 v30, v30, v226
  v_mul_f32 v31, v31, v227
  v_mfma_f32_16x16x32_bf16 v[32:35], v[84:87], v[188:191], v[32:35]
  ds_read_b128 v[64:67], v13 offset:60416
  v_cvt_pk_bf16_f32 v248, v24, v25
  v_cvt_pk_bf16_f32 v249, v26, v27
  v_mfma_f32_16x16x32_bf16 v[36:39], v[88:91], v[188:191], v[36:39]
  ds_read_b128 v[68:71], v13 offset:61440
  v_cvt_pk_bf16_f32 v250, v28, v29
  v_cvt_pk_bf16_f32 v251, v30, v31
  s_waitcnt lgkmcnt(5)
  v_mfma_f32_16x16x32_bf16 v[32:35], v[92:95], v[192:195], v[32:35]
  ds_read_b128 v[72:75], v13 offset:62464
  s_waitcnt vmcnt(14)
  s_cmp_eq_u32 s6, 0
  s_cbranch_scc1 SL_132
  s_mov_b64 exec, 1
  buffer_store_dword v252, v11, s[16:19], s43 offen
  s_mov_b64 exec, -1
  s_branch SE_133
SL_132:
  s_nop 1
  s_mov_b64 exec, 1
  buffer_store_dword v252, v11, s[16:19], s43 offen sc1
  s_mov_b64 exec, -1
SE_133:
  buffer_store_dwordx4 v[248:251], v5, s[16:19], s41 offen offset:0 sc1
  v_mfma_f32_16x16x32_bf16 v[36:39], v[96:99], v[192:195], v[36:39]
  ds_read_b128 v[76:79], v13 offset:63488
  v_mfma_f32_16x16x32_bf16 v[32:35], v[44:47], v[196:199], v[32:35]
  ds_read_b128 v[80:83], v13 offset:64512
  v_mfma_f32_16x16x32_bf16 v[36:39], v[48:51], v[196:199], v[36:39]
  ds_read_b128 v[84:87], v14 offset:0
  s_barrier
  s_waitcnt lgkmcnt(4)
  v_mfma_f32_16x16x32_bf16 v[100:103], v[52:55], v[228:231], v[100:103]
  ds_read_b128 v[88:91], v14 offset:1024
  v_mfma_f32_16x16x32_bf16 v[104:107], v[56:59], v[228:231], v[104:107]
  ds_read_b128 v[92:95], v14 offset:2048
  v_mfma_f32_16x16x32_bf16 v[108:111], v[60:63], v[228:231], v[108:111]
  ds_read_b128 v[96:99], v14 offset:3072
  v_fma_f32 v32, -v18, v240, v32
  v_fma_f32 v33, -v18, v241, v33
  v_mfma_f32_16x16x32_bf16 v[112:115], v[64:67], v[228:231], v[112:115]
  ds_read_b128 v[44:47], v14 offset:4096
  v_fma_f32 v34, -v18, v242, v34
  v_fma_f32 v35, -v18, v243, v35
  v_mfma_f32_16x16x32_bf16 v[116:119], v[68:71], v[228:231], v[116:119]
  ds_read_b128 v[48:51], v14 offset:5120
  v_fma_f32 v36, -v18, v244, v36
  v_fma_f32 v37, -v18, v245, v37
  s_waitcnt lgkmcnt(4)
  v_mfma_f32_16x16x32_bf16 v[100:103], v[72:75], v[232:235], v[100:103]
  ds_read_b128 v[52:55], v14 offset:6144
  v_fma_f32 v38, -v18, v246, v38
  v_fma_f32 v39, -v18, v247, v39
  v_mfma_f32_16x16x32_bf16 v[104:107], v[76:79], v[232:235], v[104:107]
  ds_read_b128 v[56:59], v14 offset:7168
  v_mul_f32 v220, v32, v32
  v_mul_f32 v221, v33, v33
  v_mfma_f32_16x16x32_bf16 v[108:111], v[80:83], v[232:235], v[108:111]
  ds_read_b128 v[60:63], v14 offset:8192
  v_mul_f32 v222, v34, v34
  v_mul_f32 v223, v35, v35
  v_mfma_f32_16x16x32_bf16 v[112:115], v[84:87], v[232:235], v[112:115]
  ds_read_b128 v[64:67], v14 offset:9216
  v_mul_f32 v224, v36, v36
  v_mul_f32 v225, v37, v37
  v_mfma_f32_16x16x32_bf16 v[116:119], v[88:91], v[232:235], v[116:119]
  ds_read_b128 v[68:71], v14 offset:10240
  v_mul_f32 v226, v38, v38
  v_mul_f32 v227, v39, v39
  buffer_load_dword v205, v204, s[16:19], s46 offen sc1
  s_waitcnt vmcnt(16) lgkmcnt(4)
  v_mfma_f32_16x16x32_bf16 v[100:103], v[92:95], v[120:123], v[100:103]
  ds_read_b128 v[72:75], v14 offset:11264
  v_fma_f32 v220, v220, v20, v19
  v_fma_f32 v221, v221, v20, v19
  v_mfma_f32_16x16x32_bf16 v[104:107], v[96:99], v[120:123], v[104:107]
  ds_read_b128 v[76:79], v12 offset:0
  v_fma_f32 v222, v222, v20, v19
  v_fma_f32 v223, v223, v20, v19
  v_mfma_f32_16x16x32_bf16 v[108:111], v[44:47], v[120:123], v[108:111]
  ds_read_b128 v[80:83], v12 offset:1024
  v_fma_f32 v224, v224, v20, v19
  v_fma_f32 v225, v225, v20, v19
  v_mfma_f32_16x16x32_bf16 v[112:115], v[48:51], v[120:123], v[112:115]
  ds_read_b128 v[84:87], v12 offset:2048
  v_fma_f32 v226, v226, v20, v19
  v_fma_f32 v227, v227, v20, v19
  v_mfma_f32_16x16x32_bf16 v[116:119], v[52:55], v[120:123], v[116:119]
  ds_read_b128 v[88:91], v12 offset:3072
  v_mul_f32 v220, v220, v32
  v_mul_f32 v221, v221, v33
  s_waitcnt vmcnt(15) lgkmcnt(4)
  v_mfma_f32_16x16x32_bf16 v[100:103], v[56:59], v[124:127], v[100:103]
  ds_read_b128 v[92:95], v12 offset:4096
  v_mul_f32 v222, v222, v34
  v_mul_f32 v223, v223, v35
  v_mfma_f32_16x16x32_bf16 v[104:107], v[60:63], v[124:127], v[104:107]
  ds_read_b128 v[96:99], v12 offset:5120
  v_mul_f32 v224, v224, v36
  v_mul_f32 v225, v225, v37
  v_mfma_f32_16x16x32_bf16 v[108:111], v[64:67], v[124:127], v[108:111]
  ds_read_b128 v[44:47], v12 offset:6144
  v_mul_f32 v226, v226, v38
  v_mul_f32 v227, v227, v39
  v_mfma_f32_16x16x32_bf16 v[112:115], v[68:71], v[124:127], v[112:115]
  ds_read_b128 v[48:51], v12 offset:7168
  v_exp_f32 v220, v220
  v_exp_f32 v221, v221
  v_mfma_f32_16x16x32_bf16 v[116:119], v[72:75], v[124:127], v[116:119]
  ds_read_b128 v[52:55], v12 offset:8192
  v_exp_f32 v222, v222
  v_exp_f32 v223, v223
  s_waitcnt vmcnt(14) lgkmcnt(4)
  v_mfma_f32_16x16x32_bf16 v[100:103], v[76:79], v[128:131], v[100:103]
  ds_read_b128 v[56:59], v12 offset:9216
  v_exp_f32 v224, v224
  v_exp_f32 v225, v225
  v_mfma_f32_16x16x32_bf16 v[104:107], v[80:83], v[128:131], v[104:107]
  ds_read_b128 v[60:63], v12 offset:10240
  v_exp_f32 v226, v226
  v_exp_f32 v227, v227
  v_mfma_f32_16x16x32_bf16 v[108:111], v[84:87], v[128:131], v[108:111]
  ds_read_b128 v[64:67], v12 offset:11264
  v_fma_f32 v220, v220, v21, v21
  v_fma_f32 v221, v221, v21, v21
  v_mfma_f32_16x16x32_bf16 v[112:115], v[88:91], v[128:131], v[112:115]
  ds_read_b128 v[68:71], v12 offset:12288
  v_fma_f32 v222, v222, v21, v21
  v_fma_f32 v223, v223, v21, v21
  v_mfma_f32_16x16x32_bf16 v[116:119], v[92:95], v[128:131], v[116:119]
  ds_read_b128 v[72:75], v12 offset:13312
  v_fma_f32 v224, v224, v21, v21
  v_fma_f32 v225, v225, v21, v21
  s_waitcnt vmcnt(13) lgkmcnt(4)
  v_mfma_f32_16x16x32_bf16 v[100:103], v[96:99], v[132:135], v[100:103]
  ds_read_b128 v[76:79], v12 offset:14336
  v_fma_f32 v226, v226, v21, v21
  v_fma_f32 v227, v227, v21, v21
  v_mfma_f32_16x16x32_bf16 v[104:107], v[44:47], v[132:135], v[104:107]
  ds_read_b128 v[80:83], v12 offset:15360
  v_rcp_f32 v220, v220
  v_rcp_f32 v221, v221
  v_mfma_f32_16x16x32_bf16 v[108:111], v[48:51], v[132:135], v[108:111]
  ds_read_b128 v[84:87], v12 offset:16384
  v_rcp_f32 v222, v222
  v_rcp_f32 v223, v223
  v_mfma_f32_16x16x32_bf16 v[112:115], v[52:55], v[132:135], v[112:115]
  ds_read_b128 v[88:91], v12 offset:17408
  v_rcp_f32 v224, v224
  v_rcp_f32 v225, v225
  v_mfma_f32_16x16x32_bf16 v[116:119], v[56:59], v[132:135], v[116:119]
  ds_read_b128 v[92:95], v12 offset:18432
  v_rcp_f32 v226, v226
  v_rcp_f32 v227, v227
  s_waitcnt vmcnt(12) lgkmcnt(4)
  v_mfma_f32_16x16x32_bf16 v[100:103], v[60:63], v[136:139], v[100:103]
  ds_read_b128 v[96:99], v12 offset:19456
  v_mul_f32 v32, v32, v220
  v_mul_f32 v33, v33, v221
  v_mfma_f32_16x16x32_bf16 v[104:107], v[64:67], v[136:139], v[104:107]
  ds_read_b128 v[44:47], v12 offset:20480
  v_mul_f32 v34, v34, v222
  v_mul_f32 v35, v35, v223
  v_mfma_f32_16x16x32_bf16 v[108:111], v[68:71], v[136:139], v[108:111]
  ds_read_b128 v[48:51], v12 offset:21504
  v_mul_f32 v36, v36, v224
  v_mul_f32 v37, v37, v225
  v_mfma_f32_16x16x32_bf16 v[112:115], v[72:75], v[136:139], v[112:115]
  ds_read_b128 v[52:55], v12 offset:22528
  v_mul_f32 v38, v38, v226
  v_mul_f32 v39, v39, v227
  v_mfma_f32_16x16x32_bf16 v[116:119], v[76:79], v[136:139], v[116:119]
  ds_read_b128 v[56:59], v12 offset:23552
  v_cvt_pk_bf16_f32 v236, v32, v33
  v_cvt_pk_bf16_f32 v237, v34, v35
  s_waitcnt vmcnt(11) lgkmcnt(4)
  v_mfma_f32_16x16x32_bf16 v[100:103], v[80:83], v[140:143], v[100:103]
  ds_read_b128 v[60:63], v12 offset:24576
  v_cvt_pk_bf16_f32 v238, v36, v37
  v_cvt_pk_bf16_f32 v239, v38, v39
  v_mfma_f32_16x16x32_bf16 v[104:107], v[84:87], v[140:143], v[104:107]
  ds_read_b128 v[64:67], v12 offset:25600
  buffer_store_dwordx4 v[236:239], v5, s[16:19], s41 offen offset:1024 sc1
  v_mfma_f32_16x16x32_bf16 v[108:111], v[88:91], v[140:143], v[108:111]
  ds_read_b128 v[68:71], v12 offset:26624
  v_mfma_f32_16x16x32_bf16 v[112:115], v[92:95], v[140:143], v[112:115]
  ds_read_b128 v[72:75], v12 offset:27648
  v_mfma_f32_16x16x32_bf16 v[116:119], v[96:99], v[140:143], v[116:119]
  ds_read_b128 v[76:79], v12 offset:28672
  s_barrier
  s_waitcnt vmcnt(11) lgkmcnt(4)
  v_mfma_f32_16x16x32_bf16 v[100:103], v[44:47], v[144:147], v[100:103]
  ds_read_b128 v[80:83], v12 offset:29696
  v_mfma_f32_16x16x32_bf16 v[104:107], v[48:51], v[144:147], v[104:107]
  ds_read_b128 v[84:87], v12 offset:30720
  v_mfma_f32_16x16x32_bf16 v[108:111], v[52:55], v[144:147], v[108:111]
  ds_read_b128 v[88:91], v12 offset:31744
  v_mfma_f32_16x16x32_bf16 v[112:115], v[56:59], v[144:147], v[112:115]
  ds_read_b128 v[92:95], v12 offset:32768
  v_mfma_f32_16x16x32_bf16 v[116:119], v[60:63], v[144:147], v[116:119]
  ds_read_b128 v[96:99], v12 offset:33792
  s_waitcnt vmcnt(10) lgkmcnt(4)
  v_mfma_f32_16x16x32_bf16 v[100:103], v[64:67], v[148:151], v[100:103]
  ds_read_b128 v[44:47], v12 offset:34816
  s_mov_b32 s7, 400000
  s_waitcnt vmcnt(1)
  s_branch PE_136
P_134:
  buffer_load_dword v205, v204, s[16:19], s46 offen sc1
  s_waitcnt vmcnt(0)
PE_136:
  v_cmp_ne_u32 vcc, s99, v205
  s_nop 0
  s_cbranch_vccz PD_135
  s_sub_u32 s7, s7, 1
  s_cbranch_scc0 P_134
PD_135:
  s_add_u32 s46, s46, 4096
  v_mfma_f32_16x16x32_bf16 v[104:107], v[68:71], v[148:151], v[104:107]
  ds_read_b128 v[48:51], v12 offset:35840
  v_mfma_f32_16x16x32_bf16 v[108:111], v[72:75], v[148:151], v[108:111]
  ds_read_b128 v[52:55], v12 offset:36864
  v_mfma_f32_16x16x32_bf16 v[112:115], v[76:79], v[148:151], v[112:115]
  ds_read_b128 v[56:59], v12 offset:37888
  v_mfma_f32_16x16x32_bf16 v[116:119], v[80:83], v[148:151], v[116:119]
  ds_read_b128 v[60:63], v12 offset:38912
  buffer_load_dwordx4 v[176:179], v5, s[16:19], s65 offen offset:2048 sc1
  buffer_load_dwordx4 v[180:183], v5, s[16:19], s65 offen offset:3072 sc1
  s_waitcnt vmcnt(11) lgkmcnt(4)
  v_mfma_f32_16x16x32_bf16 v[100:103], v[84:87], v[152:155], v[100:103]
  ds_read_b128 v[64:67], v12 offset:39936
  v_mfma_f32_16x16x32_bf16 v[104:107], v[88:91], v[152:155], v[104:107]
  ds_read_b128 v[68:71], v12 offset:40960
  v_mfma_f32_16x16x32_bf16 v[108:111], v[92:95], v[152:155], v[108:111]
  ds_read_b128 v[72:75], v12 offset:41984
  v_mfma_f32_16x16x32_bf16 v[112:115], v[96:99], v[152:155], v[112:115]
  ds_read_b128 v[76:79], v12 offset:43008
  v_mfma_f32_16x16x32_bf16 v[116:119], v[44:47], v[152:155], v[116:119]
  ds_read_b128 v[80:83], v12 offset:44032
  buffer_load_dwordx4 v[184:187], v5, s[16:19], s66 offen offset:2048 sc1
  buffer_load_dwordx4 v[188:191], v5, s[16:19], s66 offen offset:3072 sc1
  s_waitcnt vmcnt(12) lgkmcnt(4)
  v_mfma_f32_16x16x32_bf16 v[100:103], v[48:51], v[156:159], v[100:103]
  ds_read_b128 v[84:87], v12 offset:45056
  v_mfma_f32_16x16x32_bf16 v[104:107], v[52:55], v[156:159], v[104:107]
  ds_read_b128 v[88:91], v12 offset:46080
  v_mfma_f32_16x16x32_bf16 v[108:111], v[56:59], v[156:159], v[108:111]
  ds_read_b128 v[92:95], v12 offset:47104
  v_mfma_f32_16x16x32_bf16 v[112:115], v[60:63], v[156:159], v[112:115]
  ds_read_b128 v[96:99], v12 offset:48128
  v_mfma_f32_16x16x32_bf16 v[116:119], v[64:67], v[156:159], v[116:119]
  ds_read_b128 v[44:47], v12 offset:49152
  buffer_load_dwordx4 v[192:195], v5, s[16:19], s67 offen offset:2048 sc1
  buffer_load_dwordx4 v[196:199], v5, s[16:19], s67 offen offset:3072 sc1
  s_waitcnt vmcnt(13) lgkmcnt(4)
  v_mfma_f32_16x16x32_bf16 v[100:103], v[68:71], v[160:163], v[100:103]
  ds_read_b128 v[48:51], v12 offset:50176
  v_mfma_f32_16x16x32_bf16 v[104:107], v[72:75], v[160:163], v[104:107]
  ds_read_b128 v[52:55], v12 offset:51200
  v_mfma_f32_16x16x32_bf16 v[108:111], v[76:79], v[160:163], v[108:111]
  ds_read_b128 v[56:59], v12 offset:52224
  v_mfma_f32_16x16x32_bf16 v[112:115], v[80:83], v[160:163], v[112:115]
  ds_read_b128 v[60:63], v12 offset:53248
  v_mfma_f32_16x16x32_bf16 v[116:119], v[84:87], v[160:163], v[116:119]
  ds_read_b128 v[64:67], v12 offset:54272
  buffer_load_dwordx4 v[120:123], v5, s[16:19], s68 offen offset:2048 sc1
  buffer_load_dwordx4 v[124:127], v5, s[16:19], s68 offen offset:3072 sc1
  s_waitcnt vmcnt(14) lgkmcnt(4)
  v_mfma_f32_16x16x32_bf16 v[100:103], v[88:91], v[164:167], v[100:103]
  ds_read_b128 v[68:71], v12 offset:55296
  v_mfma_f32_16x16x32_bf16 v[104:107], v[92:95], v[164:167], v[104:107]
  ds_read_b128 v[72:75], v12 offset:56320
  v_mfma_f32_16x16x32_bf16 v[108:111], v[96:99], v[164:167], v[108:111]
  ds_read_b128 v[76:79], v12 offset:57344
  v_mfma_f32_16x16x32_bf16 v[112:115], v[44:47], v[164:167], v[112:115]
  ds_read_b128 v[80:83], v12 offset:58368
  v_mfma_f32_16x16x32_bf16 v[116:119], v[48:51], v[164:167], v[116:119]
  ds_read_b128 v[84:87], v12 offset:59392
  buffer_load_dwordx4 v[128:131], v5, s[16:19], s69 offen offset:2048 sc1
  buffer_load_dwordx4 v[132:135], v5, s[16:19], s69 offen offset:3072 sc1
  s_waitcnt vmcnt(15) lgkmcnt(4)
  v_mfma_f32_16x16x32_bf16 v[100:103], v[52:55], v[168:171], v[100:103]
  ds_read_b128 v[88:91], v12 offset:60416
  v_mfma_f32_16x16x32_bf16 v[104:107], v[56:59], v[168:171], v[104:107]
  ds_read_b128 v[92:95], v12 offset:61440
  v_mfma_f32_16x16x32_bf16 v[108:111], v[60:63], v[168:171], v[108:111]
  ds_read_b128 v[96:99], v12 offset:62464
  v_mfma_f32_16x16x32_bf16 v[112:115], v[64:67], v[168:171], v[112:115]
  ds_read_b128 v[44:47], v12 offset:63488
  v_mfma_f32_16x16x32_bf16 v[116:119], v[68:71], v[168:171], v[116:119]
  ds_read_b128 v[48:51], v12 offset:64512
  buffer_load_dwordx4 v[136:139], v5, s[16:19], s70 offen offset:2048 sc1
  buffer_load_dwordx4 v[140:143], v5, s[16:19], s70 offen offset:3072 sc1
  s_waitcnt vmcnt(16) lgkmcnt(4)
  v_mfma_f32_16x16x32_bf16 v[100:103], v[72:75], v[172:175], v[100:103]
  ds_read_b128 v[52:55], v13 offset:0
  v_mfma_f32_16x16x32_bf16 v[104:107], v[76:79], v[172:175], v[104:107]
  ds_read_b128 v[56:59], v13 offset:1024
  v_mfma_f32_16x16x32_bf16 v[108:111], v[80:83], v[172:175], v[108:111]
  ds_read_b128 v[60:63], v13 offset:2048
  v_mfma_f32_16x16x32_bf16 v[112:115], v[84:87], v[172:175], v[112:115]
  ds_read_b128 v[64:67], v13 offset:3072
  s_waitcnt vmcnt(12)
  s_cmp_eq_u32 s6, 0
  s_cbranch_scc1 SL_137
  s_mov_b64 exec, 1
  buffer_store_dword v252, v11, s[16:19], s44 offen
  s_mov_b64 exec, -1
  s_branch SE_138
SL_137:
  s_nop 1
  s_mov_b64 exec, 1
  buffer_store_dword v252, v11, s[16:19], s44 offen sc1
  s_mov_b64 exec, -1
SE_138:
  v_mfma_f32_16x16x32_bf16 v[116:119], v[88:91], v[172:175], v[116:119]
  ds_read_b128 v[68:71], v13 offset:4096
  buffer_load_dwordx4 v[144:147], v5, s[16:19], s71 offen offset:2048 sc1
  buffer_load_dwordx4 v[148:151], v5, s[16:19], s71 offen offset:3072 sc1
  s_barrier
  s_waitcnt lgkmcnt(4)
  v_mfma_f32_16x16x32_bf16 v[100:103], v[92:95], v[40:43], v[100:103]
  ds_read_b128 v[72:75], v13 offset:5120
  v_mfma_f32_16x16x32_bf16 v[104:107], v[96:99], v[40:43], v[104:107]
  ds_read_b128 v[76:79], v13 offset:6144
  v_mfma_f32_16x16x32_bf16 v[108:111], v[44:47], v[40:43], v[108:111]
  ds_read_b128 v[80:83], v13 offset:7168
  v_mfma_f32_16x16x32_bf16 v[112:115], v[48:51], v[40:43], v[112:115]
  ds_read_b128 v[84:87], v13 offset:8192
  v_mfma_f32_16x16x32_bf16 v[116:119], v[52:55], v[40:43], v[116:119]
  ds_read_b128 v[88:91], v13 offset:9216
  s_waitcnt lgkmcnt(4)
  v_mfma_f32_16x16x32_bf16 v[100:103], v[56:59], v[200:203], v[100:103]
  ds_read_b128 v[92:95], v13 offset:10240
  v_mfma_f32_16x16x32_bf16 v[104:107], v[60:63], v[200:203], v[104:107]
  ds_read_b128 v[96:99], v13 offset:11264
  v_mfma_f32_16x16x32_bf16 v[108:111], v[64:67], v[200:203], v[108:111]
  ds_read_b128 v[44:47], v13 offset:12288
  v_mfma_f32_16x16x32_bf16 v[112:115], v[68:71], v[200:203], v[112:115]
  ds_read_b128 v[48:51], v13 offset:13312
  v_mfma_f32_16x16x32_bf16 v[116:119], v[72:75], v[200:203], v[116:119]
  ds_read_b128 v[52:55], v13 offset:14336
  s_waitcnt vmcnt(14) lgkmcnt(4)
  v_mfma_f32_16x16x32_bf16 v[100:103], v[76:79], v[176:179], v[100:103]
  ds_read_b128 v[56:59], v13 offset:15360
  v_mfma_f32_16x16x32_bf16 v[104:107], v[80:83], v[176:179], v[104:107]
  ds_read_b128 v[60:63], v13 offset:16384
  v_mfma_f32_16x16x32_bf16 v[108:111], v[84:87], v[176:179], v[108:111]
  ds_read_b128 v[64:67], v13 offset:17408
  v_mfma_f32_16x16x32_bf16 v[112:115], v[88:91], v[176:179], v[112:115]
  ds_read_b128 v[68:71], v13 offset:18432
  v_mfma_f32_16x16x32_bf16 v[116:119], v[92:95], v[176:179], v[116:119]
  ds_read_b128 v[72:75], v13 offset:19456
  s_waitcnt vmcnt(13) lgkmcnt(4)
  v_mfma_f32_16x16x32_bf16 v[100:103], v[96:99], v[180:183], v[100:103]
  ds_read_b128 v[76:79], v13 offset:20480
  v_mfma_f32_16x16x32_bf16 v[104:107], v[44:47], v[180:183], v[104:107]
  ds_read_b128 v[80:83], v13 offset:21504
  v_mfma_f32_16x16x32_bf16 v[108:111], v[48:51], v[180:183], v[108:111]
  ds_read_b128 v[84:87], v13 offset:22528
  v_mfma_f32_16x16x32_bf16 v[112:115], v[52:55], v[180:183], v[112:115]
  ds_read_b128 v[88:91], v13 offset:23552
  v_mfma_f32_16x16x32_bf16 v[116:119], v[56:59], v[180:183], v[116:119]
  ds_read_b128 v[92:95], v13 offset:24576
  s_waitcnt vmcnt(12) lgkmcnt(4)
  v_mfma_f32_16x16x32_bf16 v[100:103], v[60:63], v[184:187], v[100:103]
  ds_read_b128 v[96:99], v13 offset:25600
  v_mfma_f32_16x16x32_bf16 v[104:107], v[64:67], v[184:187], v[104:107]
  ds_read_b128 v[44:47], v13 offset:26624
  v_mfma_f32_16x16x32_bf16 v[108:111], v[68:71], v[184:187], v[108:111]
  ds_read_b128 v[48:51], v13 offset:27648
  v_mfma_f32_16x16x32_bf16 v[112:115], v[72:75], v[184:187], v[112:115]
  ds_read_b128 v[52:55], v13 offset:28672
  v_mfma_f32_16x16x32_bf16 v[116:119], v[76:79], v[184:187], v[116:119]
  ds_read_b128 v[56:59], v13 offset:29696
  s_waitcnt vmcnt(11) lgkmcnt(4)
  v_mfma_f32_16x16x32_bf16 v[100:103], v[80:83], v[188:191], v[100:103]
  ds_read_b128 v[60:63], v13 offset:30720
  v_mfma_f32_16x16x32_bf16 v[104:107], v[84:87], v[188:191], v[104:107]
  ds_read_b128 v[64:67], v13 offset:31744
  v_mfma_f32_16x16x32_bf16 v[108:111], v[88:91], v[188:191], v[108:111]
  ds_read_b128 v[68:71], v13 offset:32768
  v_mfma_f32_16x16x32_bf16 v[112:115], v[92:95], v[188:191], v[112:115]
  ds_read_b128 v[72:75], v13 offset:33792
  v_mfma_f32_16x16x32_bf16 v[116:119], v[96:99], v[188:191], v[116:119]
  ds_read_b128 v[76:79], v13 offset:34816
  buffer_load_dword v205, v204, s[16:19], s46 offen sc1
  s_waitcnt vmcnt(11) lgkmcnt(4)
  v_mfma_f32_16x16x32_bf16 v[100:103], v[44:47], v[192:195], v[100:103]
  ds_read_b128 v[80:83], v13 offset:35840
  v_mfma_f32_16x16x32_bf16 v[104:107], v[48:51], v[192:195], v[104:107]
  ds_read_b128 v[84:87], v13 offset:36864
  v_mfma_f32_16x16x32_bf16 v[108:111], v[52:55], v[192:195], v[108:111]
  ds_read_b128 v[88:91], v13 offset:37888
  v_mfma_f32_16x16x32_bf16 v[112:115], v[56:59], v[192:195], v[112:115]
  ds_read_b128 v[92:95], v13 offset:38912
  v_mfma_f32_16x16x32_bf16 v[116:119], v[60:63], v[192:195], v[116:119]
  ds_read_b128 v[96:99], v13 offset:39936
  s_waitcnt vmcnt(10) lgkmcnt(4)
  v_mfma_f32_16x16x32_bf16 v[100:103], v[64:67], v[196:199], v[100:103]
  ds_read_b128 v[44:47], v13 offset:40960
  v_mfma_f32_16x16x32_bf16 v[104:107], v[68:71], v[196:199], v[104:107]
  ds_read_b128 v[48:51], v13 offset:41984
  v_mfma_f32_16x16x32_bf16 v[108:111], v[72:75], v[196:199], v[108:111]
  ds_read_b128 v[52:55], v13 offset:43008
  v_mfma_f32_16x16x32_bf16 v[112:115], v[76:79], v[196:199], v[112:115]
  ds_read_b128 v[56:59], v13 offset:44032
  v_mfma_f32_16x16x32_bf16 v[116:119], v[80:83], v[196:199], v[116:119]
  ds_read_b128 v[60:63], v13 offset:45056
  s_barrier
  s_waitcnt vmcnt(9) lgkmcnt(4)
  v_mfma_f32_16x16x32_bf16 v[100:103], v[84:87], v[120:123], v[100:103]
  ds_read_b128 v[64:67], v13 offset:46080
  v_mfma_f32_16x16x32_bf16 v[104:107], v[88:91], v[120:123], v[104:107]
  ds_read_b128 v[68:71], v13 offset:47104
  v_mfma_f32_16x16x32_bf16 v[108:111], v[92:95], v[120:123], v[108:111]
  ds_read_b128 v[72:75], v13 offset:48128
  v_mfma_f32_16x16x32_bf16 v[112:115], v[96:99], v[120:123], v[112:115]
  ds_read_b128 v[76:79], v13 offset:49152
  v_mfma_f32_16x16x32_bf16 v[116:119], v[44:47], v[120:123], v[116:119]
  ds_read_b128 v[80:83], v13 offset:50176
  s_waitcnt vmcnt(8) lgkmcnt(4)
  v_mfma_f32_16x16x32_bf16 v[100:103], v[48:51], v[124:127], v[100:103]
  ds_read_b128 v[84:87], v13 offset:51200
  v_mfma_f32_16x16x32_bf16 v[104:107], v[52:55], v[124:127], v[104:107]
  ds_read_b128 v[88:91], v13 offset:52224
  v_mfma_f32_16x16x32_bf16 v[108:111], v[56:59], v[124:127], v[108:111]
  ds_read_b128 v[92:95], v13 offset:53248
  v_mfma_f32_16x16x32_bf16 v[112:115], v[60:63], v[124:127], v[112:115]
  ds_read_b128 v[96:99], v13 offset:54272
  v_mfma_f32_16x16x32_bf16 v[116:119], v[64:67], v[124:127], v[116:119]
  ds_read_b128 v[44:47], v13 offset:55296
  s_waitcnt vmcnt(7) lgkmcnt(4)
  v_mfma_f32_16x16x32_bf16 v[100:103], v[68:71], v[128:131], v[100:103]
  ds_read_b128 v[48:51], v13 offset:56320
  v_mfma_f32_16x16x32_bf16 v[104:107], v[72:75], v[128:131], v[104:107]
  ds_read_b128 v[52:55], v13 offset:57344
  v_mfma_f32_16x16x32_bf16 v[108:111], v[76:79], v[128:131], v[108:111]
  ds_read_b128 v[56:59], v13 offset:58368
  v_mfma_f32_16x16x32_bf16 v[112:115], v[80:83], v[128:131], v[112:115]
  ds_read_b128 v[60:63], v13 offset:59392
  v_mfma_f32_16x16x32_bf16 v[116:119], v[84:87], v[128:131], v[116:119]
  ds_read_b128 v[64:67], v13 offset:60416
  s_waitcnt vmcnt(6) lgkmcnt(4)
  v_mfma_f32_16x16x32_bf16 v[100:103], v[88:91], v[132:135], v[100:103]
  ds_read_b128 v[68:71], v13 offset:61440
  v_mfma_f32_16x16x32_bf16 v[104:107], v[92:95], v[132:135], v[104:107]
  ds_read_b128 v[72:75], v13 offset:62464
  v_mfma_f32_16x16x32_bf16 v[108:111], v[96:99], v[132:135], v[108:111]
  ds_read_b128 v[76:79], v13 offset:63488
  v_mfma_f32_16x16x32_bf16 v[112:115], v[44:47], v[132:135], v[112:115]
  ds_read_b128 v[80:83], v13 offset:64512
  v_mfma_f32_16x16x32_bf16 v[116:119], v[48:51], v[132:135], v[116:119]
  ds_read_b128 v[84:87], v14 offset:0
  s_waitcnt vmcnt(5) lgkmcnt(4)
  v_mfma_f32_16x16x32_bf16 v[100:103], v[52:55], v[136:139], v[100:103]
  ds_read_b128 v[88:91], v14 offset:1024
  v_mfma_f32_16x16x32_bf16 v[104:107], v[56:59], v[136:139], v[104:107]
  ds_read_b128 v[92:95], v14 offset:2048
  v_mfma_f32_16x16x32_bf16 v[108:111], v[60:63], v[136:139], v[108:111]
  ds_read_b128 v[96:99], v14 offset:3072
  v_mfma_f32_16x16x32_bf16 v[112:115], v[64:67], v[136:139], v[112:115]
  ds_read_b128 v[44:47], v14 offset:4096
  s_mov_b32 s7, 400000
  s_waitcnt vmcnt(0)
  s_branch PE_141
P_139:
  buffer_load_dword v205, v204, s[16:19], s46 offen sc1
  s_waitcnt vmcnt(0)
PE_141:
  v_cmp_ne_u32 vcc, s99, v205
  s_nop 0
  s_cbranch_vccz PD_140
  s_sub_u32 s7, s7, 1
  s_cbranch_scc0 P_139
PD_140:
  s_add_u32 s46, s46, 4096
  v_mfma_f32_16x16x32_bf16 v[116:119], v[68:71], v[136:139], v[116:119]
  ds_read_b128 v[48:51], v14 offset:5120
  s_add_u32 s65, s65, 4096
  buffer_load_dwordx4 v[152:155], v5, s[16:19], s65 offen offset:0 sc1
  buffer_load_dwordx4 v[156:159], v5, s[16:19], s65 offen offset:1024 sc1
  s_waitcnt vmcnt(6) lgkmcnt(4)
  v_mfma_f32_16x16x32_bf16 v[100:103], v[72:75], v[140:143], v[100:103]
  ds_read_b128 v[52:55], v14 offset:6144
  v_mfma_f32_16x16x32_bf16 v[104:107], v[76:79], v[140:143], v[104:107]
  ds_read_b128 v[56:59], v14 offset:7168
  v_mfma_f32_16x16x32_bf16 v[108:111], v[80:83], v[140:143], v[108:111]
  ds_read_b128 v[60:63], v14 offset:8192
  v_mfma_f32_16x16x32_bf16 v[112:115], v[84:87], v[140:143], v[112:115]
  ds_read_b128 v[64:67], v14 offset:9216
  v_mfma_f32_16x16x32_bf16 v[116:119], v[88:91], v[140:143], v[116:119]
  ds_read_b128 v[68:71], v14 offset:10240
  s_add_u32 s66, s66, 4096
  buffer_load_dwordx4 v[160:163], v5, s[16:19], s66 offen offset:0 sc1
  buffer_load_dwordx4 v[164:167], v5, s[16:19], s66 offen offset:1024 sc1
  s_waitcnt vmcnt(6) lgkmcnt(4)
  v_mfma_f32_16x16x32_bf16 v[100:103], v[92:95], v[144:147], v[100:103]
  ds_read_b128 v[72:75], v14 offset:11264
  v_mfma_f32_16x16x32_bf16 v[104:107], v[96:99], v[144:147], v[104:107]
  ds_read_b128 v[76:79], v12 offset:0
  v_mfma_f32_16x16x32_bf16 v[108:111], v[44:47], v[144:147], v[108:111]
  ds_read_b128 v[80:83], v12 offset:1024
  v_mfma_f32_16x16x32_bf16 v[112:115], v[48:51], v[144:147], v[112:115]
  ds_read_b128 v[84:87], v12 offset:2048
  v_mfma_f32_16x16x32_bf16 v[116:119], v[52:55], v[144:147], v[116:119]
  ds_read_b128 v[88:91], v12 offset:3072
  s_add_u32 s67, s67, 4096
  buffer_load_dwordx4 v[168:171], v5, s[16:19], s67 offen offset:0 sc1
  buffer_load_dwordx4 v[172:175], v5, s[16:19], s67 offen offset:1024 sc1
  s_waitcnt vmcnt(7) lgkmcnt(4)
  v_mfma_f32_16x16x32_bf16 v[100:103], v[56:59], v[148:151], v[100:103]
  ds_read_b128 v[92:95], v12 offset:4096
  v_mfma_f32_16x16x32_bf16 v[104:107], v[60:63], v[148:151], v[104:107]
  ds_read_b128 v[96:99], v12 offset:5120
  v_mfma_f32_16x16x32_bf16 v[108:111], v[64:67], v[148:151], v[108:111]
  ds_read_b128 v[44:47], v12 offset:6144
  v_mfma_f32_16x16x32_bf16 v[112:115], v[68:71], v[148:151], v[112:115]
  ds_read_b128 v[48:51], v12 offset:7168
  v_mfma_f32_16x16x32_bf16 v[116:119], v[72:75], v[148:151], v[116:119]
  ds_read_b128 v[52:55], v12 offset:8192
  s_add_u32 s68, s68, 4096
  buffer_load_dwordx4 v[176:179], v5, s[16:19], s68 offen offset:0 sc1
  buffer_load_dwordx4 v[180:183], v5, s[16:19], s68 offen offset:1024 sc1
  s_barrier
  s_waitcnt lgkmcnt(4)
  v_mfma_f32_16x16x32_bf16 v[100:103], v[76:79], v[248:251], v[100:103]
  ds_read_b128 v[56:59], v12 offset:9216
  v_mfma_f32_16x16x32_bf16 v[104:107], v[80:83], v[248:251], v[104:107]
  ds_read_b128 v[60:63], v12 offset:10240
  v_mfma_f32_16x16x32_bf16 v[108:111], v[84:87], v[248:251], v[108:111]
  ds_read_b128 v[64:67], v12 offset:11264
  v_mfma_f32_16x16x32_bf16 v[112:115], v[88:91], v[248:251], v[112:115]
  ds_read_b128 v[68:71], v12 offset:12288
  v_mfma_f32_16x16x32_bf16 v[116:119], v[92:95], v[248:251], v[116:119]
  ds_read_b128 v[72:75], v12 offset:13312
  s_add_u32 s69, s69, 4096
  buffer_load_dwordx4 v[184:187], v5, s[16:19], s69 offen offset:0 sc1
  buffer_load_dwordx4 v[188:191], v5, s[16:19], s69 offen offset:1024 sc1
  s_waitcnt lgkmcnt(4)
  v_mfma_f32_16x16x32_bf16 v[100:103], v[96:99], v[236:239], v[100:103]
  ds_read_b128 v[76:79], v12 offset:14336
  v_mfma_f32_16x16x32_bf16 v[104:107], v[44:47], v[236:239], v[104:107]
  ds_read_b128 v[80:83], v12 offset:15360
  v_mfma_f32_16x16x32_bf16 v[108:111], v[48:51], v[236:239], v[108:111]
  ds_read_b128 v[84:87], v12 offset:16384
  v_mfma_f32_16x16x32_bf16 v[112:115], v[52:55], v[236:239], v[112:115]
  ds_read_b128 v[88:91], v12 offset:17408
  v_mfma_f32_16x16x32_bf16 v[116:119], v[56:59], v[236:239], v[116:119]
  ds_read_b128 v[92:95], v12 offset:18432
  s_add_u32 s70, s70, 4096
  buffer_load_dwordx4 v[192:195], v5, s[16:19], s70 offen offset:0 sc1
  buffer_load_dwordx4 v[196:199], v5, s[16:19], s70 offen offset:1024 sc1
  s_waitcnt vmcnt(11) lgkmcnt(4)
  v_mfma_f32_16x16x32_bf16 v[100:103], v[60:63], v[152:155], v[100:103]
  ds_read_b128 v[96:99], v12 offset:19456
  v_mfma_f32_16x16x32_bf16 v[104:107], v[64:67], v[152:155], v[104:107]
  ds_read_b128 v[44:47], v12 offset:20480
  v_mfma_f32_16x16x32_bf16 v[108:111], v[68:71], v[152:155], v[108:111]
  ds_read_b128 v[48:51], v12 offset:21504
  v_mfma_f32_16x16x32_bf16 v[112:115], v[72:75], v[152:155], v[112:115]
  ds_read_b128 v[52:55], v12 offset:22528
  v_mfma_f32_16x16x32_bf16 v[116:119], v[76:79], v[152:155], v[116:119]
  ds_read_b128 v[56:59], v12 offset:23552
  s_add_u32 s71, s71, 4096
  buffer_load_dwordx4 v[120:123], v5, s[16:19], s71 offen offset:0 sc1
  buffer_load_dwordx4 v[124:127], v5, s[16:19], s71 offen offset:1024 sc1
  s_waitcnt vmcnt(12) lgkmcnt(4)
  v_mfma_f32_16x16x32_bf16 v[100:103], v[80:83], v[156:159], v[100:103]
  ds_read_b128 v[60:63], v12 offset:24576
  v_mfma_f32_16x16x32_bf16 v[104:107], v[84:87], v[156:159], v[104:107]
  ds_read_b128 v[64:67], v12 offset:25600
  v_mfma_f32_16x16x32_bf16 v[108:111], v[88:91], v[156:159], v[108:111]
  ds_read_b128 v[68:71], v12 offset:26624
  v_mfma_f32_16x16x32_bf16 v[112:115], v[92:95], v[156:159], v[112:115]
  ds_read_b128 v[72:75], v12 offset:27648
  v_mfma_f32_16x16x32_bf16 v[116:119], v[96:99], v[156:159], v[116:119]
  ds_read_b128 v[76:79], v12 offset:28672
  s_waitcnt vmcnt(11) lgkmcnt(4)
  v_mfma_f32_16x16x32_bf16 v[100:103], v[44:47], v[160:163], v[100:103]
  ds_read_b128 v[80:83], v12 offset:29696
  v_mfma_f32_16x16x32_bf16 v[104:107], v[48:51], v[160:163], v[104:107]
  ds_read_b128 v[84:87], v12 offset:30720
  v_mfma_f32_16x16x32_bf16 v[108:111], v[52:55], v[160:163], v[108:111]
  ds_read_b128 v[88:91], v12 offset:31744
  v_mfma_f32_16x16x32_bf16 v[112:115], v[56:59], v[160:163], v[112:115]
  ds_read_b128 v[92:95], v12 offset:32768
  v_mfma_f32_16x16x32_bf16 v[116:119], v[60:63], v[160:163], v[116:119]
  ds_read_b128 v[96:99], v12 offset:33792
  s_waitcnt vmcnt(10) lgkmcnt(4)
  v_mfma_f32_16x16x32_bf16 v[100:103], v[64:67], v[164:167], v[100:103]
  ds_read_b128 v[44:47], v12 offset:34816
  v_mfma_f32_16x16x32_bf16 v[104:107], v[68:71], v[164:167], v[104:107]
  ds_read_b128 v[48:51], v12 offset:35840
  v_mfma_f32_16x16x32_bf16 v[108:111], v[72:75], v[164:167], v[108:111]
  ds_read_b128 v[52:55], v12 offset:36864
  v_mfma_f32_16x16x32_bf16 v[112:115], v[76:79], v[164:167], v[112:115]
  ds_read_b128 v[56:59], v12 offset:37888
  v_mfma_f32_16x16x32_bf16 v[116:119], v[80:83], v[164:167], v[116:119]
  ds_read_b128 v[60:63], v12 offset:38912
  s_waitcnt vmcnt(9) lgkmcnt(4)
  v_mfma_f32_16x16x32_bf16 v[100:103], v[84:87], v[168:171], v[100:103]
  ds_read_b128 v[64:67], v12 offset:39936
  v_mfma_f32_16x16x32_bf16 v[104:107], v[88:91], v[168:171], v[104:107]
  ds_read_b128 v[68:71], v12 offset:40960
  v_mfma_f32_16x16x32_bf16 v[108:111], v[92:95], v[168:171], v[108:111]
  ds_read_b128 v[72:75], v12 offset:41984
  v_mfma_f32_16x16x32_bf16 v[112:115], v[96:99], v[168:171], v[112:115]
  ds_read_b128 v[76:79], v12 offset:43008
  v_mfma_f32_16x16x32_bf16 v[116:119], v[44:47], v[168:171], v[116:119]
  ds_read_b128 v[80:83], v12 offset:44032
  s_waitcnt vmcnt(8) lgkmcnt(4)
  v_mfma_f32_16x16x32_bf16 v[100:103], v[48:51], v[172:175], v[100:103]
  ds_read_b128 v[84:87], v12 offset:45056
  v_mfma_f32_16x16x32_bf16 v[104:107], v[52:55], v[172:175], v[104:107]
  ds_read_b128 v[88:91], v12 offset:46080
  v_mfma_f32_16x16x32_bf16 v[108:111], v[56:59], v[172:175], v[108:111]
  ds_read_b128 v[92:95], v12 offset:47104
  v_mfma_f32_16x16x32_bf16 v[112:115], v[60:63], v[172:175], v[112:115]
  ds_read_b128 v[96:99], v12 offset:48128
  v_mfma_f32_16x16x32_bf16 v[116:119], v[64:67], v[172:175], v[116:119]
  ds_read_b128 v[44:47], v12 offset:49152
  s_waitcnt vmcnt(7) lgkmcnt(4)
  v_mfma_f32_16x16x32_bf16 v[100:103], v[68:71], v[176:179], v[100:103]
  ds_read_b128 v[48:51], v12 offset:50176
  v_mfma_f32_16x16x32_bf16 v[104:107], v[72:75], v[176:179], v[104:107]
  ds_read_b128 v[52:55], v12 offset:51200
  v_mfma_f32_16x16x32_bf16 v[108:111], v[76:79], v[176:179], v[108:111]
  ds_read_b128 v[56:59], v12 offset:52224
  v_mfma_f32_16x16x32_bf16 v[112:115], v[80:83], v[176:179], v[112:115]
  ds_read_b128 v[60:63], v12 offset:53248
  v_mfma_f32_16x16x32_bf16 v[116:119], v[84:87], v[176:179], v[116:119]
  ds_read_b128 v[64:67], v12 offset:54272
  s_waitcnt vmcnt(6) lgkmcnt(4)
  v_mfma_f32_16x16x32_bf16 v[100:103], v[88:91], v[180:183], v[100:103]
  ds_read_b128 v[68:71], v12 offset:55296
  v_mfma_f32_16x16x32_bf16 v[104:107], v[92:95], v[180:183], v[104:107]
  ds_read_b128 v[72:75], v12 offset:56320
  v_mfma_f32_16x16x32_bf16 v[108:111], v[96:99], v[180:183], v[108:111]
  ds_read_b128 v[76:79], v12 offset:57344
  v_mfma_f32_16x16x32_bf16 v[112:115], v[44:47], v[180:183], v[112:115]
  ds_read_b128 v[80:83], v12 offset:58368
  v_mfma_f32_16x16x32_bf16 v[116:119], v[48:51], v[180:183], v[116:119]
  ds_read_b128 v[84:87], v12 offset:59392
  s_waitcnt vmcnt(5) lgkmcnt(4)
  v_mfma_f32_16x16x32_bf16 v[100:103], v[52:55], v[184:187], v[100:103]
  ds_read_b128 v[88:91], v12 offset:60416
  v_mfma_f32_16x16x32_bf16 v[104:107], v[56:59], v[184:187], v[104:107]
  ds_read_b128 v[92:95], v12 offset:61440
  v_mfma_f32_16x16x32_bf16 v[108:111], v[60:63], v[184:187], v[108:111]
  ds_read_b128 v[96:99], v12 offset:62464
  v_mfma_f32_16x16x32_bf16 v[112:115], v[64:67], v[184:187], v[112:115]
  ds_read_b128 v[44:47], v12 offset:63488
  v_mfma_f32_16x16x32_bf16 v[116:119], v[68:71], v[184:187], v[116:119]
  ds_read_b128 v[48:51], v12 offset:64512
  s_waitcnt vmcnt(4) lgkmcnt(4)
  v_mfma_f32_16x16x32_bf16 v[100:103], v[72:75], v[188:191], v[100:103]
  ds_read_b128 v[52:55], v13 offset:0
  v_mfma_f32_16x16x32_bf16 v[104:107], v[76:79], v[188:191], v[104:107]
  ds_read_b128 v[56:59], v13 offset:1024
  v_mfma_f32_16x16x32_bf16 v[108:111], v[80:83], v[188:191], v[108:111]
  ds_read_b128 v[60:63], v13 offset:2048
  v_mfma_f32_16x16x32_bf16 v[112:115], v[84:87], v[188:191], v[112:115]
  ds_read_b128 v[64:67], v13 offset:3072
  v_mfma_f32_16x16x32_bf16 v[116:119], v[88:91], v[188:191], v[116:119]
  ds_read_b128 v[68:71], v13 offset:4096
  s_waitcnt vmcnt(3) lgkmcnt(4)
  v_mfma_f32_16x16x32_bf16 v[100:103], v[92:95], v[192:195], v[100:103]
  ds_read_b128 v[72:75], v13 offset:5120
  v_mfma_f32_16x16x32_bf16 v[104:107], v[96:99], v[192:195], v[104:107]
  ds_read_b128 v[76:79], v13 offset:6144
  v_mfma_f32_16x16x32_bf16 v[108:111], v[44:47], v[192:195], v[108:111]
  ds_read_b128 v[80:83], v13 offset:7168
  v_mfma_f32_16x16x32_bf16 v[112:115], v[48:51], v[192:195], v[112:115]
  ds_read_b128 v[84:87], v13 offset:8192
  v_mfma_f32_16x16x32_bf16 v[116:119], v[52:55], v[192:195], v[116:119]
  ds_read_b128 v[88:91], v13 offset:9216
  s_waitcnt vmcnt(2) lgkmcnt(4)
  v_mfma_f32_16x16x32_bf16 v[100:103], v[56:59], v[196:199], v[100:103]
  ds_read_b128 v[92:95], v13 offset:10240
  v_mfma_f32_16x16x32_bf16 v[104:107], v[60:63], v[196:199], v[104:107]
  ds_read_b128 v[96:99], v13 offset:11264
  v_mfma_f32_16x16x32_bf16 v[108:111], v[64:67], v[196:199], v[108:111]
  ds_read_b128 v[44:47], v13 offset:12288
  v_mfma_f32_16x16x32_bf16 v[112:115], v[68:71], v[196:199], v[112:115]
  ds_read_b128 v[48:51], v13 offset:13312
  v_mfma_f32_16x16x32_bf16 v[116:119], v[72:75], v[196:199], v[116:119]
  ds_read_b128 v[52:55], v13 offset:14336
  s_waitcnt vmcnt(1) lgkmcnt(4)
  v_mfma_f32_16x16x32_bf16 v[100:103], v[76:79], v[120:123], v[100:103]
  ds_read_b128 v[56:59], v13 offset:15360
  v_mfma_f32_16x16x32_bf16 v[104:107], v[80:83], v[120:123], v[104:107]
  v_mfma_f32_16x16x32_bf16 v[108:111], v[84:87], v[120:123], v[108:111]
  v_mfma_f32_16x16x32_bf16 v[112:115], v[88:91], v[120:123], v[112:115]
  v_mfma_f32_16x16x32_bf16 v[116:119], v[92:95], v[120:123], v[116:119]
  s_waitcnt vmcnt(0) lgkmcnt(0)
  v_mfma_f32_16x16x32_bf16 v[100:103], v[96:99], v[124:127], v[100:103]
  v_mfma_f32_16x16x32_bf16 v[104:107], v[44:47], v[124:127], v[104:107]
  v_mfma_f32_16x16x32_bf16 v[108:111], v[48:51], v[124:127], v[108:111]
  v_mfma_f32_16x16x32_bf16 v[112:115], v[52:55], v[124:127], v[112:115]
  v_mfma_f32_16x16x32_bf16 v[116:119], v[56:59], v[124:127], v[116:119]
  s_nop 7
  v_cvt_pk_bf16_f32 v228, v116, v117
  v_cvt_pk_bf16_f32 v230, v116, v117
  v_cvt_pk_bf16_f32 v229, v118, v119
  v_cvt_pk_bf16_f32 v231, v118, v119
  v_cvt_pk_bf16_f32 v220, v100, v101
  v_cvt_pk_bf16_f32 v221, v102, v103
  v_cvt_pk_bf16_f32 v222, v104, v105
  v_cvt_pk_bf16_f32 v223, v106, v107
  v_cvt_pk_bf16_f32 v224, v108, v109
  v_cvt_pk_bf16_f32 v225, v110, v111
  v_cvt_pk_bf16_f32 v226, v112, v113
  v_cvt_pk_bf16_f32 v227, v114, v115
  v_permlane16_swap_b32 v228, v230
  v_permlane16_swap_b32 v229, v231
  v_permlane16_swap_b32 v220, v222
  v_permlane16_swap_b32 v221, v223
  v_permlane16_swap_b32 v224, v226
  v_permlane16_swap_b32 v225, v227
  buffer_store_dwordx4 v[220:223], v9, s[20:23], 0 offen
  buffer_store_dwordx4 v[224:227], v9, s[20:23], 0 offen offset:64
  s_mov_b32 exec_lo, 0xffff
  s_mov_b32 exec_hi, 0xffff
  buffer_store_dwordx4 v[228:231], v10, s[20:23], 0 offen
  s_mov_b64 exec, -1
  s_or_b32 s94, s2, s3
  s_cbranch_scc1 EP_142
  s_mov_b32 s94, 0xb9c000
  s_mov_b64 exec, 1
  buffer_store_dword v252, v11, s[16:19], s94 offen
  s_mov_b64 exec, -1
EP_142:
  s_branch L_fin
L_fin:
L_end:
  s_endpgm
.section .rodata,"a"
.p2align 6
.amdhsa_kernel sequential_preLN__linear_kernel_hedgehog__mixer_s_mlp__prompt_kernel
  .amdhsa_next_free_vgpr 256
  .amdhsa_next_free_sgpr 102
  .amdhsa_accum_offset 256
  .amdhsa_group_segment_fixed_size 0
  .amdhsa_kernarg_size 96
  .amdhsa_user_sgpr_count 2
  .amdhsa_user_sgpr_kernarg_segment_ptr 1
  .amdhsa_system_sgpr_workgroup_id_x 1
.end_amdhsa_kernel
```
